```python
import torch

def _softmax(x, axis=-1):
    return torch.softmax(x, dim=axis)

def _gelu(x):
    return torch.nn.functional.gelu(x, approximate='tanh')

def _silu(x):
    return torch.nn.functional.silu(x)

def _sigmoid(x):
    return torch.sigmoid(x)

def _layernorm(x, axis=-1, eps=1e-05):
    m = x.mean(dim=axis, keepdim=True)
    v = x.var(dim=axis, keepdim=True, unbiased=False)
    return (x - m) / torch.sqrt(v + eps)

def _scatter_add(tgt, idx, src, axis=0):
    return tgt.clone().index_add_(axis, idx, src)

def _segment_sum(src, seg, n):
    out = torch.zeros((n,) + src.shape[1:], dtype=src.dtype)
    return out.index_add_(0, seg, src)

def _pad(x, pw):
    flat = tuple((v for pair in reversed(pw) for v in pair))
    return torch.nn.functional.pad(x, flat)
kernel_name = 'parallel_sum__sliding_block__mixer_gmlp__prompt'

def setup_inputs():

    _w = lambda a: (lambda t: t.to(torch.bfloat16) if t.is_floating_point() else t)(torch.as_tensor(a))

    def _A_setup():
        B, S, D = (1, 2048, 512)
        return {'x': _w((lambda *s: torch.randn(*s, dtype=torch.bfloat16) * 0.05)(B, S, D)), 'wqkv': _w((lambda *s: torch.randn(*s, dtype=torch.bfloat16) * 0.1)(D, 3 * D)), 'wo': _w((lambda *s: torch.randn(*s, dtype=torch.bfloat16) * 0.05)(D, D))}
    _A_in = _A_setup()

    def _B_setup():
        B, S, D, F = (1, 2048, 512, 1792)
        Fh = F // 2
        return {'x': _w((lambda *s: torch.randn(*s, dtype=torch.bfloat16) * 0.05)(B, S, D)), 'w_in': _w((lambda *s: torch.randn(*s, dtype=torch.bfloat16) * 0.4)(D, 2 * Fh)), 'w_sp': _w(0.01 * (lambda *s: torch.randn(*s, dtype=torch.bfloat16) * 0.4)(S, S)), 'b_sp': _w(1.0 + 0.01 * (lambda *s: torch.randn(*s, dtype=torch.bfloat16) * 0.05)(S)), 'w_out': _w((lambda *s: torch.randn(*s, dtype=torch.bfloat16) * 0.05)(Fh, D))}
    _B_in = _B_setup()
    return {'A_x': _A_in['x'], 'A_wqkv': _A_in['wqkv'], 'A_wo': _A_in['wo'], 'B_x': _B_in['x'], 'B_w_in': _B_in['w_in'], 'B_w_sp': _B_in['w_sp'], 'B_b_sp': _B_in['b_sp'], 'B_w_out': _B_in['w_out']}

def reference(A_x, A_wqkv, A_wo, B_x, B_w_in, B_w_sp, B_b_sp, B_w_out):

    def _A_ref(x, wqkv, wo):
        B, S, D = x.shape
        H = 32
        Dh = D // H
        W = 256
        qkv = (lambda x, *d: x.permute(*d))((x @ wqkv).reshape(B, S, 3, H, Dh), 2, 0, 3, 1, 4)
        q, k, v = (qkv[0], qkv[1], qkv[2])
        scores = torch.einsum('bhqd,bhkd->bhqk', q, k) * Dh ** (-0.5)
        idx = torch.arange(S)
        mask = (idx[:, None] - idx[None, :] >= 0) & (idx[:, None] - idx[None, :] < W)
        scores = torch.where(mask[None, None], scores, -1000000000.0)
        p = _softmax(scores, axis=-1)
        o = torch.einsum('bhqk,bhkd->bhqd', p, v)
        return (lambda x, *d: x.permute(*d))(o, 0, 2, 1, 3).reshape(B, S, D) @ wo

    def _B_ref(x, w_in, w_sp, b_sp, w_out):
        B, S, D = x.shape
        F = w_in.shape[-1]
        Fh = F // 2
        z = _gelu(torch.einsum('bsd,df->bsf', x, w_in))
        z1 = z[..., :Fh].clone()
        z2 = _layernorm(z[..., Fh:], axis=-1)
        g = torch.einsum('ts,bsf->btf', w_sp, z2) + b_sp[None, :, None]
        return torch.einsum('bsf,fd->bsd', z1 * g, w_out)
    x = A_x
    xn = _layernorm(x, axis=-1)
    return x + _A_ref(xn, A_wqkv, A_wo) + _B_ref(xn, B_w_in, B_w_sp, B_b_sp, B_w_out)
```

```asm
; @launch grid=(256,1,1) block=(256,1,1) lds=163840
.amdgcn_target "amdgcn-amd-amdhsa--gfx950"
.text
.globl parallel_sum__sliding_block__mixer_gmlp__prompt_kernel
.p2align 8
.type parallel_sum__sliding_block__mixer_gmlp__prompt_kernel,@function
parallel_sum__sliding_block__mixer_gmlp__prompt_kernel:
    s_cmp_ge_u32 s2, 256
    s_cbranch_scc1 L_end
    s_load_dwordx16 s[48:63], s[0:1], 0
    s_load_dwordx2 s[44:45], s[0:1], 64
    s_load_dwordx2 s[46:47], s[0:1], 80
    v_lshrrev_b32 v2, 6, v0
    v_and_b32 v0, 63, v0
    v_readfirstlane_b32 s3, v2
    s_and_b32 s64, s2, 7
    s_lshr_b32 s65, s2, 3
    s_lshr_b32 s4, s64, 1
    s_lshl_b32 s4, s4, 3
    s_lshr_b32 s5, s65, 2
    s_add_u32 s4, s4, s5
    s_and_b32 s5, s64, 1
    s_lshl_b32 s5, s5, 2
    s_and_b32 s64, s65, 3
    s_add_u32 s5, s5, s64
    s_lshl_b32 s65, s65, 2
    s_add_u32 s65, s65, s3
    s_getpc_b64 s[66:67]
    s_lshl_b32 s64, s65, 2
    v_and_b32 v2, 3, v0
    v_add_u32 v2, s64, v2
    v_min_u32 v2, ((L_last - parallel_sum__sliding_block__mixer_gmlp__prompt_kernel) / 128 - 1), v2
    v_lshlrev_b32 v2, 7, v2
    global_load_dword v22, v2, s[66:67]
    v_lshrrev_b32 v36, 2, v0
    v_and_b32 v37, 3, v0
    v_lshlrev_b32 v38, 10, v36
    v_lshl_add_u32 v38, v37, 4, v38
    s_lshl_b32 s66, s4, 2
    s_add_u32 s66, s66, s3
    s_lshl_b32 s66, s66, 14
    s_add_u32 s71, s4, s5
    s_and_b32 s71, s71, 3
    s_add_u32 s72, s71, 0
    s_and_b32 s72, s72, 3
    s_mul_i32 s72, s72, 256
    s_add_u32 s72, s72, s66
    s_mov_b32 s67, 0x0a060400
    s_lshl_b32 s68, s5, 3
    s_lshr_b32 s73, s67, s68
    s_and_b32 s73, s73, 0xff
    s_cmp_ge_u32 s5, 4
    s_cselect_b32 s67, 14, 0
    s_add_u32 s73, s73, s67
    v_lshrrev_b32 v2, 4, v0
    v_and_b32 v3, 15, v0
    v_lshlrev_b32 v4, 1, v2
    v_xor_b32 v3, v3, v4
    v_lshlrev_b32 v3, 4, v3
    v_mul_u32_u24 v2, 3584, v2
    v_add_u32 v40, v2, v3
    v_xor_b32 v3, 128, v3
    v_add_u32 v2, v2, v3
    v_add_u32 v41, 13312, v2
    v_add_u32 v42, 26624, v40
    v_add_u32 v43, 39936, v2
    s_lshl_b32 s75, s73, 6
    s_mul_i32 s67, s3, 114688
    s_add_u32 s75, s75, s67
    s_add_u32 s75, s75, 1792
    s_lshl_b32 s7, s3, 10
    s_lshl_b32 s82, s3, 13
    s_mul_i32 s83, s3, 3072
    s_waitcnt lgkmcnt(0)
    s_mov_b32 s8, s48
    s_and_b32 s9, s49, 0xffff
    s_mov_b32 s10, 2097152
    s_mov_b32 s11, 0x00020000
    buffer_load_dwordx4 v[192:195], v38, s[8:11], s72 offen offset:0
    buffer_load_dwordx4 v[196:199], v38, s[8:11], s72 offen offset:64
    buffer_load_dwordx4 v[200:203], v38, s[8:11], s72 offen offset:128
    buffer_load_dwordx4 v[204:207], v38, s[8:11], s72 offen offset:192
    s_add_u32 s72, s71, 1
    s_and_b32 s72, s72, 3
    s_mul_i32 s72, s72, 256
    s_add_u32 s72, s72, s66
    buffer_load_dwordx4 v[208:211], v38, s[8:11], s72 offen offset:0
    buffer_load_dwordx4 v[212:215], v38, s[8:11], s72 offen offset:64
    buffer_load_dwordx4 v[216:219], v38, s[8:11], s72 offen offset:128
    buffer_load_dwordx4 v[220:223], v38, s[8:11], s72 offen offset:192
    s_add_u32 s72, s71, 2
    s_and_b32 s72, s72, 3
    s_mul_i32 s72, s72, 256
    s_add_u32 s72, s72, s66
    buffer_load_dwordx4 v[224:227], v38, s[8:11], s72 offen offset:0
    buffer_load_dwordx4 v[228:231], v38, s[8:11], s72 offen offset:64
    s_mov_b32 s20, s56
    s_and_b32 s21, s57, 0xffff
    s_mov_b32 s22, 1835008
    s_mov_b32 s23, 0x00020000
    s_load_dword s84, s[46:47], 0
    s_mov_b32 s12, s50
    s_and_b32 s13, s51, 0xffff
    s_mov_b32 s14, 1572864
    s_mov_b32 s15, 0x00020000
    s_mov_b32 s16, s52
    s_and_b32 s17, s53, 0xffff
    s_mov_b32 s18, 524288
    s_mov_b32 s19, 0x00020000
    s_mov_b32 s24, s58
    s_and_b32 s25, s59, 0xffff
    s_mov_b32 s26, 8388608
    s_mov_b32 s27, 0x00020000
    s_mov_b32 s28, s60
    s_and_b32 s29, s61, 0xffff
    s_mov_b32 s30, 4096
    s_mov_b32 s31, 0x00020000
    s_mov_b32 s32, s62
    s_and_b32 s33, s63, 0xffff
    s_mov_b32 s34, 917504
    s_mov_b32 s35, 0x00020000
    s_mov_b32 s36, s44
    s_and_b32 s37, s45, 0xffff
    s_mov_b32 s38, 2097152
    s_mov_b32 s39, 0x00020000
    s_mov_b32 s40, s46
    s_and_b32 s41, s47, 0xffff
    s_mov_b32 s42, 268435456
    s_mov_b32 s43, 0x00020000
    v_and_b32 v1, 15, v0
    v_lshrrev_b32 v20, 4, v0
    v_lshlrev_b32 v21, 4, v0
    s_lshl_b32 s67, s65, 6
    v_add_u32 v23, s67, v0
    s_lshl_b32 s67, s3, 6
    v_lshrrev_b32 v2, 3, v0
    v_lshlrev_b32 v3, 1, v20
    v_and_b32 v4, 7, v0
    v_xor_b32 v3, v3, v4
    v_lshlrev_b32 v3, 4, v3
    v_mul_u32_u24 v5, 3072, v2
    v_add_u32 v39, v5, v3
    v_lshl_add_u32 v24, v2, 10, v3
    v_xor_b32 v3, v20, v4
    v_lshlrev_b32 v2, 12, v2
    v_lshl_add_u32 v10, v3, 4, v2
    v_xor_b32 v11, 64, v10
    v_add_u32 v11, 31744, v11
    v_and_b32 v2, 7, v36
    s_lshl_b32 s67, s3, 1
    v_xor_b32 v2, s67, v2
    v_lshlrev_b32 v2, 5, v2
    v_lshl_add_u32 v2, v36, 8, v2
    v_lshl_add_u32 v44, v37, 3, v2
    v_xor_b32 v45, 32, v44
    v_bfe_u32 v25, v0, 3, 2
    v_lshlrev_b32 v2, 7, v36
    v_lshl_add_u32 v26, v37, 3, v2
    v_xor_b32 v2, s3, v25
    v_lshl_add_u32 v2, v2, 5, v26
    v_lshrrev_b32 v3, 5, v0
    v_lshl_add_u32 v46, v3, 11, v2
    v_and_b32 v2, 1, v0
    v_mul_u32_u24 v2, 576, v2
    v_lshlrev_b32 v3, 4, v36
    v_xor_b32 v2, v2, v3
    v_bfe_u32 v3, v0, 1, 1
    v_lshl_add_u32 v2, v3, 3, v2
    s_add_u32 s67, s7, 98304
    v_add_u32 v47, s67, v2
    v_lshrrev_b32 v3, 5, v0
    v_lshlrev_b32 v3, 6, v3
    v_xor_b32 v3, v3, v21
    v_add_u32 v48, 98304, v3
    s_mul_i32 s77, s3, 24576
    s_lshl_b32 s67, s5, 7
    s_add_u32 s77, s77, s67
    s_and_b32 s67, s4, 8
    s_lshl_b32 s67, s67, 8
    s_lshl_b32 s79, s66, 2
    s_add_u32 s79, s79, s67
    s_xor_b32 s79, s79, 2097152
    s_lshl_b32 s81, s3, 11
    v_and_b32 v2, 31, v0
    v_mul_u32_u24 v28, 4, v2
    v_min_u32 v30, 1, v0
    v_lshlrev_b32 v30, 30, v30
    s_lshl_b32 s55, s5, 2
    s_add_u32 s55, s55, s3
    s_mul_i32 s51, s55, 128
    s_add_u32 s51, s51, 65536
    s_mul_i32 s68, s4, 4
    s_add_u32 s52, s51, s68
    s_mul_i32 s53, s4, 128
    s_add_u32 s53, s53, 262144
    s_mul_i32 s68, s55, 4
    s_add_u32 s54, s53, s68
    s_lshl_b32 s57, s4, 13
    s_add_u32 s57, s57, 1048576
    s_lshl_b32 s67, s5, 10
    s_add_u32 s56, s57, s67
    s_lshl_b32 s67, s3, 8
    s_add_u32 s57, s57, s67
    s_add_u32 s58, s57, 4096
    s_lshl_b32 s59, s55, 17
    s_lshl_b32 s67, s4, 12
    s_add_u32 s60, s59, 6291456
    s_add_u32 s59, s59, s67
    s_add_u32 s59, s59, 2097152
    s_mul_i32 s61, s4, 180224
    s_add_u32 s61, s61, 10485760
    s_and_b32 s67, s5, 3
    s_lshl_b32 s67, s67, 2
    s_add_u32 s67, s67, s3
    s_lshr_b32 s74, 0x180, s67
    s_and_b32 s74, s74, 1
    s_lshl_b32 s67, s74, 30
    v_add_u32 v31, s67, v21
    s_add_u32 s73, s73, s3
    s_mov_b32 s62, 0xffff0000
    buffer_load_dwordx4 v[232:235], v38, s[8:11], s72 offen offset:128
    buffer_load_dwordx4 v[236:239], v38, s[8:11], s72 offen offset:192
    s_add_u32 s72, s71, 3
    s_and_b32 s72, s72, 3
    s_mul_i32 s72, s72, 256
    s_add_u32 s72, s72, s66
    buffer_load_dwordx4 v[240:243], v38, s[8:11], s72 offen offset:0
    buffer_load_dwordx4 v[244:247], v38, s[8:11], s72 offen offset:64
    buffer_load_dwordx4 v[248:251], v38, s[8:11], s72 offen offset:128
    buffer_load_dwordx4 v[252:255], v38, s[8:11], s72 offen offset:192
    s_lshl_b32 s63, s73, 10
    s_add_u32 s63, s63, 16384
    s_add_u32 s63, s63, s61
    s_lshl_b32 s85, s2, 2
    s_add_u32 s85, s85, s3
    v_mov_b32 v2, 0
    v_mov_b32 v3, 0
    v_mov_b32 v4, 0
    v_mov_b32 v5, 0
    v_mov_b32 v6, 0
    v_mov_b32 v7, 0
    v_mov_b32 v8, 0
    v_mov_b32 v9, 0
    s_waitcnt vmcnt(15)
    v_lshlrev_b32 v64, 16, v192
    v_and_b32 v65, s62, v192
    v_lshlrev_b32 v66, 16, v193
    s_add_u32 s76, s71, 0
    s_and_b32 s76, s76, 3
    s_mul_i32 s76, s76, 458752
    s_add_u32 s76, s76, s75
    s_add_u32 m0, s82, 0
    s_nop 0
    buffer_load_dwordx4 v40, s[20:23], s76 offen offset:0 lds
    v_and_b32 v67, s62, v193
    v_lshlrev_b32 v68, 16, v194
    v_and_b32 v69, s62, v194
    v_lshlrev_b32 v70, 16, v195
    v_and_b32 v71, s62, v195
    v_pk_add_f32 v[2:3], v[2:3], v[64:65]
    v_pk_fma_f32 v[6:7], v[64:65], v[64:65], v[6:7]
    v_pk_add_f32 v[4:5], v[4:5], v[66:67]
    v_pk_fma_f32 v[8:9], v[66:67], v[66:67], v[8:9]
    v_pk_add_f32 v[2:3], v[2:3], v[68:69]
    v_pk_fma_f32 v[6:7], v[68:69], v[68:69], v[6:7]
    v_pk_add_f32 v[4:5], v[4:5], v[70:71]
    buffer_load_dwordx4 v41, s[20:23], s76 offen offset:1024 lds
    v_pk_fma_f32 v[8:9], v[70:71], v[70:71], v[8:9]
    s_waitcnt vmcnt(16)
    v_lshlrev_b32 v72, 16, v196
    v_and_b32 v73, s62, v196
    v_lshlrev_b32 v74, 16, v197
    v_and_b32 v75, s62, v197
    v_lshlrev_b32 v76, 16, v198
    v_and_b32 v77, s62, v198
    v_lshlrev_b32 v78, 16, v199
    v_and_b32 v79, s62, v199
    v_pk_add_f32 v[2:3], v[2:3], v[72:73]
    v_pk_fma_f32 v[6:7], v[72:73], v[72:73], v[6:7]
    v_pk_add_f32 v[4:5], v[4:5], v[74:75]
    v_pk_fma_f32 v[8:9], v[74:75], v[74:75], v[8:9]
    v_pk_add_f32 v[2:3], v[2:3], v[76:77]
    v_pk_fma_f32 v[6:7], v[76:77], v[76:77], v[6:7]
    v_pk_add_f32 v[4:5], v[4:5], v[78:79]
    buffer_load_dwordx4 v42, s[20:23], s76 offen offset:2048 lds
    v_pk_fma_f32 v[8:9], v[78:79], v[78:79], v[8:9]
    s_waitcnt vmcnt(16)
    v_lshlrev_b32 v80, 16, v200
    v_and_b32 v81, s62, v200
    v_lshlrev_b32 v82, 16, v201
    v_and_b32 v83, s62, v201
    v_lshlrev_b32 v84, 16, v202
    v_and_b32 v85, s62, v202
    v_lshlrev_b32 v86, 16, v203
    v_and_b32 v87, s62, v203
    v_pk_add_f32 v[2:3], v[2:3], v[80:81]
    v_pk_fma_f32 v[6:7], v[80:81], v[80:81], v[6:7]
    v_pk_add_f32 v[4:5], v[4:5], v[82:83]
    v_pk_fma_f32 v[8:9], v[82:83], v[82:83], v[8:9]
    v_pk_add_f32 v[2:3], v[2:3], v[84:85]
    v_pk_fma_f32 v[6:7], v[84:85], v[84:85], v[6:7]
    buffer_load_dwordx4 v43, s[20:23], s76 offen offset:3072 lds
    v_pk_add_f32 v[4:5], v[4:5], v[86:87]
    v_pk_fma_f32 v[8:9], v[86:87], v[86:87], v[8:9]
    s_waitcnt vmcnt(16)
    v_lshlrev_b32 v88, 16, v204
    v_and_b32 v89, s62, v204
    v_lshlrev_b32 v90, 16, v205
    v_and_b32 v91, s62, v205
    v_lshlrev_b32 v92, 16, v206
    v_and_b32 v93, s62, v206
    v_lshlrev_b32 v94, 16, v207
    v_and_b32 v95, s62, v207
    v_pk_add_f32 v[2:3], v[2:3], v[88:89]
    v_pk_fma_f32 v[6:7], v[88:89], v[88:89], v[6:7]
    v_pk_add_f32 v[4:5], v[4:5], v[90:91]
    v_pk_fma_f32 v[8:9], v[90:91], v[90:91], v[8:9]
    v_pk_add_f32 v[2:3], v[2:3], v[92:93]
    v_pk_fma_f32 v[6:7], v[92:93], v[92:93], v[6:7]
    s_add_u32 m0, s82, 4096
    s_add_u32 s76, s76, 57344
    buffer_load_dwordx4 v40, s[20:23], s76 offen offset:0 lds
    v_pk_add_f32 v[4:5], v[4:5], v[94:95]
    v_pk_fma_f32 v[8:9], v[94:95], v[94:95], v[8:9]
    s_waitcnt vmcnt(16)
    v_lshlrev_b32 v96, 16, v208
    v_and_b32 v97, s62, v208
    v_lshlrev_b32 v98, 16, v209
    v_and_b32 v99, s62, v209
    v_lshlrev_b32 v100, 16, v210
    v_and_b32 v101, s62, v210
    v_lshlrev_b32 v102, 16, v211
    v_and_b32 v103, s62, v211
    v_pk_add_f32 v[2:3], v[2:3], v[96:97]
    v_pk_fma_f32 v[6:7], v[96:97], v[96:97], v[6:7]
    v_pk_add_f32 v[4:5], v[4:5], v[98:99]
    v_pk_fma_f32 v[8:9], v[98:99], v[98:99], v[8:9]
    buffer_load_dwordx4 v41, s[20:23], s76 offen offset:1024 lds
    v_pk_add_f32 v[2:3], v[2:3], v[100:101]
    v_pk_fma_f32 v[6:7], v[100:101], v[100:101], v[6:7]
    v_pk_add_f32 v[4:5], v[4:5], v[102:103]
    v_pk_fma_f32 v[8:9], v[102:103], v[102:103], v[8:9]
    s_waitcnt vmcnt(16)
    v_lshlrev_b32 v104, 16, v212
    v_and_b32 v105, s62, v212
    v_lshlrev_b32 v106, 16, v213
    v_and_b32 v107, s62, v213
    v_lshlrev_b32 v108, 16, v214
    v_and_b32 v109, s62, v214
    v_lshlrev_b32 v110, 16, v215
    v_and_b32 v111, s62, v215
    v_pk_add_f32 v[2:3], v[2:3], v[104:105]
    v_pk_fma_f32 v[6:7], v[104:105], v[104:105], v[6:7]
    v_pk_add_f32 v[4:5], v[4:5], v[106:107]
    v_pk_fma_f32 v[8:9], v[106:107], v[106:107], v[8:9]
    v_pk_add_f32 v[2:3], v[2:3], v[108:109]
    v_pk_fma_f32 v[6:7], v[108:109], v[108:109], v[6:7]
    v_pk_add_f32 v[4:5], v[4:5], v[110:111]
    v_pk_fma_f32 v[8:9], v[110:111], v[110:111], v[8:9]
    s_waitcnt vmcnt(15)
    v_lshlrev_b32 v112, 16, v216
    v_and_b32 v113, s62, v216
    v_lshlrev_b32 v114, 16, v217
    v_and_b32 v115, s62, v217
    v_lshlrev_b32 v116, 16, v218
    v_and_b32 v117, s62, v218
    buffer_load_dwordx4 v42, s[20:23], s76 offen offset:2048 lds
    v_lshlrev_b32 v118, 16, v219
    v_and_b32 v119, s62, v219
    v_pk_add_f32 v[2:3], v[2:3], v[112:113]
    v_pk_fma_f32 v[6:7], v[112:113], v[112:113], v[6:7]
    v_pk_add_f32 v[4:5], v[4:5], v[114:115]
    v_pk_fma_f32 v[8:9], v[114:115], v[114:115], v[8:9]
    v_pk_add_f32 v[2:3], v[2:3], v[116:117]
    v_pk_fma_f32 v[6:7], v[116:117], v[116:117], v[6:7]
    v_pk_add_f32 v[4:5], v[4:5], v[118:119]
    v_pk_fma_f32 v[8:9], v[118:119], v[118:119], v[8:9]
    s_waitcnt vmcnt(15)
    v_lshlrev_b32 v120, 16, v220
    v_and_b32 v121, s62, v220
    v_lshlrev_b32 v122, 16, v221
    v_and_b32 v123, s62, v221
    v_lshlrev_b32 v124, 16, v222
    buffer_load_dwordx4 v43, s[20:23], s76 offen offset:3072 lds
    v_and_b32 v125, s62, v222
    v_lshlrev_b32 v126, 16, v223
    v_and_b32 v127, s62, v223
    v_pk_add_f32 v[2:3], v[2:3], v[120:121]
    v_pk_fma_f32 v[6:7], v[120:121], v[120:121], v[6:7]
    v_pk_add_f32 v[4:5], v[4:5], v[122:123]
    v_pk_fma_f32 v[8:9], v[122:123], v[122:123], v[8:9]
    v_pk_add_f32 v[2:3], v[2:3], v[124:125]
    v_pk_fma_f32 v[6:7], v[124:125], v[124:125], v[6:7]
    v_pk_add_f32 v[4:5], v[4:5], v[126:127]
    v_pk_fma_f32 v[8:9], v[126:127], v[126:127], v[8:9]
    s_waitcnt vmcnt(15)
    v_lshlrev_b32 v128, 16, v224
    v_and_b32 v129, s62, v224
    v_lshlrev_b32 v130, 16, v225
    v_and_b32 v131, s62, v225
    v_lshlrev_b32 v132, 16, v226
    s_mul_i32 s69, s85, 896
    v_min_u32 v33, 6, v0
    v_lshlrev_b32 v33, 7, v33
    buffer_load_dword v22, v33, s[32:35], s69 offen
    v_and_b32 v133, s62, v226
    v_lshlrev_b32 v134, 16, v227
    v_and_b32 v135, s62, v227
    v_pk_add_f32 v[2:3], v[2:3], v[128:129]
    v_pk_fma_f32 v[6:7], v[128:129], v[128:129], v[6:7]
    v_pk_add_f32 v[4:5], v[4:5], v[130:131]
    v_pk_fma_f32 v[8:9], v[130:131], v[130:131], v[8:9]
    v_pk_add_f32 v[2:3], v[2:3], v[132:133]
    v_pk_fma_f32 v[6:7], v[132:133], v[132:133], v[6:7]
    v_pk_add_f32 v[4:5], v[4:5], v[134:135]
    v_pk_fma_f32 v[8:9], v[134:135], v[134:135], v[8:9]
    s_waitcnt vmcnt(15)
    v_lshlrev_b32 v136, 16, v228
    v_and_b32 v137, s62, v228
    s_lshl_b32 s69, s85, 9
    v_and_b32 v33, 3, v0
    v_lshlrev_b32 v33, 7, v33
    buffer_load_dword v22, v33, s[16:19], s69 offen
    v_lshlrev_b32 v138, 16, v229
    v_and_b32 v139, s62, v229
    v_lshlrev_b32 v140, 16, v230
    v_and_b32 v141, s62, v230
    v_lshlrev_b32 v142, 16, v231
    v_and_b32 v143, s62, v231
    v_pk_add_f32 v[2:3], v[2:3], v[136:137]
    v_pk_fma_f32 v[6:7], v[136:137], v[136:137], v[6:7]
    v_pk_add_f32 v[4:5], v[4:5], v[138:139]
    v_pk_fma_f32 v[8:9], v[138:139], v[138:139], v[8:9]
    v_pk_add_f32 v[2:3], v[2:3], v[140:141]
    v_pk_fma_f32 v[6:7], v[140:141], v[140:141], v[6:7]
    v_pk_add_f32 v[4:5], v[4:5], v[142:143]
    v_pk_fma_f32 v[8:9], v[142:143], v[142:143], v[8:9]
    s_add_u32 s76, s71, 1
    s_and_b32 s76, s76, 3
    s_mul_i32 s76, s76, 458752
    s_add_u32 s76, s76, s75
    s_add_u32 m0, s82, 32768
    s_nop 0
    buffer_load_dwordx4 v40, s[20:23], s76 offen offset:0 lds
    s_waitcnt vmcnt(16)
    v_lshlrev_b32 v144, 16, v232
    v_and_b32 v145, s62, v232
    v_lshlrev_b32 v146, 16, v233
    v_and_b32 v147, s62, v233
    v_lshlrev_b32 v148, 16, v234
    v_and_b32 v149, s62, v234
    v_lshlrev_b32 v150, 16, v235
    v_and_b32 v151, s62, v235
    v_pk_add_f32 v[2:3], v[2:3], v[144:145]
    v_pk_fma_f32 v[6:7], v[144:145], v[144:145], v[6:7]
    v_pk_add_f32 v[4:5], v[4:5], v[146:147]
    v_pk_fma_f32 v[8:9], v[146:147], v[146:147], v[8:9]
    v_pk_add_f32 v[2:3], v[2:3], v[148:149]
    v_pk_fma_f32 v[6:7], v[148:149], v[148:149], v[6:7]
    v_pk_add_f32 v[4:5], v[4:5], v[150:151]
    v_pk_fma_f32 v[8:9], v[150:151], v[150:151], v[8:9]
    s_waitcnt vmcnt(15)
    v_lshlrev_b32 v152, 16, v236
    v_and_b32 v153, s62, v236
    v_lshlrev_b32 v154, 16, v237
    v_and_b32 v155, s62, v237
    v_lshlrev_b32 v156, 16, v238
    v_and_b32 v157, s62, v238
    v_lshlrev_b32 v158, 16, v239
    v_and_b32 v159, s62, v239
    v_pk_add_f32 v[2:3], v[2:3], v[152:153]
    v_pk_fma_f32 v[6:7], v[152:153], v[152:153], v[6:7]
    v_pk_add_f32 v[4:5], v[4:5], v[154:155]
    v_pk_fma_f32 v[8:9], v[154:155], v[154:155], v[8:9]
    v_pk_add_f32 v[2:3], v[2:3], v[156:157]
    v_pk_fma_f32 v[6:7], v[156:157], v[156:157], v[6:7]
    v_pk_add_f32 v[4:5], v[4:5], v[158:159]
    v_pk_fma_f32 v[8:9], v[158:159], v[158:159], v[8:9]
    s_waitcnt vmcnt(14)
    v_lshlrev_b32 v160, 16, v240
    v_and_b32 v161, s62, v240
    v_lshlrev_b32 v162, 16, v241
    v_and_b32 v163, s62, v241
    v_lshlrev_b32 v164, 16, v242
    v_and_b32 v165, s62, v242
    v_lshlrev_b32 v166, 16, v243
    v_and_b32 v167, s62, v243
    v_pk_add_f32 v[2:3], v[2:3], v[160:161]
    v_pk_fma_f32 v[6:7], v[160:161], v[160:161], v[6:7]
    v_pk_add_f32 v[4:5], v[4:5], v[162:163]
    v_pk_fma_f32 v[8:9], v[162:163], v[162:163], v[8:9]
    v_pk_add_f32 v[2:3], v[2:3], v[164:165]
    v_pk_fma_f32 v[6:7], v[164:165], v[164:165], v[6:7]
    v_pk_add_f32 v[4:5], v[4:5], v[166:167]
    v_pk_fma_f32 v[8:9], v[166:167], v[166:167], v[8:9]
    s_waitcnt vmcnt(13)
    v_lshlrev_b32 v168, 16, v244
    v_and_b32 v169, s62, v244
    v_lshlrev_b32 v170, 16, v245
    v_and_b32 v171, s62, v245
    v_lshlrev_b32 v172, 16, v246
    v_and_b32 v173, s62, v246
    v_lshlrev_b32 v174, 16, v247
    v_and_b32 v175, s62, v247
    v_pk_add_f32 v[2:3], v[2:3], v[168:169]
    v_pk_fma_f32 v[6:7], v[168:169], v[168:169], v[6:7]
    v_pk_add_f32 v[4:5], v[4:5], v[170:171]
    v_pk_fma_f32 v[8:9], v[170:171], v[170:171], v[8:9]
    v_pk_add_f32 v[2:3], v[2:3], v[172:173]
    v_pk_fma_f32 v[6:7], v[172:173], v[172:173], v[6:7]
    v_pk_add_f32 v[4:5], v[4:5], v[174:175]
    v_pk_fma_f32 v[8:9], v[174:175], v[174:175], v[8:9]
    s_waitcnt vmcnt(12)
    v_lshlrev_b32 v176, 16, v248
    v_and_b32 v177, s62, v248
    v_lshlrev_b32 v178, 16, v249
    v_and_b32 v179, s62, v249
    v_lshlrev_b32 v180, 16, v250
    v_and_b32 v181, s62, v250
    v_lshlrev_b32 v182, 16, v251
    v_and_b32 v183, s62, v251
    v_pk_add_f32 v[2:3], v[2:3], v[176:177]
    v_pk_fma_f32 v[6:7], v[176:177], v[176:177], v[6:7]
    v_pk_add_f32 v[4:5], v[4:5], v[178:179]
    v_pk_fma_f32 v[8:9], v[178:179], v[178:179], v[8:9]
    v_pk_add_f32 v[2:3], v[2:3], v[180:181]
    v_pk_fma_f32 v[6:7], v[180:181], v[180:181], v[6:7]
    v_pk_add_f32 v[4:5], v[4:5], v[182:183]
    v_pk_fma_f32 v[8:9], v[182:183], v[182:183], v[8:9]
    s_waitcnt vmcnt(11)
    v_lshlrev_b32 v184, 16, v252
    v_and_b32 v185, s62, v252
    v_lshlrev_b32 v186, 16, v253
    v_and_b32 v187, s62, v253
    v_lshlrev_b32 v188, 16, v254
    v_and_b32 v189, s62, v254
    v_lshlrev_b32 v190, 16, v255
    v_and_b32 v191, s62, v255
    v_pk_add_f32 v[2:3], v[2:3], v[184:185]
    v_pk_fma_f32 v[6:7], v[184:185], v[184:185], v[6:7]
    v_pk_add_f32 v[4:5], v[4:5], v[186:187]
    v_pk_fma_f32 v[8:9], v[186:187], v[186:187], v[8:9]
    v_pk_add_f32 v[2:3], v[2:3], v[188:189]
    v_pk_fma_f32 v[6:7], v[188:189], v[188:189], v[6:7]
    v_pk_add_f32 v[4:5], v[4:5], v[190:191]
    v_pk_fma_f32 v[8:9], v[190:191], v[190:191], v[8:9]
    s_waitcnt lgkmcnt(0)
    s_mul_i32 s6, s84, 0x9E3779B1
    s_add_u32 s6, s6, 0x7F4A7C15
    v_pk_add_f32 v[2:3], v[2:3], v[4:5]
    v_pk_add_f32 v[6:7], v[6:7], v[8:9]
    v_add_f32 v2, v2, v3
    v_add_f32 v6, v6, v7
    v_mov_b32 v29, s6
    v_add_f32_dpp v2, v2, v2 quad_perm:[1,0,3,2] row_mask:0xf bank_mask:0xf
    v_add_f32_dpp v6, v6, v6 quad_perm:[1,0,3,2] row_mask:0xf bank_mask:0xf
    s_nop 0
    v_add_f32_dpp v2, v2, v2 quad_perm:[2,3,0,1] row_mask:0xf bank_mask:0xf
    v_add_f32_dpp v6, v6, v6 quad_perm:[2,3,0,1] row_mask:0xf bank_mask:0xf
    v_mul_f32 v2, 0x3b000000, v2
    v_mul_f32 v6, 0x3b000000, v6
    v_fma_f32 v6, -v2, v2, v6
    v_max_f32 v6, 0, v6
    v_add_f32 v6, 0x3727c5ac, v6
    v_rsq_f32 v4, v6
    v_mul_f32 v5, -1.0, v2
    v_mul_f32 v5, v5, v4
    v_pk_fma_f32 v[64:65], v[64:65], v[4:5], v[4:5] op_sel:[0,0,1] op_sel_hi:[1,0,1]
    v_pk_fma_f32 v[66:67], v[66:67], v[4:5], v[4:5] op_sel:[0,0,1] op_sel_hi:[1,0,1]
    v_pk_fma_f32 v[68:69], v[68:69], v[4:5], v[4:5] op_sel:[0,0,1] op_sel_hi:[1,0,1]
    v_pk_fma_f32 v[70:71], v[70:71], v[4:5], v[4:5] op_sel:[0,0,1] op_sel_hi:[1,0,1]
    v_cvt_pk_bf16_f32 v192, v64, v65
    v_cvt_pk_bf16_f32 v193, v66, v67
    v_cvt_pk_bf16_f32 v194, v68, v69
    v_cvt_pk_bf16_f32 v195, v70, v71
    ds_write_b64 v47, v[192:193] offset:0
    ds_write_b64 v47, v[194:195] offset:256
    v_pk_fma_f32 v[72:73], v[72:73], v[4:5], v[4:5] op_sel:[0,0,1] op_sel_hi:[1,0,1]
    v_pk_fma_f32 v[74:75], v[74:75], v[4:5], v[4:5] op_sel:[0,0,1] op_sel_hi:[1,0,1]
    v_pk_fma_f32 v[76:77], v[76:77], v[4:5], v[4:5] op_sel:[0,0,1] op_sel_hi:[1,0,1]
    v_pk_fma_f32 v[78:79], v[78:79], v[4:5], v[4:5] op_sel:[0,0,1] op_sel_hi:[1,0,1]
    v_cvt_pk_bf16_f32 v196, v72, v73
    v_cvt_pk_bf16_f32 v197, v74, v75
    v_cvt_pk_bf16_f32 v198, v76, v77
    v_cvt_pk_bf16_f32 v199, v78, v79
    ds_write_b64 v47, v[196:197] offset:4096
    ds_write_b64 v47, v[198:199] offset:4352
    v_pk_fma_f32 v[80:81], v[80:81], v[4:5], v[4:5] op_sel:[0,0,1] op_sel_hi:[1,0,1]
    v_pk_fma_f32 v[82:83], v[82:83], v[4:5], v[4:5] op_sel:[0,0,1] op_sel_hi:[1,0,1]
    v_pk_fma_f32 v[84:85], v[84:85], v[4:5], v[4:5] op_sel:[0,0,1] op_sel_hi:[1,0,1]
    v_pk_fma_f32 v[86:87], v[86:87], v[4:5], v[4:5] op_sel:[0,0,1] op_sel_hi:[1,0,1]
    v_cvt_pk_bf16_f32 v200, v80, v81
    v_cvt_pk_bf16_f32 v201, v82, v83
    v_cvt_pk_bf16_f32 v202, v84, v85
    v_cvt_pk_bf16_f32 v203, v86, v87
    ds_write_b64 v47, v[200:201] offset:8192
    ds_write_b64 v47, v[202:203] offset:8448
    v_pk_fma_f32 v[88:89], v[88:89], v[4:5], v[4:5] op_sel:[0,0,1] op_sel_hi:[1,0,1]
    v_pk_fma_f32 v[90:91], v[90:91], v[4:5], v[4:5] op_sel:[0,0,1] op_sel_hi:[1,0,1]
    v_pk_fma_f32 v[92:93], v[92:93], v[4:5], v[4:5] op_sel:[0,0,1] op_sel_hi:[1,0,1]
    v_pk_fma_f32 v[94:95], v[94:95], v[4:5], v[4:5] op_sel:[0,0,1] op_sel_hi:[1,0,1]
    v_cvt_pk_bf16_f32 v204, v88, v89
    v_cvt_pk_bf16_f32 v205, v90, v91
    v_cvt_pk_bf16_f32 v206, v92, v93
    v_cvt_pk_bf16_f32 v207, v94, v95
    ds_write_b64 v47, v[204:205] offset:12288
    ds_write_b64 v47, v[206:207] offset:12544
    v_pk_fma_f32 v[96:97], v[96:97], v[4:5], v[4:5] op_sel:[0,0,1] op_sel_hi:[1,0,1]
    v_pk_fma_f32 v[98:99], v[98:99], v[4:5], v[4:5] op_sel:[0,0,1] op_sel_hi:[1,0,1]
    v_pk_fma_f32 v[100:101], v[100:101], v[4:5], v[4:5] op_sel:[0,0,1] op_sel_hi:[1,0,1]
    v_pk_fma_f32 v[102:103], v[102:103], v[4:5], v[4:5] op_sel:[0,0,1] op_sel_hi:[1,0,1]
    v_cvt_pk_bf16_f32 v208, v96, v97
    v_cvt_pk_bf16_f32 v209, v98, v99
    v_cvt_pk_bf16_f32 v210, v100, v101
    v_cvt_pk_bf16_f32 v211, v102, v103
    ds_write_b64 v47, v[208:209] offset:16384
    ds_write_b64 v47, v[210:211] offset:16640
    v_pk_fma_f32 v[104:105], v[104:105], v[4:5], v[4:5] op_sel:[0,0,1] op_sel_hi:[1,0,1]
    v_pk_fma_f32 v[106:107], v[106:107], v[4:5], v[4:5] op_sel:[0,0,1] op_sel_hi:[1,0,1]
    v_pk_fma_f32 v[108:109], v[108:109], v[4:5], v[4:5] op_sel:[0,0,1] op_sel_hi:[1,0,1]
    v_pk_fma_f32 v[110:111], v[110:111], v[4:5], v[4:5] op_sel:[0,0,1] op_sel_hi:[1,0,1]
    v_cvt_pk_bf16_f32 v212, v104, v105
    v_cvt_pk_bf16_f32 v213, v106, v107
    v_cvt_pk_bf16_f32 v214, v108, v109
    v_cvt_pk_bf16_f32 v215, v110, v111
    ds_write_b64 v47, v[212:213] offset:20480
    ds_write_b64 v47, v[214:215] offset:20736
    v_pk_fma_f32 v[112:113], v[112:113], v[4:5], v[4:5] op_sel:[0,0,1] op_sel_hi:[1,0,1]
    v_pk_fma_f32 v[114:115], v[114:115], v[4:5], v[4:5] op_sel:[0,0,1] op_sel_hi:[1,0,1]
    v_pk_fma_f32 v[116:117], v[116:117], v[4:5], v[4:5] op_sel:[0,0,1] op_sel_hi:[1,0,1]
    v_pk_fma_f32 v[118:119], v[118:119], v[4:5], v[4:5] op_sel:[0,0,1] op_sel_hi:[1,0,1]
    v_cvt_pk_bf16_f32 v216, v112, v113
    v_cvt_pk_bf16_f32 v217, v114, v115
    v_cvt_pk_bf16_f32 v218, v116, v117
    v_cvt_pk_bf16_f32 v219, v118, v119
    ds_write_b64 v47, v[216:217] offset:24576
    ds_write_b64 v47, v[218:219] offset:24832
    v_pk_fma_f32 v[120:121], v[120:121], v[4:5], v[4:5] op_sel:[0,0,1] op_sel_hi:[1,0,1]
    v_pk_fma_f32 v[122:123], v[122:123], v[4:5], v[4:5] op_sel:[0,0,1] op_sel_hi:[1,0,1]
    v_pk_fma_f32 v[124:125], v[124:125], v[4:5], v[4:5] op_sel:[0,0,1] op_sel_hi:[1,0,1]
    v_pk_fma_f32 v[126:127], v[126:127], v[4:5], v[4:5] op_sel:[0,0,1] op_sel_hi:[1,0,1]
    v_cvt_pk_bf16_f32 v220, v120, v121
    v_cvt_pk_bf16_f32 v221, v122, v123
    v_cvt_pk_bf16_f32 v222, v124, v125
    v_cvt_pk_bf16_f32 v223, v126, v127
    ds_write_b64 v47, v[220:221] offset:28672
    ds_write_b64 v47, v[222:223] offset:28928
    s_waitcnt lgkmcnt(0)
    s_barrier
    v_pk_fma_f32 v[128:129], v[128:129], v[4:5], v[4:5] op_sel:[0,0,1] op_sel_hi:[1,0,1]
    v_pk_fma_f32 v[130:131], v[130:131], v[4:5], v[4:5] op_sel:[0,0,1] op_sel_hi:[1,0,1]
    v_pk_fma_f32 v[132:133], v[132:133], v[4:5], v[4:5] op_sel:[0,0,1] op_sel_hi:[1,0,1]
    ds_read_b128 a[0:3], v48 offset:0
    v_pk_fma_f32 v[134:135], v[134:135], v[4:5], v[4:5] op_sel:[0,0,1] op_sel_hi:[1,0,1]
    v_cvt_pk_bf16_f32 v224, v128, v129
    ds_read_b128 a[4:7], v48 offset:1024
    v_cvt_pk_bf16_f32 v225, v130, v131
    v_cvt_pk_bf16_f32 v226, v132, v133
    ds_read_b128 a[8:11], v48 offset:2048
    v_cvt_pk_bf16_f32 v227, v134, v135
    ds_write_b64 v47, v[224:225] offset:32768
    ds_write_b64 v47, v[226:227] offset:33024
    ds_read_b128 a[12:15], v48 offset:3072
    v_pk_fma_f32 v[136:137], v[136:137], v[4:5], v[4:5] op_sel:[0,0,1] op_sel_hi:[1,0,1]
    v_pk_fma_f32 v[138:139], v[138:139], v[4:5], v[4:5] op_sel:[0,0,1] op_sel_hi:[1,0,1]
    v_pk_fma_f32 v[140:141], v[140:141], v[4:5], v[4:5] op_sel:[0,0,1] op_sel_hi:[1,0,1]
    ds_read_b128 a[16:19], v48 offset:4096
    v_pk_fma_f32 v[142:143], v[142:143], v[4:5], v[4:5] op_sel:[0,0,1] op_sel_hi:[1,0,1]
    v_cvt_pk_bf16_f32 v228, v136, v137
    ds_read_b128 a[20:23], v48 offset:5120
    v_cvt_pk_bf16_f32 v229, v138, v139
    v_cvt_pk_bf16_f32 v230, v140, v141
    ds_read_b128 a[24:27], v48 offset:6144
    v_cvt_pk_bf16_f32 v231, v142, v143
    ds_write_b64 v47, v[228:229] offset:36864
    ds_write_b64 v47, v[230:231] offset:37120
    ds_read_b128 a[28:31], v48 offset:7168
    v_pk_fma_f32 v[144:145], v[144:145], v[4:5], v[4:5] op_sel:[0,0,1] op_sel_hi:[1,0,1]
    v_pk_fma_f32 v[146:147], v[146:147], v[4:5], v[4:5] op_sel:[0,0,1] op_sel_hi:[1,0,1]
    v_pk_fma_f32 v[148:149], v[148:149], v[4:5], v[4:5] op_sel:[0,0,1] op_sel_hi:[1,0,1]
    ds_read_b128 a[32:35], v48 offset:8192
    v_pk_fma_f32 v[150:151], v[150:151], v[4:5], v[4:5] op_sel:[0,0,1] op_sel_hi:[1,0,1]
    v_cvt_pk_bf16_f32 v232, v144, v145
    ds_read_b128 a[36:39], v48 offset:9216
    v_cvt_pk_bf16_f32 v233, v146, v147
    v_cvt_pk_bf16_f32 v234, v148, v149
    ds_read_b128 a[40:43], v48 offset:10240
    v_cvt_pk_bf16_f32 v235, v150, v151
    ds_write_b64 v47, v[232:233] offset:40960
    ds_write_b64 v47, v[234:235] offset:41216
    ds_read_b128 a[44:47], v48 offset:11264
    v_pk_fma_f32 v[152:153], v[152:153], v[4:5], v[4:5] op_sel:[0,0,1] op_sel_hi:[1,0,1]
    v_pk_fma_f32 v[154:155], v[154:155], v[4:5], v[4:5] op_sel:[0,0,1] op_sel_hi:[1,0,1]
    v_pk_fma_f32 v[156:157], v[156:157], v[4:5], v[4:5] op_sel:[0,0,1] op_sel_hi:[1,0,1]
    ds_read_b128 a[48:51], v48 offset:12288
    v_pk_fma_f32 v[158:159], v[158:159], v[4:5], v[4:5] op_sel:[0,0,1] op_sel_hi:[1,0,1]
    v_cvt_pk_bf16_f32 v236, v152, v153
    ds_read_b128 a[52:55], v48 offset:13312
    v_cvt_pk_bf16_f32 v237, v154, v155
    v_cvt_pk_bf16_f32 v238, v156, v157
    ds_read_b128 a[56:59], v48 offset:14336
    v_cvt_pk_bf16_f32 v239, v158, v159
    ds_write_b64 v47, v[236:237] offset:45056
    ds_write_b64 v47, v[238:239] offset:45312
    buffer_load_dwordx4 v41, s[20:23], s76 offen offset:1024 lds
    ds_read_b128 a[60:63], v48 offset:15360
    v_pk_fma_f32 v[160:161], v[160:161], v[4:5], v[4:5] op_sel:[0,0,1] op_sel_hi:[1,0,1]
    v_pk_fma_f32 v[162:163], v[162:163], v[4:5], v[4:5] op_sel:[0,0,1] op_sel_hi:[1,0,1]
    v_pk_fma_f32 v[164:165], v[164:165], v[4:5], v[4:5] op_sel:[0,0,1] op_sel_hi:[1,0,1]
    ds_read_b128 a[64:67], v48 offset:16384
    v_pk_fma_f32 v[166:167], v[166:167], v[4:5], v[4:5] op_sel:[0,0,1] op_sel_hi:[1,0,1]
    v_cvt_pk_bf16_f32 v240, v160, v161
    ds_read_b128 a[68:71], v48 offset:17408
    v_cvt_pk_bf16_f32 v241, v162, v163
    v_cvt_pk_bf16_f32 v242, v164, v165
    ds_read_b128 a[72:75], v48 offset:18432
    v_cvt_pk_bf16_f32 v243, v166, v167
    ds_write_b64 v47, v[240:241] offset:49152
    ds_write_b64 v47, v[242:243] offset:49408
    ds_read_b128 a[76:79], v48 offset:19456
    v_pk_fma_f32 v[168:169], v[168:169], v[4:5], v[4:5] op_sel:[0,0,1] op_sel_hi:[1,0,1]
    v_pk_fma_f32 v[170:171], v[170:171], v[4:5], v[4:5] op_sel:[0,0,1] op_sel_hi:[1,0,1]
    v_pk_fma_f32 v[172:173], v[172:173], v[4:5], v[4:5] op_sel:[0,0,1] op_sel_hi:[1,0,1]
    ds_read_b128 a[80:83], v48 offset:20480
    buffer_load_dwordx4 v42, s[20:23], s76 offen offset:2048 lds
    v_pk_fma_f32 v[174:175], v[174:175], v[4:5], v[4:5] op_sel:[0,0,1] op_sel_hi:[1,0,1]
    v_cvt_pk_bf16_f32 v244, v168, v169
    ds_read_b128 a[84:87], v48 offset:21504
    v_cvt_pk_bf16_f32 v245, v170, v171
    v_cvt_pk_bf16_f32 v246, v172, v173
    ds_read_b128 a[88:91], v48 offset:22528
    v_cvt_pk_bf16_f32 v247, v174, v175
    ds_write_b64 v47, v[244:245] offset:53248
    ds_write_b64 v47, v[246:247] offset:53504
    ds_read_b128 a[92:95], v48 offset:23552
    v_pk_fma_f32 v[176:177], v[176:177], v[4:5], v[4:5] op_sel:[0,0,1] op_sel_hi:[1,0,1]
    v_pk_fma_f32 v[178:179], v[178:179], v[4:5], v[4:5] op_sel:[0,0,1] op_sel_hi:[1,0,1]
    v_pk_fma_f32 v[180:181], v[180:181], v[4:5], v[4:5] op_sel:[0,0,1] op_sel_hi:[1,0,1]
    ds_read_b128 a[96:99], v48 offset:24576
    v_pk_fma_f32 v[182:183], v[182:183], v[4:5], v[4:5] op_sel:[0,0,1] op_sel_hi:[1,0,1]
    v_cvt_pk_bf16_f32 v248, v176, v177
    ds_read_b128 a[100:103], v48 offset:25600
    v_cvt_pk_bf16_f32 v249, v178, v179
    v_cvt_pk_bf16_f32 v250, v180, v181
    buffer_load_dwordx4 v43, s[20:23], s76 offen offset:3072 lds
    ds_read_b128 a[104:107], v48 offset:26624
    v_cvt_pk_bf16_f32 v251, v182, v183
    ds_write_b64 v47, v[248:249] offset:57344
    ds_write_b64 v47, v[250:251] offset:57600
    ds_read_b128 a[108:111], v48 offset:27648
    v_pk_fma_f32 v[184:185], v[184:185], v[4:5], v[4:5] op_sel:[0,0,1] op_sel_hi:[1,0,1]
    v_pk_fma_f32 v[186:187], v[186:187], v[4:5], v[4:5] op_sel:[0,0,1] op_sel_hi:[1,0,1]
    v_pk_fma_f32 v[188:189], v[188:189], v[4:5], v[4:5] op_sel:[0,0,1] op_sel_hi:[1,0,1]
    ds_read_b128 a[112:115], v48 offset:28672
    v_pk_fma_f32 v[190:191], v[190:191], v[4:5], v[4:5] op_sel:[0,0,1] op_sel_hi:[1,0,1]
    v_cvt_pk_bf16_f32 v252, v184, v185
    ds_read_b128 a[116:119], v48 offset:29696
    v_cvt_pk_bf16_f32 v253, v186, v187
    v_cvt_pk_bf16_f32 v254, v188, v189
    ds_read_b128 a[120:123], v48 offset:30720
    v_cvt_pk_bf16_f32 v255, v190, v191
    ds_write_b64 v47, v[252:253] offset:61440
    ds_write_b64 v47, v[254:255] offset:61696
    ds_read_b128 a[124:127], v48 offset:31744
    s_add_u32 m0, s82, 36864
    s_add_u32 s76, s76, 57344
    buffer_load_dwordx4 v40, s[20:23], s76 offen offset:0 lds
    s_waitcnt lgkmcnt(0)
    s_waitcnt vmcnt(7)
    s_barrier
    v_mov_b32 v52, 0xbdd2d3e8
    buffer_load_dwordx4 v41, s[20:23], s76 offen offset:1024 lds
    v_mov_b32 v53, 0xc0135761
    buffer_load_dwordx4 v42, s[20:23], s76 offen offset:2048 lds
    v_lshlrev_b32 v38, 4, v1
    v_lshl_add_u32 v38, v20, 10, v38
    v_and_b32 v2, 0x27, v0
    v_bfe_u32 v3, v0, 3, 1
    v_lshl_or_b32 v2, v3, 4, v2
    v_and_b32 v3, 1, v20
    v_lshl_or_b32 v2, v3, 3, v2
    v_lshlrev_b32 v47, 4, v2
    buffer_load_dwordx4 v43, s[20:23], s76 offen offset:3072 lds
    v_lshl_or_b32 v3, v3, 5, v1
    v_lshrrev_b32 v4, 5, v0
    v_lshl_or_b32 v3, v4, 4, v3
    v_lshlrev_b32 v49, 4, v3
    s_add_u32 s86, s51, 589824
    s_mov_b32 s44, 15
    s_mov_b32 s45, 0
    s_lshl_b64 s[44:45], s[44:45], s4
    s_lshr_b64 s[44:45], s[44:45], 4
    v_add_u32 v50, 0, v44
    v_add_u32 v51, 0, v45
    ds_read_b64_tr_b16 v[188:189], v50 offset:0
    ds_read_b64_tr_b16 v[190:191], v50 offset:4096
    ds_read_b64_tr_b16 v[192:193], v51 offset:0
    ds_read_b64_tr_b16 v[194:195], v51 offset:4096
    ds_read_b64_tr_b16 v[200:201], v50 offset:8192
    ds_read_b64_tr_b16 v[202:203], v50 offset:12288
    ds_read_b64_tr_b16 v[204:205], v51 offset:8192
    ds_read_b64_tr_b16 v[206:207], v51 offset:12288
    s_add_u32 s76, s71, 2
    s_and_b32 s76, s76, 3
    s_mul_i32 s76, s76, 458752
    s_add_u32 s76, s76, s75
    s_add_u32 m0, s82, 65536
    s_nop 0
    buffer_load_dwordx4 v40, s[20:23], s76 offen offset:0 lds
    s_waitcnt lgkmcnt(4)
    v_mfma_f32_16x16x32_bf16 v[156:159], v[188:191], a[0:3], 0
    ds_read_b64_tr_b16 v[212:213], v50 offset:16384
    v_mfma_f32_16x16x32_bf16 v[160:163], v[188:191], a[4:7], 0
    ds_read_b64_tr_b16 v[214:215], v50 offset:20480
    buffer_load_dwordx4 v41, s[20:23], s76 offen offset:1024 lds
    v_mfma_f32_16x16x32_bf16 v[164:167], v[188:191], a[8:11], 0
    ds_read_b64_tr_b16 v[216:217], v51 offset:16384
    v_mfma_f32_16x16x32_bf16 v[168:171], v[188:191], a[12:15], 0
    ds_read_b64_tr_b16 v[218:219], v51 offset:20480
    v_mfma_f32_16x16x32_bf16 v[172:175], v[192:195], a[0:3], 0
    ds_read_b128 a[128:131], v48 offset:32768
    v_mfma_f32_16x16x32_bf16 v[176:179], v[192:195], a[4:7], 0
    ds_read_b128 a[132:135], v48 offset:33792
    v_mfma_f32_16x16x32_bf16 v[180:183], v[192:195], a[8:11], 0
    ds_read_b128 a[136:139], v48 offset:34816
    buffer_load_dwordx4 v42, s[20:23], s76 offen offset:2048 lds
    v_mfma_f32_16x16x32_bf16 v[184:187], v[192:195], a[12:15], 0
    ds_read_b128 a[140:143], v48 offset:35840
    s_waitcnt lgkmcnt(8)
    v_mfma_f32_16x16x32_bf16 v[156:159], v[200:203], a[16:19], v[156:159]
    ds_read_b64_tr_b16 v[188:189], v50 offset:24576
    v_mfma_f32_16x16x32_bf16 v[160:163], v[200:203], a[20:23], v[160:163]
    ds_read_b64_tr_b16 v[190:191], v50 offset:28672
    v_mfma_f32_16x16x32_bf16 v[164:167], v[200:203], a[24:27], v[164:167]
    ds_read_b64_tr_b16 v[192:193], v51 offset:24576
    v_mfma_f32_16x16x32_bf16 v[168:171], v[200:203], a[28:31], v[168:171]
    ds_read_b64_tr_b16 v[194:195], v51 offset:28672
    buffer_load_dwordx4 v43, s[20:23], s76 offen offset:3072 lds
    v_mfma_f32_16x16x32_bf16 v[172:175], v[204:207], a[16:19], v[172:175]
    ds_read_b128 a[144:147], v48 offset:36864
    v_mfma_f32_16x16x32_bf16 v[176:179], v[204:207], a[20:23], v[176:179]
    ds_read_b128 a[148:151], v48 offset:37888
    v_mfma_f32_16x16x32_bf16 v[180:183], v[204:207], a[24:27], v[180:183]
    ds_read_b128 a[152:155], v48 offset:38912
    v_mfma_f32_16x16x32_bf16 v[184:187], v[204:207], a[28:31], v[184:187]
    ds_read_b128 a[156:159], v48 offset:39936
    s_waitcnt vmcnt(4)
    s_barrier
    s_waitcnt lgkmcnt(12)
    v_mfma_f32_16x16x32_bf16 v[156:159], v[212:215], a[32:35], v[156:159]
    s_add_u32 m0, s82, 69632
    s_add_u32 s76, s76, 57344
    buffer_load_dwordx4 v40, s[20:23], s76 offen offset:0 lds
    v_add_u32 v50, 32768, v44
    buffer_load_dwordx4 v41, s[20:23], s76 offen offset:1024 lds
    v_mfma_f32_16x16x32_bf16 v[160:163], v[212:215], a[36:39], v[160:163]
    v_add_u32 v51, 32768, v45
    v_mfma_f32_16x16x32_bf16 v[164:167], v[212:215], a[40:43], v[164:167]
    ds_read_b64_tr_b16 v[200:201], v50 offset:0
    v_mfma_f32_16x16x32_bf16 v[168:171], v[212:215], a[44:47], v[168:171]
    buffer_load_dwordx4 v42, s[20:23], s76 offen offset:2048 lds
    ds_read_b64_tr_b16 v[202:203], v50 offset:4096
    ds_read_b64_tr_b16 v[204:205], v51 offset:0
    v_mfma_f32_16x16x32_bf16 v[172:175], v[216:219], a[32:35], v[172:175]
    ds_read_b64_tr_b16 v[206:207], v51 offset:4096
    v_mfma_f32_16x16x32_bf16 v[176:179], v[216:219], a[36:39], v[176:179]
    ds_read_b128 a[160:163], v48 offset:40960
    v_mfma_f32_16x16x32_bf16 v[180:183], v[216:219], a[40:43], v[180:183]
    ds_read_b128 a[164:167], v48 offset:41984
    v_mfma_f32_16x16x32_bf16 v[184:187], v[216:219], a[44:47], v[184:187]
    ds_read_b128 a[168:171], v48 offset:43008
    buffer_load_dwordx4 v43, s[20:23], s76 offen offset:3072 lds
    ds_read_b128 a[172:175], v48 offset:44032
    s_waitcnt lgkmcnt(12)
    v_mfma_f32_16x16x32_bf16 v[156:159], v[188:191], a[48:51], v[156:159]
    ds_read_b64_tr_b16 v[212:213], v50 offset:8192
    v_mfma_f32_16x16x32_bf16 v[160:163], v[188:191], a[52:55], v[160:163]
    ds_read_b64_tr_b16 v[214:215], v50 offset:12288
    v_mfma_f32_16x16x32_bf16 v[164:167], v[188:191], a[56:59], v[164:167]
    ds_read_b64_tr_b16 v[216:217], v51 offset:8192
    v_mfma_f32_16x16x32_bf16 v[168:171], v[188:191], a[60:63], v[168:171]
    ds_read_b64_tr_b16 v[218:219], v51 offset:12288
    v_mfma_f32_16x16x32_bf16 v[172:175], v[192:195], a[48:51], v[172:175]
    s_add_u32 s76, s71, 3
    s_and_b32 s76, s76, 3
    s_mul_i32 s76, s76, 458752
    s_add_u32 s76, s76, s75
    s_add_u32 m0, s82, 98304
    s_nop 0
    buffer_load_dwordx4 v40, s[20:23], s76 offen offset:0 lds
    ds_read_b128 a[176:179], v48 offset:45056
    v_mfma_f32_16x16x32_bf16 v[176:179], v[192:195], a[52:55], v[176:179]
    ds_read_b128 a[180:183], v48 offset:46080
    v_mfma_f32_16x16x32_bf16 v[180:183], v[192:195], a[56:59], v[180:183]
    ds_read_b128 a[184:187], v48 offset:47104
    v_mfma_f32_16x16x32_bf16 v[184:187], v[192:195], a[60:63], v[184:187]
    ds_read_b128 a[188:191], v48 offset:48128
    s_waitcnt lgkmcnt(12)
    v_mfma_f32_16x16x32_bf16 v[156:159], v[200:203], a[64:67], v[156:159]
    buffer_load_dwordx4 v41, s[20:23], s76 offen offset:1024 lds
    ds_read_b64_tr_b16 v[188:189], v50 offset:16384
    v_mfma_f32_16x16x32_bf16 v[160:163], v[200:203], a[68:71], v[160:163]
    ds_read_b64_tr_b16 v[190:191], v50 offset:20480
    v_mfma_f32_16x16x32_bf16 v[164:167], v[200:203], a[72:75], v[164:167]
    ds_read_b64_tr_b16 v[192:193], v51 offset:16384
    v_mfma_f32_16x16x32_bf16 v[168:171], v[200:203], a[76:79], v[168:171]
    ds_read_b64_tr_b16 v[194:195], v51 offset:20480
    v_mfma_f32_16x16x32_bf16 v[172:175], v[204:207], a[64:67], v[172:175]
    ds_read_b128 a[192:195], v48 offset:49152
    v_mfma_f32_16x16x32_bf16 v[176:179], v[204:207], a[68:71], v[176:179]
    buffer_load_dwordx4 v42, s[20:23], s76 offen offset:2048 lds
    ds_read_b128 a[196:199], v48 offset:50176
    v_mfma_f32_16x16x32_bf16 v[180:183], v[204:207], a[72:75], v[180:183]
    ds_read_b128 a[200:203], v48 offset:51200
    v_mfma_f32_16x16x32_bf16 v[184:187], v[204:207], a[76:79], v[184:187]
    ds_read_b128 a[204:207], v48 offset:52224
    s_waitcnt lgkmcnt(12)
    v_mfma_f32_16x16x32_bf16 v[156:159], v[212:215], a[80:83], v[156:159]
    ds_read_b64_tr_b16 v[200:201], v50 offset:24576
    v_mfma_f32_16x16x32_bf16 v[160:163], v[212:215], a[84:87], v[160:163]
    ds_read_b64_tr_b16 v[202:203], v50 offset:28672
    v_mfma_f32_16x16x32_bf16 v[164:167], v[212:215], a[88:91], v[164:167]
    buffer_load_dwordx4 v43, s[20:23], s76 offen offset:3072 lds
    ds_read_b64_tr_b16 v[204:205], v51 offset:24576
    v_mfma_f32_16x16x32_bf16 v[168:171], v[212:215], a[92:95], v[168:171]
    ds_read_b64_tr_b16 v[206:207], v51 offset:28672
    v_mfma_f32_16x16x32_bf16 v[172:175], v[216:219], a[80:83], v[172:175]
    ds_read_b128 a[208:211], v48 offset:53248
    v_mfma_f32_16x16x32_bf16 v[176:179], v[216:219], a[84:87], v[176:179]
    ds_read_b128 a[212:215], v48 offset:54272
    v_mfma_f32_16x16x32_bf16 v[180:183], v[216:219], a[88:91], v[180:183]
    ds_read_b128 a[216:219], v48 offset:55296
    v_mfma_f32_16x16x32_bf16 v[184:187], v[216:219], a[92:95], v[184:187]
    s_add_u32 m0, s82, 102400
    s_add_u32 s76, s76, 57344
    buffer_load_dwordx4 v40, s[20:23], s76 offen offset:0 lds
    ds_read_b128 a[220:223], v48 offset:56320
    s_waitcnt vmcnt(5)
    s_barrier
    s_waitcnt lgkmcnt(12)
    v_mfma_f32_16x16x32_bf16 v[156:159], v[188:191], a[96:99], v[156:159]
    buffer_load_dwordx4 v41, s[20:23], s76 offen offset:1024 lds
    v_add_u32 v50, 65536, v44
    buffer_load_dwordx4 v42, s[20:23], s76 offen offset:2048 lds
    v_mfma_f32_16x16x32_bf16 v[160:163], v[188:191], a[100:103], v[160:163]
    v_add_u32 v51, 65536, v45
    v_mfma_f32_16x16x32_bf16 v[164:167], v[188:191], a[104:107], v[164:167]
    ds_read_b64_tr_b16 v[212:213], v50 offset:0
    v_mfma_f32_16x16x32_bf16 v[168:171], v[188:191], a[108:111], v[168:171]
    buffer_load_dwordx4 v43, s[20:23], s76 offen offset:3072 lds
    ds_read_b64_tr_b16 v[214:215], v50 offset:4096
    ds_read_b64_tr_b16 v[216:217], v51 offset:0
    v_mfma_f32_16x16x32_bf16 v[172:175], v[192:195], a[96:99], v[172:175]
    ds_read_b64_tr_b16 v[218:219], v51 offset:4096
    v_mfma_f32_16x16x32_bf16 v[176:179], v[192:195], a[100:103], v[176:179]
    ds_read_b128 a[224:227], v48 offset:57344
    v_mfma_f32_16x16x32_bf16 v[180:183], v[192:195], a[104:107], v[180:183]
    ds_read_b128 a[228:231], v48 offset:58368
    v_mfma_f32_16x16x32_bf16 v[184:187], v[192:195], a[108:111], v[184:187]
    ds_read_b128 a[232:235], v48 offset:59392
    s_add_u32 s78, s71, 0
    s_and_b32 s78, s78, 3
    s_mul_i32 s78, s78, 393216
    s_add_u32 s78, s78, s77
    s_add_u32 m0, s83, 0
    s_nop 0
    buffer_load_dwordx4 v39, s[12:15], s78 offen offset:0 lds
    ds_read_b128 a[236:239], v48 offset:60416
    s_waitcnt lgkmcnt(12)
    v_mfma_f32_16x16x32_bf16 v[156:159], v[200:203], a[112:115], v[156:159]
    ds_read_b64_tr_b16 v[188:189], v50 offset:8192
    v_mfma_f32_16x16x32_bf16 v[160:163], v[200:203], a[116:119], v[160:163]
    ds_read_b64_tr_b16 v[190:191], v50 offset:12288
    v_mfma_f32_16x16x32_bf16 v[164:167], v[200:203], a[120:123], v[164:167]
    ds_read_b64_tr_b16 v[192:193], v51 offset:8192
    v_mfma_f32_16x16x32_bf16 v[168:171], v[200:203], a[124:127], v[168:171]
    buffer_load_dwordx4 v39, s[12:15], s78 offen offset:1024 lds
    ds_read_b64_tr_b16 v[194:195], v51 offset:12288
    v_mfma_f32_16x16x32_bf16 v[172:175], v[204:207], a[112:115], v[172:175]
    ds_read_b128 a[240:243], v48 offset:61440
    v_mfma_f32_16x16x32_bf16 v[176:179], v[204:207], a[116:119], v[176:179]
    ds_read_b128 a[244:247], v48 offset:62464
    v_mfma_f32_16x16x32_bf16 v[180:183], v[204:207], a[120:123], v[180:183]
    ds_read_b128 a[248:251], v48 offset:63488
    v_mfma_f32_16x16x32_bf16 v[184:187], v[204:207], a[124:127], v[184:187]
    ds_read_b128 a[252:255], v48 offset:64512
    s_waitcnt lgkmcnt(12)
    v_mfma_f32_16x16x32_bf16 v[156:159], v[212:215], a[128:131], v[156:159]
    v_mfma_f32_16x16x32_bf16 v[160:163], v[212:215], a[132:135], v[160:163]
    buffer_load_dwordx4 v39, s[12:15], s78 offen offset:2048 lds
    ds_read_b64_tr_b16 v[200:201], v50 offset:16384
    v_mfma_f32_16x16x32_bf16 v[164:167], v[212:215], a[136:139], v[164:167]
    v_mfma_f32_16x16x32_bf16 v[168:171], v[212:215], a[140:143], v[168:171]
    ds_read_b64_tr_b16 v[202:203], v50 offset:20480
    v_mfma_f32_16x16x32_bf16 v[172:175], v[216:219], a[128:131], v[172:175]
    v_mfma_f32_16x16x32_bf16 v[176:179], v[216:219], a[132:135], v[176:179]
    ds_read_b64_tr_b16 v[204:205], v51 offset:16384
    v_mfma_f32_16x16x32_bf16 v[180:183], v[216:219], a[136:139], v[180:183]
    s_add_u32 m0, s83, 12288
    s_add_u32 s78, s78, 98304
    buffer_load_dwordx4 v39, s[12:15], s78 offen offset:0 lds
    v_mfma_f32_16x16x32_bf16 v[184:187], v[216:219], a[140:143], v[184:187]
    ds_read_b64_tr_b16 v[206:207], v51 offset:20480
    s_waitcnt lgkmcnt(8)
    v_mfma_f32_16x16x32_bf16 v[156:159], v[188:191], a[144:147], v[156:159]
    v_mfma_f32_16x16x32_bf16 v[160:163], v[188:191], a[148:151], v[160:163]
    ds_read_b64_tr_b16 v[212:213], v50 offset:24576
    v_mfma_f32_16x16x32_bf16 v[164:167], v[188:191], a[152:155], v[164:167]
    v_mfma_f32_16x16x32_bf16 v[168:171], v[188:191], a[156:159], v[168:171]
    buffer_load_dwordx4 v39, s[12:15], s78 offen offset:1024 lds
    ds_read_b64_tr_b16 v[214:215], v50 offset:28672
    v_mfma_f32_16x16x32_bf16 v[172:175], v[192:195], a[144:147], v[172:175]
    v_mfma_f32_16x16x32_bf16 v[176:179], v[192:195], a[148:151], v[176:179]
    ds_read_b64_tr_b16 v[216:217], v51 offset:24576
    v_mfma_f32_16x16x32_bf16 v[180:183], v[192:195], a[152:155], v[180:183]
    v_mfma_f32_16x16x32_bf16 v[184:187], v[192:195], a[156:159], v[184:187]
    ds_read_b64_tr_b16 v[218:219], v51 offset:28672
    s_waitcnt lgkmcnt(8)
    s_waitcnt vmcnt(5)
    s_barrier
    s_waitcnt lgkmcnt(4)
    v_mfma_f32_16x16x32_bf16 v[156:159], v[200:203], a[160:163], v[156:159]
    buffer_load_dwordx4 v39, s[12:15], s78 offen offset:2048 lds
    v_mfma_f32_16x16x32_bf16 v[160:163], v[200:203], a[164:167], v[160:163]
    s_add_u32 m0, s83, 131072
    s_add_u32 s78, s78, 98304
    buffer_load_dwordx4 v39, s[12:15], s78 offen offset:0 lds
    v_add_u32 v50, 98304, v44
    v_mfma_f32_16x16x32_bf16 v[164:167], v[200:203], a[168:171], v[164:167]
    v_add_u32 v51, 98304, v45
    v_mfma_f32_16x16x32_bf16 v[168:171], v[200:203], a[172:175], v[168:171]
    buffer_load_dwordx4 v39, s[12:15], s78 offen offset:1024 lds
    ds_read_b64_tr_b16 v[188:189], v50 offset:0
    v_mfma_f32_16x16x32_bf16 v[172:175], v[204:207], a[160:163], v[172:175]
    v_mfma_f32_16x16x32_bf16 v[176:179], v[204:207], a[164:167], v[176:179]
    ds_read_b64_tr_b16 v[190:191], v50 offset:4096
    v_mfma_f32_16x16x32_bf16 v[180:183], v[204:207], a[168:171], v[180:183]
    ds_read_b64_tr_b16 v[192:193], v51 offset:0
    v_mfma_f32_16x16x32_bf16 v[184:187], v[204:207], a[172:175], v[184:187]
    ds_read_b64_tr_b16 v[194:195], v51 offset:4096
    s_waitcnt lgkmcnt(4)
    v_mfma_f32_16x16x32_bf16 v[156:159], v[212:215], a[176:179], v[156:159]
    v_mfma_f32_16x16x32_bf16 v[160:163], v[212:215], a[180:183], v[160:163]
    buffer_load_dwordx4 v39, s[12:15], s78 offen offset:2048 lds
    ds_read_b64_tr_b16 v[200:201], v50 offset:8192
    v_mfma_f32_16x16x32_bf16 v[164:167], v[212:215], a[184:187], v[164:167]
    v_mfma_f32_16x16x32_bf16 v[168:171], v[212:215], a[188:191], v[168:171]
    ds_read_b64_tr_b16 v[202:203], v50 offset:12288
    v_mfma_f32_16x16x32_bf16 v[172:175], v[216:219], a[176:179], v[172:175]
    v_mfma_f32_16x16x32_bf16 v[176:179], v[216:219], a[180:183], v[176:179]
    ds_read_b64_tr_b16 v[204:205], v51 offset:8192
    v_mfma_f32_16x16x32_bf16 v[180:183], v[216:219], a[184:187], v[180:183]
    s_add_u32 m0, s83, 143360
    s_add_u32 s78, s78, 98304
    buffer_load_dwordx4 v39, s[12:15], s78 offen offset:0 lds
    v_mfma_f32_16x16x32_bf16 v[184:187], v[216:219], a[188:191], v[184:187]
    ds_read_b64_tr_b16 v[206:207], v51 offset:12288
    s_waitcnt lgkmcnt(4)
    v_mfma_f32_16x16x32_bf16 v[156:159], v[188:191], a[192:195], v[156:159]
    v_mfma_f32_16x16x32_bf16 v[160:163], v[188:191], a[196:199], v[160:163]
    ds_read_b64_tr_b16 v[212:213], v50 offset:16384
    v_mfma_f32_16x16x32_bf16 v[164:167], v[188:191], a[200:203], v[164:167]
    v_mfma_f32_16x16x32_bf16 v[168:171], v[188:191], a[204:207], v[168:171]
    buffer_load_dwordx4 v39, s[12:15], s78 offen offset:1024 lds
    ds_read_b64_tr_b16 v[214:215], v50 offset:20480
    v_mfma_f32_16x16x32_bf16 v[172:175], v[192:195], a[192:195], v[172:175]
    v_mfma_f32_16x16x32_bf16 v[176:179], v[192:195], a[196:199], v[176:179]
    ds_read_b64_tr_b16 v[216:217], v51 offset:16384
    v_mfma_f32_16x16x32_bf16 v[180:183], v[192:195], a[200:203], v[180:183]
    v_mfma_f32_16x16x32_bf16 v[184:187], v[192:195], a[204:207], v[184:187]
    ds_read_b64_tr_b16 v[218:219], v51 offset:20480
    s_waitcnt lgkmcnt(4)
    v_mfma_f32_16x16x32_bf16 v[156:159], v[200:203], a[208:211], v[156:159]
    buffer_load_dwordx4 v39, s[12:15], s78 offen offset:2048 lds
    v_mfma_f32_16x16x32_bf16 v[160:163], v[200:203], a[212:215], v[160:163]
    ds_read_b64_tr_b16 v[188:189], v50 offset:24576
    v_mfma_f32_16x16x32_bf16 v[164:167], v[200:203], a[216:219], v[164:167]
    v_mfma_f32_16x16x32_bf16 v[168:171], v[200:203], a[220:223], v[168:171]
    ds_read_b64_tr_b16 v[190:191], v50 offset:28672
    v_mfma_f32_16x16x32_bf16 v[172:175], v[204:207], a[208:211], v[172:175]
    v_mfma_f32_16x16x32_bf16 v[176:179], v[204:207], a[212:215], v[176:179]
    ds_read_b64_tr_b16 v[192:193], v51 offset:24576
    s_add_u32 s78, s71, 1
    s_and_b32 s78, s78, 3
    s_mul_i32 s78, s78, 393216
    s_add_u32 s78, s78, s77
    s_add_u32 m0, s83, 32768
    s_nop 0
    buffer_load_dwordx4 v39, s[12:15], s78 offen offset:0 lds
    v_mfma_f32_16x16x32_bf16 v[180:183], v[204:207], a[216:219], v[180:183]
    v_mfma_f32_16x16x32_bf16 v[184:187], v[204:207], a[220:223], v[184:187]
    ds_read_b64_tr_b16 v[194:195], v51 offset:28672
    s_waitcnt lgkmcnt(4)
    v_mfma_f32_16x16x32_bf16 v[156:159], v[212:215], a[224:227], v[156:159]
    v_mfma_f32_16x16x32_bf16 v[160:163], v[212:215], a[228:231], v[160:163]
    v_mfma_f32_16x16x32_bf16 v[164:167], v[212:215], a[232:235], v[164:167]
    buffer_load_dwordx4 v39, s[12:15], s78 offen offset:1024 lds
    v_mfma_f32_16x16x32_bf16 v[168:171], v[212:215], a[236:239], v[168:171]
    v_mfma_f32_16x16x32_bf16 v[172:175], v[216:219], a[224:227], v[172:175]
    v_mfma_f32_16x16x32_bf16 v[176:179], v[216:219], a[228:231], v[176:179]
    v_mfma_f32_16x16x32_bf16 v[180:183], v[216:219], a[232:235], v[180:183]
    v_mfma_f32_16x16x32_bf16 v[184:187], v[216:219], a[236:239], v[184:187]
    buffer_load_dwordx4 v39, s[12:15], s78 offen offset:2048 lds
    s_waitcnt lgkmcnt(0)
    v_mfma_f32_16x16x32_bf16 v[156:159], v[188:191], a[240:243], v[156:159]
    v_mfma_f32_16x16x32_bf16 v[160:163], v[188:191], a[244:247], v[160:163]
    v_mfma_f32_16x16x32_bf16 v[164:167], v[188:191], a[248:251], v[164:167]
    v_mfma_f32_16x16x32_bf16 v[168:171], v[188:191], a[252:255], v[168:171]
    v_mfma_f32_16x16x32_bf16 v[172:175], v[192:195], a[240:243], v[172:175]
    s_add_u32 m0, s83, 45056
    s_add_u32 s78, s78, 98304
    buffer_load_dwordx4 v39, s[12:15], s78 offen offset:0 lds
    v_mfma_f32_16x16x32_bf16 v[176:179], v[192:195], a[244:247], v[176:179]
    v_mfma_f32_16x16x32_bf16 v[180:183], v[192:195], a[248:251], v[180:183]
    v_mfma_f32_16x16x32_bf16 v[184:187], v[192:195], a[252:255], v[184:187]
    s_barrier
    s_cmp_eq_u32 s74, 1
    s_cbranch_scc1 L_rare_1
L_back_2:
    v_pk_mul_f32 v[240:241], v[156:157], v[156:157]
    v_pk_mul_f32 v[242:243], v[158:159], v[158:159]
    v_pk_mul_f32 v[244:245], v[160:161], v[160:161]
    v_pk_mul_f32 v[246:247], v[162:163], v[162:163]
    v_pk_mul_f32 v[248:249], v[164:165], v[164:165]
    buffer_load_dwordx4 v39, s[12:15], s78 offen offset:1024 lds
    v_pk_mul_f32 v[250:251], v[166:167], v[166:167]
    v_pk_mul_f32 v[252:253], v[168:169], v[168:169]
    v_pk_mul_f32 v[254:255], v[170:171], v[170:171]
    v_pk_fma_f32 v[240:241], v[240:241], v[52:53], v[52:53] op_sel:[0,0,1] op_sel_hi:[1,0,1]
    v_pk_fma_f32 v[242:243], v[242:243], v[52:53], v[52:53] op_sel:[0,0,1] op_sel_hi:[1,0,1]
    v_pk_fma_f32 v[244:245], v[244:245], v[52:53], v[52:53] op_sel:[0,0,1] op_sel_hi:[1,0,1]
    v_pk_fma_f32 v[246:247], v[246:247], v[52:53], v[52:53] op_sel:[0,0,1] op_sel_hi:[1,0,1]
    v_pk_fma_f32 v[248:249], v[248:249], v[52:53], v[52:53] op_sel:[0,0,1] op_sel_hi:[1,0,1]
    v_pk_fma_f32 v[250:251], v[250:251], v[52:53], v[52:53] op_sel:[0,0,1] op_sel_hi:[1,0,1]
    v_pk_fma_f32 v[252:253], v[252:253], v[52:53], v[52:53] op_sel:[0,0,1] op_sel_hi:[1,0,1]
    v_pk_fma_f32 v[254:255], v[254:255], v[52:53], v[52:53] op_sel:[0,0,1] op_sel_hi:[1,0,1]
    v_pk_mul_f32 v[240:241], v[240:241], v[156:157]
    v_pk_mul_f32 v[242:243], v[242:243], v[158:159]
    v_pk_mul_f32 v[244:245], v[244:245], v[160:161]
    v_pk_mul_f32 v[246:247], v[246:247], v[162:163]
    v_pk_mul_f32 v[248:249], v[248:249], v[164:165]
    v_pk_mul_f32 v[250:251], v[250:251], v[166:167]
    v_pk_mul_f32 v[252:253], v[252:253], v[168:169]
    v_pk_mul_f32 v[254:255], v[254:255], v[170:171]
    v_exp_f32 v240, v240
    buffer_load_dwordx4 v39, s[12:15], s78 offen offset:2048 lds
    v_exp_f32 v241, v241
    v_exp_f32 v242, v242
    v_exp_f32 v243, v243
    v_exp_f32 v244, v244
    v_exp_f32 v245, v245
    v_exp_f32 v246, v246
    v_exp_f32 v247, v247
    v_exp_f32 v248, v248
    v_exp_f32 v249, v249
    v_exp_f32 v250, v250
    s_add_u32 m0, s83, 65536
    s_add_u32 s78, s78, 98304
    buffer_load_dwordx4 v39, s[12:15], s78 offen offset:0 lds
    v_exp_f32 v251, v251
    v_exp_f32 v252, v252
    v_exp_f32 v253, v253
    v_exp_f32 v254, v254
    v_exp_f32 v255, v255
    v_pk_add_f32 v[240:241], v[240:241], 1.0 op_sel_hi:[1,0]
    v_pk_add_f32 v[242:243], v[242:243], 1.0 op_sel_hi:[1,0]
    v_pk_add_f32 v[244:245], v[244:245], 1.0 op_sel_hi:[1,0]
    v_pk_add_f32 v[246:247], v[246:247], 1.0 op_sel_hi:[1,0]
    v_pk_add_f32 v[248:249], v[248:249], 1.0 op_sel_hi:[1,0]
    v_pk_add_f32 v[250:251], v[250:251], 1.0 op_sel_hi:[1,0]
    v_pk_add_f32 v[252:253], v[252:253], 1.0 op_sel_hi:[1,0]
    v_pk_add_f32 v[254:255], v[254:255], 1.0 op_sel_hi:[1,0]
    buffer_load_dwordx4 v39, s[12:15], s78 offen offset:1024 lds
    v_rcp_f32 v240, v240
    v_rcp_f32 v241, v241
    v_rcp_f32 v242, v242
    v_rcp_f32 v243, v243
    v_rcp_f32 v244, v244
    v_rcp_f32 v245, v245
    v_rcp_f32 v246, v246
    v_rcp_f32 v247, v247
    v_rcp_f32 v248, v248
    v_rcp_f32 v249, v249
    buffer_load_dwordx4 v39, s[12:15], s78 offen offset:2048 lds
    v_rcp_f32 v250, v250
    v_rcp_f32 v251, v251
    v_rcp_f32 v252, v252
    v_rcp_f32 v253, v253
    v_rcp_f32 v254, v254
    v_rcp_f32 v255, v255
    v_pk_mul_f32 v[156:157], v[156:157], v[240:241]
    v_pk_mul_f32 v[158:159], v[158:159], v[242:243]
    v_pk_mul_f32 v[160:161], v[160:161], v[244:245]
    v_pk_mul_f32 v[162:163], v[162:163], v[246:247]
    v_pk_mul_f32 v[164:165], v[164:165], v[248:249]
    v_pk_mul_f32 v[166:167], v[166:167], v[250:251]
    v_pk_mul_f32 v[168:169], v[168:169], v[252:253]
    v_pk_mul_f32 v[170:171], v[170:171], v[254:255]
    s_add_u32 m0, s83, 77824
    s_add_u32 s78, s78, 98304
    buffer_load_dwordx4 v39, s[12:15], s78 offen offset:0 lds
    v_pk_mul_f32 v[240:241], v[172:173], v[172:173]
    v_pk_mul_f32 v[242:243], v[174:175], v[174:175]
    v_pk_mul_f32 v[244:245], v[176:177], v[176:177]
    v_pk_mul_f32 v[246:247], v[178:179], v[178:179]
    v_pk_mul_f32 v[248:249], v[180:181], v[180:181]
    v_pk_mul_f32 v[250:251], v[182:183], v[182:183]
    v_pk_mul_f32 v[252:253], v[184:185], v[184:185]
    v_pk_mul_f32 v[254:255], v[186:187], v[186:187]
    v_pk_fma_f32 v[240:241], v[240:241], v[52:53], v[52:53] op_sel:[0,0,1] op_sel_hi:[1,0,1]
    v_pk_fma_f32 v[242:243], v[242:243], v[52:53], v[52:53] op_sel:[0,0,1] op_sel_hi:[1,0,1]
    v_pk_fma_f32 v[244:245], v[244:245], v[52:53], v[52:53] op_sel:[0,0,1] op_sel_hi:[1,0,1]
    v_pk_fma_f32 v[246:247], v[246:247], v[52:53], v[52:53] op_sel:[0,0,1] op_sel_hi:[1,0,1]
    v_pk_fma_f32 v[248:249], v[248:249], v[52:53], v[52:53] op_sel:[0,0,1] op_sel_hi:[1,0,1]
    v_pk_fma_f32 v[250:251], v[250:251], v[52:53], v[52:53] op_sel:[0,0,1] op_sel_hi:[1,0,1]
    v_pk_fma_f32 v[252:253], v[252:253], v[52:53], v[52:53] op_sel:[0,0,1] op_sel_hi:[1,0,1]
    v_pk_fma_f32 v[254:255], v[254:255], v[52:53], v[52:53] op_sel:[0,0,1] op_sel_hi:[1,0,1]
    v_pk_mul_f32 v[240:241], v[240:241], v[172:173]
    v_pk_mul_f32 v[242:243], v[242:243], v[174:175]
    v_pk_mul_f32 v[244:245], v[244:245], v[176:177]
    buffer_load_dwordx4 v39, s[12:15], s78 offen offset:1024 lds
    v_pk_mul_f32 v[246:247], v[246:247], v[178:179]
    v_pk_mul_f32 v[248:249], v[248:249], v[180:181]
    v_pk_mul_f32 v[250:251], v[250:251], v[182:183]
    v_pk_mul_f32 v[252:253], v[252:253], v[184:185]
    v_pk_mul_f32 v[254:255], v[254:255], v[186:187]
    v_exp_f32 v240, v240
    v_exp_f32 v241, v241
    v_exp_f32 v242, v242
    v_exp_f32 v243, v243
    v_exp_f32 v244, v244
    v_exp_f32 v245, v245
    v_exp_f32 v246, v246
    v_exp_f32 v247, v247
    buffer_load_dwordx4 v39, s[12:15], s78 offen offset:2048 lds
    v_exp_f32 v248, v248
    v_exp_f32 v249, v249
    v_exp_f32 v250, v250
    v_exp_f32 v251, v251
    v_exp_f32 v252, v252
    v_exp_f32 v253, v253
    v_exp_f32 v254, v254
    v_exp_f32 v255, v255
    v_pk_add_f32 v[240:241], v[240:241], 1.0 op_sel_hi:[1,0]
    v_pk_add_f32 v[242:243], v[242:243], 1.0 op_sel_hi:[1,0]
    v_pk_add_f32 v[244:245], v[244:245], 1.0 op_sel_hi:[1,0]
    s_add_u32 s78, s71, 2
    s_and_b32 s78, s78, 3
    s_mul_i32 s78, s78, 393216
    s_add_u32 s78, s78, s77
    s_add_u32 m0, s83, 98304
    s_nop 0
    buffer_load_dwordx4 v39, s[12:15], s78 offen offset:0 lds
    v_pk_add_f32 v[246:247], v[246:247], 1.0 op_sel_hi:[1,0]
    v_pk_add_f32 v[248:249], v[248:249], 1.0 op_sel_hi:[1,0]
    v_pk_add_f32 v[250:251], v[250:251], 1.0 op_sel_hi:[1,0]
    v_pk_add_f32 v[252:253], v[252:253], 1.0 op_sel_hi:[1,0]
    v_pk_add_f32 v[254:255], v[254:255], 1.0 op_sel_hi:[1,0]
    v_rcp_f32 v240, v240
    v_rcp_f32 v241, v241
    v_rcp_f32 v242, v242
    v_rcp_f32 v243, v243
    v_rcp_f32 v244, v244
    buffer_load_dwordx4 v39, s[12:15], s78 offen offset:1024 lds
    v_rcp_f32 v245, v245
    v_rcp_f32 v246, v246
    v_rcp_f32 v247, v247
    v_rcp_f32 v248, v248
    v_rcp_f32 v249, v249
    v_rcp_f32 v250, v250
    v_rcp_f32 v251, v251
    v_rcp_f32 v252, v252
    v_rcp_f32 v253, v253
    v_rcp_f32 v254, v254
    v_rcp_f32 v255, v255
    buffer_load_dwordx4 v39, s[12:15], s78 offen offset:2048 lds
    v_pk_mul_f32 v[172:173], v[172:173], v[240:241]
    v_pk_mul_f32 v[174:175], v[174:175], v[242:243]
    v_pk_mul_f32 v[176:177], v[176:177], v[244:245]
    v_pk_mul_f32 v[178:179], v[178:179], v[246:247]
    v_pk_mul_f32 v[180:181], v[180:181], v[248:249]
    v_pk_mul_f32 v[182:183], v[182:183], v[250:251]
    v_pk_mul_f32 v[184:185], v[184:185], v[252:253]
    v_pk_mul_f32 v[186:187], v[186:187], v[254:255]
    v_pk_add_f32 v[224:225], v[156:157], v[158:159]
    v_pk_mul_f32 v[226:227], v[156:157], v[156:157]
    v_pk_add_f32 v[228:229], v[160:161], v[162:163]
    v_pk_mul_f32 v[230:231], v[160:161], v[160:161]
    v_pk_add_f32 v[232:233], v[164:165], v[166:167]
    v_pk_mul_f32 v[234:235], v[164:165], v[164:165]
    v_pk_add_f32 v[236:237], v[168:169], v[170:171]
    v_pk_mul_f32 v[238:239], v[168:169], v[168:169]
    v_pk_fma_f32 v[226:227], v[158:159], v[158:159], v[226:227]
    v_pk_fma_f32 v[230:231], v[162:163], v[162:163], v[230:231]
    v_pk_fma_f32 v[234:235], v[166:167], v[166:167], v[234:235]
    s_add_u32 m0, s83, 110592
    s_add_u32 s78, s78, 98304
    buffer_load_dwordx4 v39, s[12:15], s78 offen offset:0 lds
    v_pk_fma_f32 v[238:239], v[170:171], v[170:171], v[238:239]
    v_pk_add_f32 v[224:225], v[224:225], v[172:173]
    v_pk_fma_f32 v[226:227], v[172:173], v[172:173], v[226:227]
    v_pk_add_f32 v[228:229], v[228:229], v[176:177]
    v_pk_fma_f32 v[230:231], v[176:177], v[176:177], v[230:231]
    v_pk_add_f32 v[232:233], v[232:233], v[180:181]
    v_pk_fma_f32 v[234:235], v[180:181], v[180:181], v[234:235]
    v_pk_add_f32 v[236:237], v[236:237], v[184:185]
    v_pk_fma_f32 v[238:239], v[184:185], v[184:185], v[238:239]
    v_pk_add_f32 v[224:225], v[224:225], v[174:175]
    v_pk_fma_f32 v[226:227], v[174:175], v[174:175], v[226:227]
    v_pk_add_f32 v[228:229], v[228:229], v[178:179]
    v_pk_fma_f32 v[230:231], v[178:179], v[178:179], v[230:231]
    v_pk_add_f32 v[232:233], v[232:233], v[182:183]
    v_pk_fma_f32 v[234:235], v[182:183], v[182:183], v[234:235]
    v_pk_add_f32 v[236:237], v[236:237], v[186:187]
    v_pk_fma_f32 v[238:239], v[186:187], v[186:187], v[238:239]
    v_add_f32 v224, v224, v225
    buffer_load_dwordx4 v39, s[12:15], s78 offen offset:1024 lds
    v_add_f32 v226, v226, v227
    v_add_f32 v228, v228, v229
    v_add_f32 v230, v230, v231
    v_add_f32 v232, v232, v233
    v_add_f32 v234, v234, v235
    v_add_f32 v236, v236, v237
    v_add_f32 v238, v238, v239
    s_lshl_b32 s67, s3, 9
    s_add_u32 s67, s67, 161792
    v_lshl_add_u32 v2, v0, 3, s67
    v_permlane32_swap_b32 v224, v232
    v_permlane32_swap_b32 v228, v236
    v_add_f32 v224, v224, v232
    v_add_f32 v228, v228, v236
    s_nop 1
    v_permlane16_swap_b32 v224, v228
    v_add_f32 v224, v224, v228
    v_permlane32_swap_b32 v226, v234
    v_permlane32_swap_b32 v230, v238
    v_add_f32 v226, v226, v234
    v_add_f32 v230, v230, v238
    buffer_load_dwordx4 v39, s[12:15], s78 offen offset:2048 lds
    s_nop 0
    v_permlane16_swap_b32 v226, v230
    v_add_f32 v226, v226, v230
    v_mov_b32 v225, v226
    ds_write_b64 v2, v[224:225]
    s_waitcnt lgkmcnt(0)
    s_waitcnt vmcnt(18)
    s_barrier
    v_add_u32 v50, 0, v46
    s_lshr_b32 s69, s85, 8
    s_and_b32 s69, s69, 1
    s_xor_b32 s69, s69, 1
    s_lshl_b32 s69, s69, 11
    s_lshl_b32 s70, s85, 13
    s_add_u32 s69, s69, s70
    v_and_b32 v33, 1, v20
    v_lshlrev_b32 v33, 12, v33
    v_lshl_add_u32 v33, v1, 7, v33
    buffer_load_dword v22, v33, s[24:27], s69 offen
    ds_read_b64_tr_b16 v[200:201], v50 offset:0
    ds_read_b64_tr_b16 v[202:203], v50 offset:6144
    ds_read_b64_tr_b16 v[204:205], v50 offset:1024
    ds_read_b64_tr_b16 v[206:207], v50 offset:7168
    ds_read_b64_tr_b16 v[208:209], v50 offset:2048
    ds_read_b64_tr_b16 v[210:211], v50 offset:8192
    ds_read_b64_tr_b16 v[212:213], v50 offset:12288
    ds_read_b64_tr_b16 v[214:215], v50 offset:18432
    ds_read_b64_tr_b16 v[216:217], v50 offset:13312
    ds_read_b64_tr_b16 v[218:219], v50 offset:19456
    ds_read_b64_tr_b16 v[220:221], v50 offset:14336
    ds_read_b64_tr_b16 v[222:223], v50 offset:20480
    s_waitcnt lgkmcnt(6)
    v_mfma_f32_16x16x32_bf16 v[108:111], v[200:203], a[0:3], 0
    v_add_u32 v50, 131072, v46
    v_mfma_f32_16x16x32_bf16 v[112:115], v[200:203], a[4:7], 0
    v_lshlrev_b32 v2, 3, v0
    v_add_u32 v2, 161792, v2
    v_mfma_f32_16x16x32_bf16 v[116:119], v[200:203], a[8:11], 0
    ds_read_b64_tr_b16 v[188:189], v50 offset:0
    v_mfma_f32_16x16x32_bf16 v[120:123], v[200:203], a[12:15], 0
    ds_read_b64 v[56:57], v2 offset:0
    v_mfma_f32_16x16x32_bf16 v[124:127], v[204:207], a[0:3], 0
    ds_read_b64_tr_b16 v[190:191], v50 offset:6144
    v_mfma_f32_16x16x32_bf16 v[128:131], v[204:207], a[4:7], 0
    ds_read_b64 v[58:59], v2 offset:512
    ds_read_b64_tr_b16 v[192:193], v50 offset:1024
    v_mfma_f32_16x16x32_bf16 v[132:135], v[204:207], a[8:11], 0
    ds_read_b64 v[60:61], v2 offset:1024
    v_mfma_f32_16x16x32_bf16 v[136:139], v[204:207], a[12:15], 0
    ds_read_b64_tr_b16 v[194:195], v50 offset:7168
    v_mfma_f32_16x16x32_bf16 v[140:143], a[0:3], v[208:211], 0
    ds_read_b64 v[62:63], v2 offset:1536
    v_mfma_f32_16x16x32_bf16 v[144:147], a[4:7], v[208:211], 0
    ds_read_b64_tr_b16 v[196:197], v50 offset:2048
    v_mfma_f32_16x16x32_bf16 v[148:151], a[8:11], v[208:211], 0
    v_xor_b32 v3, s3, v20
    v_min_u32 v3, 1, v3
    v_mfma_f32_16x16x32_bf16 v[152:155], a[12:15], v[208:211], 0
    ds_read_b64_tr_b16 v[198:199], v50 offset:8192
    v_lshlrev_b32 v3, 30, v3
    v_or_b32 v3, v3, v21
    s_waitcnt lgkmcnt(10)
    v_mfma_f32_16x16x32_bf16 v[108:111], v[212:215], a[16:19], v[108:111]
    v_mfma_f32_16x16x32_bf16 v[112:115], v[212:215], a[20:23], v[112:115]
    ds_read_b64_tr_b16 v[200:201], v50 offset:12288
    v_mfma_f32_16x16x32_bf16 v[116:119], v[212:215], a[24:27], v[116:119]
    ds_read_b64_tr_b16 v[202:203], v50 offset:18432
    v_mfma_f32_16x16x32_bf16 v[120:123], v[212:215], a[28:31], v[120:123]
    s_waitcnt lgkmcnt(4)
    v_add_f32 v56, v56, v58
    v_add_f32 v57, v57, v59
    v_mfma_f32_16x16x32_bf16 v[124:127], v[216:219], a[16:19], v[124:127]
    ds_read_b64_tr_b16 v[204:205], v50 offset:13312
    v_mfma_f32_16x16x32_bf16 v[128:131], v[216:219], a[20:23], v[128:131]
    v_add_f32 v60, v60, v62
    v_add_f32 v61, v61, v63
    v_mfma_f32_16x16x32_bf16 v[132:135], v[216:219], a[24:27], v[132:135]
    ds_read_b64_tr_b16 v[206:207], v50 offset:19456
    v_mfma_f32_16x16x32_bf16 v[136:139], v[216:219], a[28:31], v[136:139]
    v_add_f32 v56, v56, v60
    v_add_f32 v58, v57, v61
    v_mfma_f32_16x16x32_bf16 v[140:143], a[16:19], v[220:223], v[140:143]
    ds_read_b64_tr_b16 v[208:209], v50 offset:14336
    v_mfma_f32_16x16x32_bf16 v[144:147], a[20:23], v[220:223], v[144:147]
    v_mov_b32 v59, s6
    v_mov_b32 v57, s6
    v_mfma_f32_16x16x32_bf16 v[148:151], a[24:27], v[220:223], v[148:151]
    ds_read_b64_tr_b16 v[210:211], v50 offset:20480
    v_mfma_f32_16x16x32_bf16 v[152:155], a[28:31], v[220:223], v[152:155]
    buffer_store_dwordx4 v[56:59], v3, s[40:43], s56 offen sc1
    s_waitcnt vmcnt(14)
    s_barrier
    s_waitcnt lgkmcnt(6)
    v_mfma_f32_16x16x32_bf16 v[108:111], v[188:191], a[32:35], v[108:111]
    s_add_u32 m0, s83, 0
    s_add_u32 s78, s78, 98304
    buffer_load_dwordx4 v39, s[12:15], s78 offen offset:0 lds
    v_mfma_f32_16x16x32_bf16 v[112:115], v[188:191], a[36:39], v[112:115]
    buffer_load_dwordx4 v39, s[12:15], s78 offen offset:1024 lds
    v_add_u32 v50, 32768, v46
    v_mfma_f32_16x16x32_bf16 v[116:119], v[188:191], a[40:43], v[116:119]
    v_mfma_f32_16x16x32_bf16 v[120:123], v[188:191], a[44:47], v[120:123]
    ds_read_b64_tr_b16 v[212:213], v50 offset:0
    v_mfma_f32_16x16x32_bf16 v[124:127], v[192:195], a[32:35], v[124:127]
    v_mfma_f32_16x16x32_bf16 v[128:131], v[192:195], a[36:39], v[128:131]
    buffer_load_dwordx4 v39, s[12:15], s78 offen offset:2048 lds
    ds_read_b64_tr_b16 v[214:215], v50 offset:6144
    v_mfma_f32_16x16x32_bf16 v[132:135], v[192:195], a[40:43], v[132:135]
    ds_read_b64_tr_b16 v[216:217], v50 offset:1024
    v_mfma_f32_16x16x32_bf16 v[136:139], v[192:195], a[44:47], v[136:139]
    v_mfma_f32_16x16x32_bf16 v[140:143], a[32:35], v[196:199], v[140:143]
    ds_read_b64_tr_b16 v[218:219], v50 offset:7168
    v_mfma_f32_16x16x32_bf16 v[144:147], a[36:39], v[196:199], v[144:147]
    v_mfma_f32_16x16x32_bf16 v[148:151], a[40:43], v[196:199], v[148:151]
    ds_read_b64_tr_b16 v[220:221], v50 offset:2048
    s_add_u32 m0, s83, 12288
    s_add_u32 s78, s78, 98304
    buffer_load_dwordx4 v39, s[12:15], s78 offen offset:0 lds
    v_mfma_f32_16x16x32_bf16 v[152:155], a[44:47], v[196:199], v[152:155]
    ds_read_b64_tr_b16 v[222:223], v50 offset:8192
    s_waitcnt lgkmcnt(6)
    v_mfma_f32_16x16x32_bf16 v[108:111], v[200:203], a[48:51], v[108:111]
    v_mfma_f32_16x16x32_bf16 v[112:115], v[200:203], a[52:55], v[112:115]
    ds_read_b64_tr_b16 v[188:189], v50 offset:12288
    v_mfma_f32_16x16x32_bf16 v[116:119], v[200:203], a[56:59], v[116:119]
    v_mfma_f32_16x16x32_bf16 v[120:123], v[200:203], a[60:63], v[120:123]
    buffer_load_dwordx4 v39, s[12:15], s78 offen offset:1024 lds
    ds_read_b64_tr_b16 v[190:191], v50 offset:18432
    v_mfma_f32_16x16x32_bf16 v[124:127], v[204:207], a[48:51], v[124:127]
    v_mfma_f32_16x16x32_bf16 v[128:131], v[204:207], a[52:55], v[128:131]
    ds_read_b64_tr_b16 v[192:193], v50 offset:13312
    v_mfma_f32_16x16x32_bf16 v[132:135], v[204:207], a[56:59], v[132:135]
    v_mfma_f32_16x16x32_bf16 v[136:139], v[204:207], a[60:63], v[136:139]
    ds_read_b64_tr_b16 v[194:195], v50 offset:19456
    v_mfma_f32_16x16x32_bf16 v[140:143], a[48:51], v[208:211], v[140:143]
    v_mfma_f32_16x16x32_bf16 v[144:147], a[52:55], v[208:211], v[144:147]
    buffer_load_dwordx4 v39, s[12:15], s78 offen offset:2048 lds
    ds_read_b64_tr_b16 v[196:197], v50 offset:14336
    v_mfma_f32_16x16x32_bf16 v[148:151], a[56:59], v[208:211], v[148:151]
    v_mfma_f32_16x16x32_bf16 v[152:155], a[60:63], v[208:211], v[152:155]
    ds_read_b64_tr_b16 v[198:199], v50 offset:20480
    s_waitcnt vmcnt(14)
    s_barrier
    s_waitcnt lgkmcnt(6)
    v_mfma_f32_16x16x32_bf16 v[108:111], v[212:215], a[64:67], v[108:111]
    v_mfma_f32_16x16x32_bf16 v[112:115], v[212:215], a[68:71], v[112:115]
    v_add_u32 v50, 65536, v46
    v_mfma_f32_16x16x32_bf16 v[116:119], v[212:215], a[72:75], v[116:119]
    v_mfma_f32_16x16x32_bf16 v[120:123], v[212:215], a[76:79], v[120:123]
    ds_read_b64_tr_b16 v[200:201], v50 offset:0
    v_mfma_f32_16x16x32_bf16 v[124:127], v[216:219], a[64:67], v[124:127]
    v_mfma_f32_16x16x32_bf16 v[128:131], v[216:219], a[68:71], v[128:131]
    ds_read_b64_tr_b16 v[202:203], v50 offset:6144
    v_mfma_f32_16x16x32_bf16 v[132:135], v[216:219], a[72:75], v[132:135]
    ds_read_b64_tr_b16 v[204:205], v50 offset:1024
    v_mfma_f32_16x16x32_bf16 v[136:139], v[216:219], a[76:79], v[136:139]
    v_mfma_f32_16x16x32_bf16 v[140:143], a[64:67], v[220:223], v[140:143]
    ds_read_b64_tr_b16 v[206:207], v50 offset:7168
    v_mfma_f32_16x16x32_bf16 v[144:147], a[68:71], v[220:223], v[144:147]
    v_mfma_f32_16x16x32_bf16 v[148:151], a[72:75], v[220:223], v[148:151]
    ds_read_b64_tr_b16 v[208:209], v50 offset:2048
    v_mfma_f32_16x16x32_bf16 v[152:155], a[76:79], v[220:223], v[152:155]
    ds_read_b64_tr_b16 v[210:211], v50 offset:8192
    s_waitcnt lgkmcnt(6)
    v_mfma_f32_16x16x32_bf16 v[108:111], v[188:191], a[80:83], v[108:111]
    v_mfma_f32_16x16x32_bf16 v[112:115], v[188:191], a[84:87], v[112:115]
    ds_read_b64_tr_b16 v[212:213], v50 offset:12288
    v_mfma_f32_16x16x32_bf16 v[116:119], v[188:191], a[88:91], v[116:119]
    v_mfma_f32_16x16x32_bf16 v[120:123], v[188:191], a[92:95], v[120:123]
    ds_read_b64_tr_b16 v[214:215], v50 offset:18432
    v_mfma_f32_16x16x32_bf16 v[124:127], v[192:195], a[80:83], v[124:127]
    v_mfma_f32_16x16x32_bf16 v[128:131], v[192:195], a[84:87], v[128:131]
    ds_read_b64_tr_b16 v[216:217], v50 offset:13312
    v_mfma_f32_16x16x32_bf16 v[132:135], v[192:195], a[88:91], v[132:135]
    v_mfma_f32_16x16x32_bf16 v[136:139], v[192:195], a[92:95], v[136:139]
    ds_read_b64_tr_b16 v[218:219], v50 offset:19456
    v_mfma_f32_16x16x32_bf16 v[140:143], a[80:83], v[196:199], v[140:143]
    v_mfma_f32_16x16x32_bf16 v[144:147], a[84:87], v[196:199], v[144:147]
    ds_read_b64_tr_b16 v[220:221], v50 offset:14336
    v_mfma_f32_16x16x32_bf16 v[148:151], a[88:91], v[196:199], v[148:151]
    v_mfma_f32_16x16x32_bf16 v[152:155], a[92:95], v[196:199], v[152:155]
    ds_read_b64_tr_b16 v[222:223], v50 offset:20480
    s_waitcnt vmcnt(8)
    s_barrier
    s_waitcnt lgkmcnt(6)
    v_mfma_f32_16x16x32_bf16 v[108:111], v[200:203], a[96:99], v[108:111]
    s_add_u32 s78, s71, 3
    s_and_b32 s78, s78, 3
    s_mul_i32 s78, s78, 393216
    s_add_u32 s78, s78, s77
    s_add_u32 m0, s83, 131072
    s_nop 0
    buffer_load_dwordx4 v39, s[12:15], s78 offen offset:0 lds
    v_mfma_f32_16x16x32_bf16 v[112:115], v[200:203], a[100:103], v[112:115]
    buffer_load_dwordx4 v39, s[12:15], s78 offen offset:1024 lds
    v_add_u32 v50, 98304, v46
    v_mfma_f32_16x16x32_bf16 v[116:119], v[200:203], a[104:107], v[116:119]
    v_mfma_f32_16x16x32_bf16 v[120:123], v[200:203], a[108:111], v[120:123]
    ds_read_b64_tr_b16 v[188:189], v50 offset:0
    v_mfma_f32_16x16x32_bf16 v[124:127], v[204:207], a[96:99], v[124:127]
    buffer_load_dwordx4 v39, s[12:15], s78 offen offset:2048 lds
    v_mfma_f32_16x16x32_bf16 v[128:131], v[204:207], a[100:103], v[128:131]
    ds_read_b64_tr_b16 v[190:191], v50 offset:6144
    v_mfma_f32_16x16x32_bf16 v[132:135], v[204:207], a[104:107], v[132:135]
    ds_read_b64_tr_b16 v[192:193], v50 offset:1024
    v_mfma_f32_16x16x32_bf16 v[136:139], v[204:207], a[108:111], v[136:139]
    v_mfma_f32_16x16x32_bf16 v[140:143], a[96:99], v[208:211], v[140:143]
    ds_read_b64_tr_b16 v[194:195], v50 offset:7168
    v_mfma_f32_16x16x32_bf16 v[144:147], a[100:103], v[208:211], v[144:147]
    s_add_u32 m0, s83, 143360
    s_add_u32 s78, s78, 98304
    buffer_load_dwordx4 v39, s[12:15], s78 offen offset:0 lds
    v_mfma_f32_16x16x32_bf16 v[148:151], a[104:107], v[208:211], v[148:151]
    ds_read_b64_tr_b16 v[196:197], v50 offset:2048
    v_mfma_f32_16x16x32_bf16 v[152:155], a[108:111], v[208:211], v[152:155]
    ds_read_b64_tr_b16 v[198:199], v50 offset:8192
    s_waitcnt lgkmcnt(6)
    v_mfma_f32_16x16x32_bf16 v[108:111], v[212:215], a[112:115], v[108:111]
    v_mfma_f32_16x16x32_bf16 v[112:115], v[212:215], a[116:119], v[112:115]
    ds_read_b64_tr_b16 v[200:201], v50 offset:12288
    v_mfma_f32_16x16x32_bf16 v[116:119], v[212:215], a[120:123], v[116:119]
    buffer_load_dwordx4 v39, s[12:15], s78 offen offset:1024 lds
    v_mfma_f32_16x16x32_bf16 v[120:123], v[212:215], a[124:127], v[120:123]
    ds_read_b64_tr_b16 v[202:203], v50 offset:18432
    v_mfma_f32_16x16x32_bf16 v[124:127], v[216:219], a[112:115], v[124:127]
    v_mfma_f32_16x16x32_bf16 v[128:131], v[216:219], a[116:119], v[128:131]
    ds_read_b64_tr_b16 v[204:205], v50 offset:13312
    v_mfma_f32_16x16x32_bf16 v[132:135], v[216:219], a[120:123], v[132:135]
    v_mfma_f32_16x16x32_bf16 v[136:139], v[216:219], a[124:127], v[136:139]
    ds_read_b64_tr_b16 v[206:207], v50 offset:19456
    v_mfma_f32_16x16x32_bf16 v[140:143], a[112:115], v[220:223], v[140:143]
    buffer_load_dwordx4 v39, s[12:15], s78 offen offset:2048 lds
    v_mfma_f32_16x16x32_bf16 v[144:147], a[116:119], v[220:223], v[144:147]
    ds_read_b64_tr_b16 v[208:209], v50 offset:14336
    v_mfma_f32_16x16x32_bf16 v[148:151], a[120:123], v[220:223], v[148:151]
    v_mfma_f32_16x16x32_bf16 v[152:155], a[124:127], v[220:223], v[152:155]
    ds_read_b64_tr_b16 v[210:211], v50 offset:20480
    s_waitcnt vmcnt(6)
    s_barrier
    s_waitcnt lgkmcnt(6)
    v_mfma_f32_16x16x32_bf16 v[108:111], v[188:191], a[128:131], v[108:111]
    s_add_u32 m0, s83, 32768
    s_add_u32 s78, s78, 98304
    buffer_load_dwordx4 v39, s[12:15], s78 offen offset:0 lds
    v_mfma_f32_16x16x32_bf16 v[112:115], v[188:191], a[132:135], v[112:115]
    buffer_load_dwordx4 v39, s[12:15], s78 offen offset:1024 lds
    v_add_u32 v50, 0, v46
    v_mfma_f32_16x16x32_bf16 v[116:119], v[188:191], a[136:139], v[116:119]
    v_mfma_f32_16x16x32_bf16 v[120:123], v[188:191], a[140:143], v[120:123]
    ds_read_b64_tr_b16 v[212:213], v50 offset:0
    v_mfma_f32_16x16x32_bf16 v[124:127], v[192:195], a[128:131], v[124:127]
    buffer_load_dwordx4 v39, s[12:15], s78 offen offset:2048 lds
    v_mfma_f32_16x16x32_bf16 v[128:131], v[192:195], a[132:135], v[128:131]
    ds_read_b64_tr_b16 v[214:215], v50 offset:6144
    v_mfma_f32_16x16x32_bf16 v[132:135], v[192:195], a[136:139], v[132:135]
    ds_read_b64_tr_b16 v[216:217], v50 offset:1024
    v_mfma_f32_16x16x32_bf16 v[136:139], v[192:195], a[140:143], v[136:139]
    v_mfma_f32_16x16x32_bf16 v[140:143], a[128:131], v[196:199], v[140:143]
    ds_read_b64_tr_b16 v[218:219], v50 offset:7168
    v_mfma_f32_16x16x32_bf16 v[144:147], a[132:135], v[196:199], v[144:147]
    s_add_u32 m0, s83, 45056
    s_add_u32 s78, s78, 98304
    buffer_load_dwordx4 v39, s[12:15], s78 offen offset:0 lds
    v_mfma_f32_16x16x32_bf16 v[148:151], a[136:139], v[196:199], v[148:151]
    ds_read_b64_tr_b16 v[220:221], v50 offset:2048
    v_mfma_f32_16x16x32_bf16 v[152:155], a[140:143], v[196:199], v[152:155]
    ds_read_b64_tr_b16 v[222:223], v50 offset:8192
    s_waitcnt lgkmcnt(6)
    v_mfma_f32_16x16x32_bf16 v[108:111], v[200:203], a[144:147], v[108:111]
    v_mfma_f32_16x16x32_bf16 v[112:115], v[200:203], a[148:151], v[112:115]
    ds_read_b64_tr_b16 v[188:189], v50 offset:12288
    v_mfma_f32_16x16x32_bf16 v[116:119], v[200:203], a[152:155], v[116:119]
    buffer_load_dwordx4 v39, s[12:15], s78 offen offset:1024 lds
    v_mfma_f32_16x16x32_bf16 v[120:123], v[200:203], a[156:159], v[120:123]
    ds_read_b64_tr_b16 v[190:191], v50 offset:18432
    v_mfma_f32_16x16x32_bf16 v[124:127], v[204:207], a[144:147], v[124:127]
    v_mfma_f32_16x16x32_bf16 v[128:131], v[204:207], a[148:151], v[128:131]
    ds_read_b64_tr_b16 v[192:193], v50 offset:13312
    v_mfma_f32_16x16x32_bf16 v[132:135], v[204:207], a[152:155], v[132:135]
    v_mfma_f32_16x16x32_bf16 v[136:139], v[204:207], a[156:159], v[136:139]
    ds_read_b64_tr_b16 v[194:195], v50 offset:19456
    v_mfma_f32_16x16x32_bf16 v[140:143], a[144:147], v[208:211], v[140:143]
    buffer_load_dwordx4 v39, s[12:15], s78 offen offset:2048 lds
    v_mfma_f32_16x16x32_bf16 v[144:147], a[148:151], v[208:211], v[144:147]
    ds_read_b64_tr_b16 v[196:197], v50 offset:14336
    v_mfma_f32_16x16x32_bf16 v[148:151], a[152:155], v[208:211], v[148:151]
    v_mfma_f32_16x16x32_bf16 v[152:155], a[156:159], v[208:211], v[152:155]
    ds_read_b64_tr_b16 v[198:199], v50 offset:20480
    s_waitcnt vmcnt(6)
    s_barrier
    s_waitcnt lgkmcnt(6)
    v_mfma_f32_16x16x32_bf16 v[108:111], v[212:215], a[160:163], v[108:111]
    s_sub_u32 s75, s75, 1792
    s_add_u32 s76, s71, 0
    s_and_b32 s76, s76, 3
    s_mul_i32 s76, s76, 458752
    s_add_u32 s76, s76, s75
    s_add_u32 m0, s82, 65536
    s_nop 0
    buffer_load_dwordx4 v40, s[20:23], s76 offen offset:0 lds
    v_mfma_f32_16x16x32_bf16 v[112:115], v[212:215], a[164:167], v[112:115]
    buffer_load_dwordx4 v41, s[20:23], s76 offen offset:1024 lds
    v_add_u32 v50, 131072, v46
    v_mfma_f32_16x16x32_bf16 v[116:119], v[212:215], a[168:171], v[116:119]
    v_mfma_f32_16x16x32_bf16 v[120:123], v[212:215], a[172:175], v[120:123]
    buffer_load_dwordx4 v42, s[20:23], s76 offen offset:2048 lds
    ds_read_b64_tr_b16 v[200:201], v50 offset:0
    v_mfma_f32_16x16x32_bf16 v[124:127], v[216:219], a[160:163], v[124:127]
    v_mfma_f32_16x16x32_bf16 v[128:131], v[216:219], a[164:167], v[128:131]
    ds_read_b64_tr_b16 v[202:203], v50 offset:6144
    v_mfma_f32_16x16x32_bf16 v[132:135], v[216:219], a[168:171], v[132:135]
    ds_read_b64_tr_b16 v[204:205], v50 offset:1024
    v_mfma_f32_16x16x32_bf16 v[136:139], v[216:219], a[172:175], v[136:139]
    v_mfma_f32_16x16x32_bf16 v[140:143], a[160:163], v[220:223], v[140:143]
    buffer_load_dwordx4 v43, s[20:23], s76 offen offset:3072 lds
    ds_read_b64_tr_b16 v[206:207], v50 offset:7168
    v_mfma_f32_16x16x32_bf16 v[144:147], a[164:167], v[220:223], v[144:147]
    v_mfma_f32_16x16x32_bf16 v[148:151], a[168:171], v[220:223], v[148:151]
    ds_read_b64_tr_b16 v[208:209], v50 offset:2048
    v_mfma_f32_16x16x32_bf16 v[152:155], a[172:175], v[220:223], v[152:155]
    ds_read_b64_tr_b16 v[210:211], v50 offset:8192
    s_waitcnt lgkmcnt(6)
    v_mfma_f32_16x16x32_bf16 v[108:111], v[188:191], a[176:179], v[108:111]
    v_mfma_f32_16x16x32_bf16 v[112:115], v[188:191], a[180:183], v[112:115]
    s_add_u32 m0, s82, 69632
    s_add_u32 s76, s76, 57344
    buffer_load_dwordx4 v40, s[20:23], s76 offen offset:0 lds
    ds_read_b64_tr_b16 v[212:213], v50 offset:12288
    v_mfma_f32_16x16x32_bf16 v[116:119], v[188:191], a[184:187], v[116:119]
    v_mfma_f32_16x16x32_bf16 v[120:123], v[188:191], a[188:191], v[120:123]
    ds_read_b64_tr_b16 v[214:215], v50 offset:18432
    v_mfma_f32_16x16x32_bf16 v[124:127], v[192:195], a[176:179], v[124:127]
    v_mfma_f32_16x16x32_bf16 v[128:131], v[192:195], a[180:183], v[128:131]
    ds_read_b64_tr_b16 v[216:217], v50 offset:13312
    v_mfma_f32_16x16x32_bf16 v[132:135], v[192:195], a[184:187], v[132:135]
    buffer_load_dwordx4 v41, s[20:23], s76 offen offset:1024 lds
    v_mfma_f32_16x16x32_bf16 v[136:139], v[192:195], a[188:191], v[136:139]
    ds_read_b64_tr_b16 v[218:219], v50 offset:19456
    v_mfma_f32_16x16x32_bf16 v[140:143], a[176:179], v[196:199], v[140:143]
    v_mfma_f32_16x16x32_bf16 v[144:147], a[180:183], v[196:199], v[144:147]
    ds_read_b64_tr_b16 v[220:221], v50 offset:14336
    v_mfma_f32_16x16x32_bf16 v[148:151], a[184:187], v[196:199], v[148:151]
    v_mfma_f32_16x16x32_bf16 v[152:155], a[188:191], v[196:199], v[152:155]
    buffer_load_dwordx4 v42, s[20:23], s76 offen offset:2048 lds
    ds_read_b64_tr_b16 v[222:223], v50 offset:20480
    s_waitcnt vmcnt(7)
    s_barrier
    s_waitcnt lgkmcnt(6)
    v_mfma_f32_16x16x32_bf16 v[108:111], v[200:203], a[192:195], v[108:111]
    buffer_load_dwordx4 v43, s[20:23], s76 offen offset:3072 lds
    v_mfma_f32_16x16x32_bf16 v[112:115], v[200:203], a[196:199], v[112:115]
    s_add_u32 s76, s71, 1
    s_and_b32 s76, s76, 3
    s_mul_i32 s76, s76, 458752
    s_add_u32 s76, s76, s75
    s_add_u32 m0, s82, 98304
    s_nop 0
    buffer_load_dwordx4 v40, s[20:23], s76 offen offset:0 lds
    v_add_u32 v50, 32768, v46
    v_mfma_f32_16x16x32_bf16 v[116:119], v[200:203], a[200:203], v[116:119]
    v_mfma_f32_16x16x32_bf16 v[120:123], v[200:203], a[204:207], v[120:123]
    buffer_load_dwordx4 v41, s[20:23], s76 offen offset:1024 lds
    ds_read_b64_tr_b16 v[188:189], v50 offset:0
    v_mfma_f32_16x16x32_bf16 v[124:127], v[204:207], a[192:195], v[124:127]
    v_mfma_f32_16x16x32_bf16 v[128:131], v[204:207], a[196:199], v[128:131]
    ds_read_b64_tr_b16 v[190:191], v50 offset:6144
    v_mfma_f32_16x16x32_bf16 v[132:135], v[204:207], a[200:203], v[132:135]
    ds_read_b64_tr_b16 v[192:193], v50 offset:1024
    v_mfma_f32_16x16x32_bf16 v[136:139], v[204:207], a[204:207], v[136:139]
    v_mfma_f32_16x16x32_bf16 v[140:143], a[192:195], v[208:211], v[140:143]
    buffer_load_dwordx4 v42, s[20:23], s76 offen offset:2048 lds
    ds_read_b64_tr_b16 v[194:195], v50 offset:7168
    v_mfma_f32_16x16x32_bf16 v[144:147], a[196:199], v[208:211], v[144:147]
    v_mfma_f32_16x16x32_bf16 v[148:151], a[200:203], v[208:211], v[148:151]
    ds_read_b64_tr_b16 v[196:197], v50 offset:2048
    v_mfma_f32_16x16x32_bf16 v[152:155], a[204:207], v[208:211], v[152:155]
    ds_read_b64_tr_b16 v[198:199], v50 offset:8192
    s_waitcnt lgkmcnt(6)
    v_mfma_f32_16x16x32_bf16 v[108:111], v[212:215], a[208:211], v[108:111]
    v_mfma_f32_16x16x32_bf16 v[112:115], v[212:215], a[212:215], v[112:115]
    ds_read_b64_tr_b16 v[200:201], v50 offset:12288
    v_mfma_f32_16x16x32_bf16 v[116:119], v[212:215], a[216:219], v[116:119]
    v_mfma_f32_16x16x32_bf16 v[120:123], v[212:215], a[220:223], v[120:123]
    ds_read_b64_tr_b16 v[202:203], v50 offset:18432
    v_mfma_f32_16x16x32_bf16 v[124:127], v[216:219], a[208:211], v[124:127]
    v_mfma_f32_16x16x32_bf16 v[128:131], v[216:219], a[212:215], v[128:131]
    buffer_load_dwordx4 v43, s[20:23], s76 offen offset:3072 lds
    ds_read_b64_tr_b16 v[204:205], v50 offset:13312
    v_mfma_f32_16x16x32_bf16 v[132:135], v[216:219], a[216:219], v[132:135]
    ds_read_b64_tr_b16 v[206:207], v50 offset:19456
    v_mfma_f32_16x16x32_bf16 v[136:139], v[216:219], a[220:223], v[136:139]
    v_mfma_f32_16x16x32_bf16 v[140:143], a[208:211], v[220:223], v[140:143]
    ds_read_b64_tr_b16 v[208:209], v50 offset:14336
    v_mfma_f32_16x16x32_bf16 v[144:147], a[212:215], v[220:223], v[144:147]
    v_mfma_f32_16x16x32_bf16 v[148:151], a[216:219], v[220:223], v[148:151]
    s_add_u32 m0, s82, 102400
    s_add_u32 s76, s76, 57344
    buffer_load_dwordx4 v40, s[20:23], s76 offen offset:0 lds
    ds_read_b64_tr_b16 v[210:211], v50 offset:20480
    v_mfma_f32_16x16x32_bf16 v[152:155], a[220:223], v[220:223], v[152:155]
    buffer_load_dwordx4 v[56:59], v38, s[40:43], s57 offen sc1
    buffer_load_dwordx4 v[60:63], v38, s[40:43], s58 offen sc1
    s_waitcnt lgkmcnt(6)
    v_mfma_f32_16x16x32_bf16 v[108:111], v[188:191], a[224:227], v[108:111]
    v_mfma_f32_16x16x32_bf16 v[112:115], v[188:191], a[228:231], v[112:115]
    v_mfma_f32_16x16x32_bf16 v[116:119], v[188:191], a[232:235], v[116:119]
    v_mfma_f32_16x16x32_bf16 v[120:123], v[188:191], a[236:239], v[120:123]
    v_mfma_f32_16x16x32_bf16 v[124:127], v[192:195], a[224:227], v[124:127]
    buffer_load_dwordx4 v41, s[20:23], s76 offen offset:1024 lds
    v_mfma_f32_16x16x32_bf16 v[128:131], v[192:195], a[228:231], v[128:131]
    v_mfma_f32_16x16x32_bf16 v[132:135], v[192:195], a[232:235], v[132:135]
    v_mfma_f32_16x16x32_bf16 v[136:139], v[192:195], a[236:239], v[136:139]
    v_mfma_f32_16x16x32_bf16 v[140:143], a[224:227], v[196:199], v[140:143]
    v_mfma_f32_16x16x32_bf16 v[144:147], a[228:231], v[196:199], v[144:147]
    buffer_load_dwordx4 v42, s[20:23], s76 offen offset:2048 lds
    v_mfma_f32_16x16x32_bf16 v[148:151], a[232:235], v[196:199], v[148:151]
    v_mfma_f32_16x16x32_bf16 v[152:155], a[236:239], v[196:199], v[152:155]
    s_waitcnt lgkmcnt(0)
    v_mfma_f32_16x16x32_bf16 v[108:111], v[200:203], a[240:243], v[108:111]
    v_mfma_f32_16x16x32_bf16 v[112:115], v[200:203], a[244:247], v[112:115]
    v_mfma_f32_16x16x32_bf16 v[116:119], v[200:203], a[248:251], v[116:119]
    buffer_load_dwordx4 v43, s[20:23], s76 offen offset:3072 lds
    v_mfma_f32_16x16x32_bf16 v[120:123], v[200:203], a[252:255], v[120:123]
    v_mfma_f32_16x16x32_bf16 v[124:127], v[204:207], a[240:243], v[124:127]
    v_mfma_f32_16x16x32_bf16 v[128:131], v[204:207], a[244:247], v[128:131]
    v_mfma_f32_16x16x32_bf16 v[132:135], v[204:207], a[248:251], v[132:135]
    v_mfma_f32_16x16x32_bf16 v[136:139], v[204:207], a[252:255], v[136:139]
    s_add_u32 s76, s71, 2
    s_and_b32 s76, s76, 3
    s_mul_i32 s76, s76, 458752
    s_add_u32 s76, s76, s75
    s_add_u32 m0, s82, 0
    s_nop 0
    buffer_load_dwordx4 v40, s[20:23], s76 offen offset:0 lds
    v_mfma_f32_16x16x32_bf16 v[140:143], a[240:243], v[208:211], v[140:143]
    v_mfma_f32_16x16x32_bf16 v[144:147], a[244:247], v[208:211], v[144:147]
    v_mfma_f32_16x16x32_bf16 v[148:151], a[248:251], v[208:211], v[148:151]
    v_mfma_f32_16x16x32_bf16 v[152:155], a[252:255], v[208:211], v[152:155]
    buffer_load_dwordx4 v41, s[20:23], s76 offen offset:1024 lds
    s_waitcnt vmcnt(5)
    v_xor_b32 v2, v57, v59
    buffer_load_dwordx4 v42, s[20:23], s76 offen offset:2048 lds
    v_xor_b32 v3, v61, v63
    buffer_load_dwordx4 v43, s[20:23], s76 offen offset:3072 lds
    v_xor_b32 v4, s6, v57
    v_xor_b32 v5, s6, v61
    v_or3_b32 v2, v2, v3, v4
    v_or_b32 v2, v2, v5
    v_cmp_ne_u32 vcc, 0, v2
    s_nop 0
    s_cmp_eq_u64 vcc, 0
    s_cbranch_scc0 L_rare_4
L_back_5:
    v_add_f32 v56, v56, v60
    s_add_u32 m0, s82, 4096
    s_add_u32 s76, s76, 57344
    buffer_load_dwordx4 v40, s[20:23], s76 offen offset:0 lds
    v_add_f32 v57, v58, v62
    s_lshl_b32 s67, s3, 7
    s_add_u32 s67, s67, 161792
    v_permlane32_swap_b32 v56, v57
    v_add_f32 v56, v56, v57
    v_mov_b32 v58, v56
    v_lshl_add_u32 v2, v1, 3, s67
    s_nop 0
    v_permlane16_swap_b32 v56, v58
    v_add_f32 v56, v56, v58
    v_mov_b32 v57, v56
    s_nop 1
    v_permlane32_swap_b32 v56, v57
    v_mul_f32 v56, 0x3a924925, v56
    v_mul_f32 v57, 0x3a924925, v57
    v_fma_f32 v57, -v56, v56, v57
    v_max_f32 v57, 0, v57
    v_add_f32 v57, 0x3727c5ac, v57
    v_rsq_f32 v60, v57
    buffer_load_dwordx4 v41, s[20:23], s76 offen offset:1024 lds
    v_mul_f32 v61, -1.0, v56
    v_mul_f32 v61, v61, v60
    ds_write_b64 v2, v[60:61]
    v_cvt_pk_bf16_f32 v92, v124, v125
    v_cvt_pk_bf16_f32 v93, v126, v127
    v_cvt_pk_bf16_f32 v94, v128, v129
    v_cvt_pk_bf16_f32 v95, v130, v131
    v_cvt_pk_bf16_f32 v100, v140, v141
    v_cvt_pk_bf16_f32 v101, v142, v143
    v_cvt_pk_bf16_f32 v102, v144, v145
    v_cvt_pk_bf16_f32 v103, v146, v147
    v_permlane16_swap_b32 v92, v94
    v_permlane16_swap_b32 v93, v95
    buffer_store_dwordx4 v[100:103], v49, s[40:43], s59 offen offset:1024 sc1
    buffer_store_dwordx4 v[92:95], v47, s[40:43], s59 offen offset:0 sc1
    v_cvt_pk_bf16_f32 v96, v132, v133
    v_cvt_pk_bf16_f32 v97, v134, v135
    v_cvt_pk_bf16_f32 v98, v136, v137
    v_cvt_pk_bf16_f32 v99, v138, v139
    v_cvt_pk_bf16_f32 v104, v148, v149
    v_cvt_pk_bf16_f32 v105, v150, v151
    v_cvt_pk_bf16_f32 v106, v152, v153
    v_cvt_pk_bf16_f32 v107, v154, v155
    v_permlane16_swap_b32 v96, v98
    v_permlane16_swap_b32 v97, v99
    buffer_store_dwordx4 v[104:107], v49, s[40:43], s59 offen offset:3072 sc1
    buffer_store_dwordx4 v[96:99], v47, s[40:43], s59 offen offset:2048 sc1
    v_mov_b32 v4, 0x3eb8aa3b
    v_pk_mul_f32 v[108:109], v[108:109], v[4:5] op_sel_hi:[1,0]
    v_pk_mul_f32 v[110:111], v[110:111], v[4:5] op_sel_hi:[1,0]
    v_pk_mul_f32 v[112:113], v[112:113], v[4:5] op_sel_hi:[1,0]
    v_pk_mul_f32 v[114:115], v[114:115], v[4:5] op_sel_hi:[1,0]
    v_pk_mul_f32 v[116:117], v[116:117], v[4:5] op_sel_hi:[1,0]
    v_pk_mul_f32 v[118:119], v[118:119], v[4:5] op_sel_hi:[1,0]
    v_pk_mul_f32 v[120:121], v[120:121], v[4:5] op_sel_hi:[1,0]
    v_pk_mul_f32 v[122:123], v[122:123], v[4:5] op_sel_hi:[1,0]
    v_cvt_pk_bf16_f32 v12, v108, v109
    v_cvt_pk_bf16_f32 v13, v110, v111
    v_cvt_pk_bf16_f32 v14, v112, v113
    v_cvt_pk_bf16_f32 v15, v114, v115
    v_cvt_pk_bf16_f32 v16, v116, v117
    v_cvt_pk_bf16_f32 v17, v118, v119
    v_cvt_pk_bf16_f32 v18, v120, v121
    v_cvt_pk_bf16_f32 v19, v122, v123
    v_permlane16_swap_b32 v12, v14
    v_permlane16_swap_b32 v13, v15
    v_permlane16_swap_b32 v16, v18
    v_permlane16_swap_b32 v17, v19
    s_waitcnt lgkmcnt(0)
    s_barrier
    v_lshlrev_b32 v2, 3, v1
    v_add_u32 v2, 161792, v2
    ds_read_b64 v[124:125], v2 offset:0
    ds_read_b64 v[126:127], v2 offset:128
    ds_read_b64 v[128:129], v2 offset:256
    ds_read_b64 v[130:131], v2 offset:384
    s_mul_i32 s56, s3, 4608
    s_add_u32 s56, s56, 131072
    v_mul_u32_u24 v3, 72, v1
    buffer_load_dwordx4 v42, s[20:23], s76 offen offset:2048 lds
    v_lshl_add_u32 v3, v20, 3, v3
    v_add_u32 v3, s56, v3
    v_and_b32 v4, 3, v36
    v_lshl_add_u32 v4, v20, 3, v4
    v_mul_u32_u24 v4, 72, v4
    v_lshl_add_u32 v4, v37, 3, v4
    v_add_u32 v4, s56, v4
    s_lshl_b32 s56, s4, 12
    s_add_u32 s56, s56, s60
    s_waitcnt lgkmcnt(2)
    v_pk_fma_f32 v[156:157], v[156:157], v[124:125], v[124:125] op_sel:[0,0,1] op_sel_hi:[1,0,1]
    v_pk_fma_f32 v[158:159], v[158:159], v[124:125], v[124:125] op_sel:[0,0,1] op_sel_hi:[1,0,1]
    v_pk_fma_f32 v[172:173], v[172:173], v[124:125], v[124:125] op_sel:[0,0,1] op_sel_hi:[1,0,1]
    v_pk_fma_f32 v[174:175], v[174:175], v[124:125], v[124:125] op_sel:[0,0,1] op_sel_hi:[1,0,1]
    v_pk_fma_f32 v[160:161], v[160:161], v[126:127], v[126:127] op_sel:[0,0,1] op_sel_hi:[1,0,1]
    v_pk_fma_f32 v[162:163], v[162:163], v[126:127], v[126:127] op_sel:[0,0,1] op_sel_hi:[1,0,1]
    v_pk_fma_f32 v[176:177], v[176:177], v[126:127], v[126:127] op_sel:[0,0,1] op_sel_hi:[1,0,1]
    v_pk_fma_f32 v[178:179], v[178:179], v[126:127], v[126:127] op_sel:[0,0,1] op_sel_hi:[1,0,1]
    buffer_load_dwordx4 v43, s[20:23], s76 offen offset:3072 lds
    v_cvt_pk_bf16_f32 v156, v156, v157
    v_cvt_pk_bf16_f32 v157, v158, v159
    ds_write_b64 v3, v[156:157] offset:0
    v_cvt_pk_bf16_f32 v172, v172, v173
    v_cvt_pk_bf16_f32 v173, v174, v175
    ds_write_b64 v3, v[172:173] offset:32
    v_cvt_pk_bf16_f32 v160, v160, v161
    v_cvt_pk_bf16_f32 v161, v162, v163
    ds_write_b64 v3, v[160:161] offset:1152
    v_cvt_pk_bf16_f32 v176, v176, v177
    v_cvt_pk_bf16_f32 v177, v178, v179
    ds_write_b64 v3, v[176:177] offset:1184
    ds_read_b64_tr_b16 v[140:141], v4 offset:0
    ds_read_b64_tr_b16 v[142:143], v4 offset:288
    ds_read_b64_tr_b16 v[144:145], v4 offset:32
    ds_read_b64_tr_b16 v[146:147], v4 offset:320
    s_waitcnt lgkmcnt(8)
    v_pk_fma_f32 v[164:165], v[164:165], v[128:129], v[128:129] op_sel:[0,0,1] op_sel_hi:[1,0,1]
    v_pk_fma_f32 v[166:167], v[166:167], v[128:129], v[128:129] op_sel:[0,0,1] op_sel_hi:[1,0,1]
    s_add_u32 s76, s71, 3
    s_and_b32 s76, s76, 3
    s_mul_i32 s76, s76, 458752
    s_add_u32 s76, s76, s75
    s_add_u32 m0, s82, 32768
    s_nop 0
    buffer_load_dwordx4 v40, s[20:23], s76 offen offset:0 lds
    v_pk_fma_f32 v[180:181], v[180:181], v[128:129], v[128:129] op_sel:[0,0,1] op_sel_hi:[1,0,1]
    v_pk_fma_f32 v[182:183], v[182:183], v[128:129], v[128:129] op_sel:[0,0,1] op_sel_hi:[1,0,1]
    v_pk_fma_f32 v[168:169], v[168:169], v[130:131], v[130:131] op_sel:[0,0,1] op_sel_hi:[1,0,1]
    v_pk_fma_f32 v[170:171], v[170:171], v[130:131], v[130:131] op_sel:[0,0,1] op_sel_hi:[1,0,1]
    v_pk_fma_f32 v[184:185], v[184:185], v[130:131], v[130:131] op_sel:[0,0,1] op_sel_hi:[1,0,1]
    v_pk_fma_f32 v[186:187], v[186:187], v[130:131], v[130:131] op_sel:[0,0,1] op_sel_hi:[1,0,1]
    v_cvt_pk_bf16_f32 v164, v164, v165
    v_cvt_pk_bf16_f32 v165, v166, v167
    ds_write_b64 v3, v[164:165] offset:2304
    v_cvt_pk_bf16_f32 v180, v180, v181
    v_cvt_pk_bf16_f32 v181, v182, v183
    ds_write_b64 v3, v[180:181] offset:2336
    v_cvt_pk_bf16_f32 v168, v168, v169
    v_cvt_pk_bf16_f32 v169, v170, v171
    ds_write_b64 v3, v[168:169] offset:3456
    v_cvt_pk_bf16_f32 v184, v184, v185
    v_cvt_pk_bf16_f32 v185, v186, v187
    ds_write_b64 v3, v[184:185] offset:3488
    ds_read_b64_tr_b16 v[148:149], v4 offset:2304
    ds_read_b64_tr_b16 v[150:151], v4 offset:2592
    ds_read_b64_tr_b16 v[152:153], v4 offset:2336
    ds_read_b64_tr_b16 v[154:155], v4 offset:2624
    v_add_u32 v50, 65536, v44
    v_add_u32 v51, 65536, v45
    ds_read_b64_tr_b16 v[212:213], v50 offset:0
    ds_read_b64_tr_b16 v[214:215], v50 offset:4096
    ds_read_b64_tr_b16 v[216:217], v51 offset:0
    ds_read_b64_tr_b16 v[218:219], v51 offset:4096
    ds_read_b64_tr_b16 v[188:189], v50 offset:8192
    ds_read_b64_tr_b16 v[190:191], v50 offset:12288
    ds_read_b64_tr_b16 v[192:193], v51 offset:8192
    ds_read_b64_tr_b16 v[194:195], v51 offset:12288
    s_waitcnt lgkmcnt(15)
    buffer_store_dwordx4 v[140:143], v31, s[40:43], s56 offen offset:0 sc1
    s_waitcnt lgkmcnt(15)
    buffer_store_dwordx4 v[144:147], v31, s[40:43], s56 offen offset:1024 sc1
    s_waitcnt lgkmcnt(10)
    buffer_store_dwordx4 v[148:151], v31, s[40:43], s56 offen offset:2048 sc1
    s_waitcnt lgkmcnt(8)
    buffer_store_dwordx4 v[152:155], v31, s[40:43], s56 offen offset:3072 sc1
    s_waitcnt lgkmcnt(4)
    v_mfma_f32_16x16x32_bf16 v[224:227], v[212:215], a[0:3], 0
    v_mfma_f32_16x16x32_bf16 v[228:231], v[212:215], a[4:7], 0
    ds_read_b64_tr_b16 v[200:201], v50 offset:16384
    v_mfma_f32_16x16x32_bf16 v[232:235], v[212:215], a[8:11], 0
    v_mfma_f32_16x16x32_bf16 v[236:239], v[212:215], a[12:15], 0
    ds_read_b64_tr_b16 v[202:203], v50 offset:20480
    v_mfma_f32_16x16x32_bf16 v[240:243], v[216:219], a[0:3], 0
    v_mfma_f32_16x16x32_bf16 v[244:247], v[216:219], a[4:7], 0
    ds_read_b64_tr_b16 v[204:205], v51 offset:16384
    v_mfma_f32_16x16x32_bf16 v[248:251], v[216:219], a[8:11], 0
    v_mfma_f32_16x16x32_bf16 v[252:255], v[216:219], a[12:15], 0
    ds_read_b64_tr_b16 v[206:207], v51 offset:20480
    s_waitcnt lgkmcnt(4)
    v_mfma_f32_16x16x32_bf16 v[224:227], v[188:191], a[16:19], v[224:227]
    v_mfma_f32_16x16x32_bf16 v[228:231], v[188:191], a[20:23], v[228:231]
    ds_read_b64_tr_b16 v[212:213], v50 offset:24576
    v_mfma_f32_16x16x32_bf16 v[232:235], v[188:191], a[24:27], v[232:235]
    buffer_load_dwordx4 v41, s[20:23], s76 offen offset:1024 lds
    v_mfma_f32_16x16x32_bf16 v[236:239], v[188:191], a[28:31], v[236:239]
    ds_read_b64_tr_b16 v[214:215], v50 offset:28672
    v_mfma_f32_16x16x32_bf16 v[240:243], v[192:195], a[16:19], v[240:243]
    v_mfma_f32_16x16x32_bf16 v[244:247], v[192:195], a[20:23], v[244:247]
    ds_read_b64_tr_b16 v[216:217], v51 offset:24576
    v_mfma_f32_16x16x32_bf16 v[248:251], v[192:195], a[24:27], v[248:251]
    v_mfma_f32_16x16x32_bf16 v[252:255], v[192:195], a[28:31], v[252:255]
    buffer_load_dwordx4 v42, s[20:23], s76 offen offset:2048 lds
    ds_read_b64_tr_b16 v[218:219], v51 offset:28672
    s_waitcnt vmcnt(19)
    s_barrier
    s_waitcnt lgkmcnt(4)
    v_mfma_f32_16x16x32_bf16 v[224:227], v[200:203], a[32:35], v[224:227]
    v_mfma_f32_16x16x32_bf16 v[228:231], v[200:203], a[36:39], v[228:231]
    buffer_load_dwordx4 v43, s[20:23], s76 offen offset:3072 lds
    v_add_u32 v50, 98304, v44
    v_mfma_f32_16x16x32_bf16 v[232:235], v[200:203], a[40:43], v[232:235]
    v_add_u32 v51, 98304, v45
    v_mfma_f32_16x16x32_bf16 v[236:239], v[200:203], a[44:47], v[236:239]
    ds_read_b64_tr_b16 v[188:189], v50 offset:0
    v_mfma_f32_16x16x32_bf16 v[240:243], v[204:207], a[32:35], v[240:243]
    v_mfma_f32_16x16x32_bf16 v[244:247], v[204:207], a[36:39], v[244:247]
    s_add_u32 m0, s82, 36864
    s_add_u32 s76, s76, 57344
    buffer_load_dwordx4 v40, s[20:23], s76 offen offset:0 lds
    ds_read_b64_tr_b16 v[190:191], v50 offset:4096
    v_mfma_f32_16x16x32_bf16 v[248:251], v[204:207], a[40:43], v[248:251]
    ds_read_b64_tr_b16 v[192:193], v51 offset:0
    v_mfma_f32_16x16x32_bf16 v[252:255], v[204:207], a[44:47], v[252:255]
    ds_read_b64_tr_b16 v[194:195], v51 offset:4096
    s_waitcnt lgkmcnt(4)
    v_mfma_f32_16x16x32_bf16 v[224:227], v[212:215], a[48:51], v[224:227]
    v_mfma_f32_16x16x32_bf16 v[228:231], v[212:215], a[52:55], v[228:231]
    ds_read_b64_tr_b16 v[200:201], v50 offset:8192
    v_mfma_f32_16x16x32_bf16 v[232:235], v[212:215], a[56:59], v[232:235]
    buffer_load_dwordx4 v41, s[20:23], s76 offen offset:1024 lds
    v_mfma_f32_16x16x32_bf16 v[236:239], v[212:215], a[60:63], v[236:239]
    ds_read_b64_tr_b16 v[202:203], v50 offset:12288
    v_mfma_f32_16x16x32_bf16 v[240:243], v[216:219], a[48:51], v[240:243]
    v_mfma_f32_16x16x32_bf16 v[244:247], v[216:219], a[52:55], v[244:247]
    ds_read_b64_tr_b16 v[204:205], v51 offset:8192
    v_mfma_f32_16x16x32_bf16 v[248:251], v[216:219], a[56:59], v[248:251]
    v_mfma_f32_16x16x32_bf16 v[252:255], v[216:219], a[60:63], v[252:255]
    buffer_load_dwordx4 v42, s[20:23], s76 offen offset:2048 lds
    ds_read_b64_tr_b16 v[206:207], v51 offset:12288
    s_waitcnt lgkmcnt(4)
    v_mfma_f32_16x16x32_bf16 v[224:227], v[188:191], a[64:67], v[224:227]
    v_mfma_f32_16x16x32_bf16 v[228:231], v[188:191], a[68:71], v[228:231]
    ds_read_b64_tr_b16 v[212:213], v50 offset:16384
    v_mfma_f32_16x16x32_bf16 v[232:235], v[188:191], a[72:75], v[232:235]
    v_mfma_f32_16x16x32_bf16 v[236:239], v[188:191], a[76:79], v[236:239]
    ds_read_b64_tr_b16 v[214:215], v50 offset:20480
    buffer_load_dwordx4 v43, s[20:23], s76 offen offset:3072 lds
    v_mfma_f32_16x16x32_bf16 v[240:243], v[192:195], a[64:67], v[240:243]
    v_mfma_f32_16x16x32_bf16 v[244:247], v[192:195], a[68:71], v[244:247]
    ds_read_b64_tr_b16 v[216:217], v51 offset:16384
    v_mfma_f32_16x16x32_bf16 v[248:251], v[192:195], a[72:75], v[248:251]
    v_mfma_f32_16x16x32_bf16 v[252:255], v[192:195], a[76:79], v[252:255]
    ds_read_b64_tr_b16 v[218:219], v51 offset:20480
    s_waitcnt lgkmcnt(4)
    v_mfma_f32_16x16x32_bf16 v[224:227], v[200:203], a[80:83], v[224:227]
    s_waitcnt vmcnt(14)
    s_add_u32 s69, s52, 589824
    buffer_store_dword v29, v30, s[40:43], s69 offen sc1
    v_mfma_f32_16x16x32_bf16 v[228:231], v[200:203], a[84:87], v[228:231]
    ds_read_b64_tr_b16 v[188:189], v50 offset:24576
    v_mfma_f32_16x16x32_bf16 v[232:235], v[200:203], a[88:91], v[232:235]
    v_mfma_f32_16x16x32_bf16 v[236:239], v[200:203], a[92:95], v[236:239]
    ds_read_b64_tr_b16 v[190:191], v50 offset:28672
    v_mfma_f32_16x16x32_bf16 v[240:243], v[204:207], a[80:83], v[240:243]
    s_add_u32 m0, s81, 131072
    s_add_u32 s80, s79, 0
    buffer_load_dwordx4 v10, s[24:27], s80 offen offset:0 lds
    v_mfma_f32_16x16x32_bf16 v[244:247], v[204:207], a[84:87], v[244:247]
    ds_read_b64_tr_b16 v[192:193], v51 offset:24576
    v_mfma_f32_16x16x32_bf16 v[248:251], v[204:207], a[88:91], v[248:251]
    v_mfma_f32_16x16x32_bf16 v[252:255], v[204:207], a[92:95], v[252:255]
    ds_read_b64_tr_b16 v[194:195], v51 offset:28672
    s_waitcnt vmcnt(14)
    s_barrier
    s_waitcnt lgkmcnt(4)
    v_mfma_f32_16x16x32_bf16 v[224:227], v[212:215], a[96:99], v[224:227]
    buffer_load_dwordx4 v11, s[24:27], s80 offen offset:1024 lds
    v_mfma_f32_16x16x32_bf16 v[228:231], v[212:215], a[100:103], v[228:231]
    v_add_u32 v50, 0, v44
    v_mfma_f32_16x16x32_bf16 v[232:235], v[212:215], a[104:107], v[232:235]
    v_add_u32 v51, 0, v45
    v_mfma_f32_16x16x32_bf16 v[236:239], v[212:215], a[108:111], v[236:239]
    ds_read_b64_tr_b16 v[200:201], v50 offset:0
    v_mfma_f32_16x16x32_bf16 v[240:243], v[216:219], a[96:99], v[240:243]
    s_add_u32 m0, s81, 139264
    s_add_u32 s80, s79, 1024
    buffer_load_dwordx4 v10, s[24:27], s80 offen offset:0 lds
    v_mfma_f32_16x16x32_bf16 v[244:247], v[216:219], a[100:103], v[244:247]
    ds_read_b64_tr_b16 v[202:203], v50 offset:4096
    v_mfma_f32_16x16x32_bf16 v[248:251], v[216:219], a[104:107], v[248:251]
    ds_read_b64_tr_b16 v[204:205], v51 offset:0
    v_mfma_f32_16x16x32_bf16 v[252:255], v[216:219], a[108:111], v[252:255]
    ds_read_b64_tr_b16 v[206:207], v51 offset:4096
    s_waitcnt lgkmcnt(4)
    v_mfma_f32_16x16x32_bf16 v[224:227], v[188:191], a[112:115], v[224:227]
    v_mfma_f32_16x16x32_bf16 v[228:231], v[188:191], a[116:119], v[228:231]
    buffer_load_dwordx4 v11, s[24:27], s80 offen offset:1024 lds
    ds_read_b64_tr_b16 v[212:213], v50 offset:8192
    v_mfma_f32_16x16x32_bf16 v[232:235], v[188:191], a[120:123], v[232:235]
    v_mfma_f32_16x16x32_bf16 v[236:239], v[188:191], a[124:127], v[236:239]
    ds_read_b64_tr_b16 v[214:215], v50 offset:12288
    v_mfma_f32_16x16x32_bf16 v[240:243], v[192:195], a[112:115], v[240:243]
    v_mfma_f32_16x16x32_bf16 v[244:247], v[192:195], a[116:119], v[244:247]
    ds_read_b64_tr_b16 v[216:217], v51 offset:8192
    v_mfma_f32_16x16x32_bf16 v[248:251], v[192:195], a[120:123], v[248:251]
    s_add_u32 m0, s81, 147456
    s_add_u32 s80, s79, 128
    buffer_load_dwordx4 v10, s[24:27], s80 offen offset:0 lds
    v_mfma_f32_16x16x32_bf16 v[252:255], v[192:195], a[124:127], v[252:255]
    ds_read_b64_tr_b16 v[218:219], v51 offset:12288
    s_waitcnt lgkmcnt(4)
    v_mfma_f32_16x16x32_bf16 v[224:227], v[200:203], a[128:131], v[224:227]
    v_mfma_f32_16x16x32_bf16 v[228:231], v[200:203], a[132:135], v[228:231]
    ds_read_b64_tr_b16 v[188:189], v50 offset:16384
    v_mfma_f32_16x16x32_bf16 v[232:235], v[200:203], a[136:139], v[232:235]
    v_mfma_f32_16x16x32_bf16 v[236:239], v[200:203], a[140:143], v[236:239]
    buffer_load_dwordx4 v11, s[24:27], s80 offen offset:1024 lds
    ds_read_b64_tr_b16 v[190:191], v50 offset:20480
    v_mfma_f32_16x16x32_bf16 v[240:243], v[204:207], a[128:131], v[240:243]
    v_mfma_f32_16x16x32_bf16 v[244:247], v[204:207], a[132:135], v[244:247]
    ds_read_b64_tr_b16 v[192:193], v51 offset:16384
    v_mfma_f32_16x16x32_bf16 v[248:251], v[204:207], a[136:139], v[248:251]
    v_mfma_f32_16x16x32_bf16 v[252:255], v[204:207], a[140:143], v[252:255]
    ds_read_b64_tr_b16 v[194:195], v51 offset:20480
    s_waitcnt lgkmcnt(4)
    v_mfma_f32_16x16x32_bf16 v[224:227], v[212:215], a[144:147], v[224:227]
    s_add_u32 m0, s81, 155648
    s_add_u32 s80, s79, 1152
    buffer_load_dwordx4 v10, s[24:27], s80 offen offset:0 lds
    v_mfma_f32_16x16x32_bf16 v[228:231], v[212:215], a[148:151], v[228:231]
    ds_read_b64_tr_b16 v[200:201], v50 offset:24576
    v_mfma_f32_16x16x32_bf16 v[232:235], v[212:215], a[152:155], v[232:235]
    v_mfma_f32_16x16x32_bf16 v[236:239], v[212:215], a[156:159], v[236:239]
    ds_read_b64_tr_b16 v[202:203], v50 offset:28672
    v_mfma_f32_16x16x32_bf16 v[240:243], v[216:219], a[144:147], v[240:243]
    v_mfma_f32_16x16x32_bf16 v[244:247], v[216:219], a[148:151], v[244:247]
    buffer_load_dwordx4 v11, s[24:27], s80 offen offset:1024 lds
    ds_read_b64_tr_b16 v[204:205], v51 offset:24576
    v_mfma_f32_16x16x32_bf16 v[248:251], v[216:219], a[152:155], v[248:251]
    v_mfma_f32_16x16x32_bf16 v[252:255], v[216:219], a[156:159], v[252:255]
    ds_read_b64_tr_b16 v[206:207], v51 offset:28672
    s_waitcnt vmcnt(9)
    s_barrier
    s_waitcnt lgkmcnt(4)
    v_mfma_f32_16x16x32_bf16 v[224:227], v[188:191], a[160:163], v[224:227]
    s_add_u32 m0, s81, 65536
    s_add_u32 s80, s79, 256
    buffer_load_dwordx4 v10, s[24:27], s80 offen offset:0 lds
    v_mfma_f32_16x16x32_bf16 v[228:231], v[188:191], a[164:167], v[228:231]
    buffer_load_dwordx4 v11, s[24:27], s80 offen offset:1024 lds
    v_add_u32 v50, 32768, v44
    v_mfma_f32_16x16x32_bf16 v[232:235], v[188:191], a[168:171], v[232:235]
    v_add_u32 v51, 32768, v45
    v_mfma_f32_16x16x32_bf16 v[236:239], v[188:191], a[172:175], v[236:239]
    ds_read_b64_tr_b16 v[212:213], v50 offset:0
    v_mfma_f32_16x16x32_bf16 v[240:243], v[192:195], a[160:163], v[240:243]
    v_mfma_f32_16x16x32_bf16 v[244:247], v[192:195], a[164:167], v[244:247]
    ds_read_b64_tr_b16 v[214:215], v50 offset:4096
    v_mfma_f32_16x16x32_bf16 v[248:251], v[192:195], a[168:171], v[248:251]
    ds_read_b64_tr_b16 v[216:217], v51 offset:0
    v_mfma_f32_16x16x32_bf16 v[252:255], v[192:195], a[172:175], v[252:255]
    ds_read_b64_tr_b16 v[218:219], v51 offset:4096
    s_waitcnt lgkmcnt(4)
    v_mfma_f32_16x16x32_bf16 v[224:227], v[200:203], a[176:179], v[224:227]
    s_add_u32 m0, s81, 73728
    s_add_u32 s80, s79, 1280
    buffer_load_dwordx4 v10, s[24:27], s80 offen offset:0 lds
    v_mfma_f32_16x16x32_bf16 v[228:231], v[200:203], a[180:183], v[228:231]
    ds_read_b64_tr_b16 v[188:189], v50 offset:8192
    v_mfma_f32_16x16x32_bf16 v[232:235], v[200:203], a[184:187], v[232:235]
    v_mfma_f32_16x16x32_bf16 v[236:239], v[200:203], a[188:191], v[236:239]
    ds_read_b64_tr_b16 v[190:191], v50 offset:12288
    v_mfma_f32_16x16x32_bf16 v[240:243], v[204:207], a[176:179], v[240:243]
    v_mfma_f32_16x16x32_bf16 v[244:247], v[204:207], a[180:183], v[244:247]
    ds_read_b64_tr_b16 v[192:193], v51 offset:8192
    buffer_load_dwordx4 v11, s[24:27], s80 offen offset:1024 lds
    v_mfma_f32_16x16x32_bf16 v[248:251], v[204:207], a[184:187], v[248:251]
    v_mfma_f32_16x16x32_bf16 v[252:255], v[204:207], a[188:191], v[252:255]
    ds_read_b64_tr_b16 v[194:195], v51 offset:12288
    s_waitcnt lgkmcnt(4)
    v_mfma_f32_16x16x32_bf16 v[224:227], v[212:215], a[192:195], v[224:227]
    v_mfma_f32_16x16x32_bf16 v[228:231], v[212:215], a[196:199], v[228:231]
    ds_read_b64_tr_b16 v[200:201], v50 offset:16384
    v_mfma_f32_16x16x32_bf16 v[232:235], v[212:215], a[200:203], v[232:235]
    v_mfma_f32_16x16x32_bf16 v[236:239], v[212:215], a[204:207], v[236:239]
    s_add_u32 m0, s81, 81920
    s_add_u32 s80, s79, 384
    buffer_load_dwordx4 v10, s[24:27], s80 offen offset:0 lds
    ds_read_b64_tr_b16 v[202:203], v50 offset:20480
    v_mfma_f32_16x16x32_bf16 v[240:243], v[216:219], a[192:195], v[240:243]
    v_mfma_f32_16x16x32_bf16 v[244:247], v[216:219], a[196:199], v[244:247]
    ds_read_b64_tr_b16 v[204:205], v51 offset:16384
    v_mfma_f32_16x16x32_bf16 v[248:251], v[216:219], a[200:203], v[248:251]
    v_mfma_f32_16x16x32_bf16 v[252:255], v[216:219], a[204:207], v[252:255]
    ds_read_b64_tr_b16 v[206:207], v51 offset:20480
    s_waitcnt lgkmcnt(4)
    v_mfma_f32_16x16x32_bf16 v[224:227], v[188:191], a[208:211], v[224:227]
    buffer_load_dwordx4 v11, s[24:27], s80 offen offset:1024 lds
    v_mfma_f32_16x16x32_bf16 v[228:231], v[188:191], a[212:215], v[228:231]
    ds_read_b64_tr_b16 v[212:213], v50 offset:24576
    v_mfma_f32_16x16x32_bf16 v[232:235], v[188:191], a[216:219], v[232:235]
    v_mfma_f32_16x16x32_bf16 v[236:239], v[188:191], a[220:223], v[236:239]
    ds_read_b64_tr_b16 v[214:215], v50 offset:28672
    v_mfma_f32_16x16x32_bf16 v[240:243], v[192:195], a[208:211], v[240:243]
    v_mfma_f32_16x16x32_bf16 v[244:247], v[192:195], a[212:215], v[244:247]
    ds_read_b64_tr_b16 v[216:217], v51 offset:24576
    s_add_u32 m0, s81, 90112
    s_add_u32 s80, s79, 1408
    buffer_load_dwordx4 v10, s[24:27], s80 offen offset:0 lds
    v_mfma_f32_16x16x32_bf16 v[248:251], v[192:195], a[216:219], v[248:251]
    v_mfma_f32_16x16x32_bf16 v[252:255], v[192:195], a[220:223], v[252:255]
    ds_read_b64_tr_b16 v[218:219], v51 offset:28672
    s_barrier
    s_waitcnt lgkmcnt(4)
    v_mfma_f32_16x16x32_bf16 v[224:227], v[200:203], a[224:227], v[224:227]
    v_mfma_f32_16x16x32_bf16 v[228:231], v[200:203], a[228:231], v[228:231]
    buffer_load_dwordx4 v11, s[24:27], s80 offen offset:1024 lds
    v_mfma_f32_16x16x32_bf16 v[232:235], v[200:203], a[232:235], v[232:235]
    v_mfma_f32_16x16x32_bf16 v[236:239], v[200:203], a[236:239], v[236:239]
    v_mfma_f32_16x16x32_bf16 v[240:243], v[204:207], a[224:227], v[240:243]
    v_mfma_f32_16x16x32_bf16 v[244:247], v[204:207], a[228:231], v[244:247]
    v_mfma_f32_16x16x32_bf16 v[248:251], v[204:207], a[232:235], v[248:251]
    v_mfma_f32_16x16x32_bf16 v[252:255], v[204:207], a[236:239], v[252:255]
    s_add_u32 m0, s81, 98304
    s_add_u32 s80, s79, 512
    buffer_load_dwordx4 v10, s[24:27], s80 offen offset:0 lds
    buffer_load_dword v27, v28, s[40:43], s86 offen sc1
    s_waitcnt lgkmcnt(0)
    v_mfma_f32_16x16x32_bf16 v[224:227], v[212:215], a[240:243], v[224:227]
    v_mfma_f32_16x16x32_bf16 v[228:231], v[212:215], a[244:247], v[228:231]
    v_mfma_f32_16x16x32_bf16 v[232:235], v[212:215], a[248:251], v[232:235]
    v_mfma_f32_16x16x32_bf16 v[236:239], v[212:215], a[252:255], v[236:239]
    v_mfma_f32_16x16x32_bf16 v[240:243], v[216:219], a[240:243], v[240:243]
    v_mfma_f32_16x16x32_bf16 v[244:247], v[216:219], a[244:247], v[244:247]
    buffer_load_dwordx4 v11, s[24:27], s80 offen offset:1024 lds
    v_mfma_f32_16x16x32_bf16 v[248:251], v[216:219], a[248:251], v[248:251]
    v_mfma_f32_16x16x32_bf16 v[252:255], v[216:219], a[252:255], v[252:255]
    s_barrier
    s_lshl_b32 s67, s4, 1
    s_sub_i32 s56, 8, s67
    s_max_i32 s56, s56, 0
    s_add_i32 s88, s59, -16384
    s_cmp_gt_u32 s56, 0
    s_cselect_b32 s88, 1073741824, s88
    s_add_i32 s89, s59, -14336
    s_cmp_gt_u32 s56, 1
    s_cselect_b32 s89, 1073741824, s89
    s_add_i32 s90, s59, -12288
    s_cmp_gt_u32 s56, 2
    s_cselect_b32 s90, 1073741824, s90
    s_add_i32 s91, s59, -10240
    s_cmp_gt_u32 s56, 3
    s_cselect_b32 s91, 1073741824, s91
    s_add_i32 s92, s59, -8192
    s_cmp_gt_u32 s56, 4
    s_cselect_b32 s92, 1073741824, s92
    s_add_i32 s93, s59, -6144
    s_cmp_gt_u32 s56, 5
    s_cselect_b32 s93, 1073741824, s93
    s_add_i32 s94, s59, -4096
    s_cmp_gt_u32 s56, 6
    s_cselect_b32 s94, 1073741824, s94
    s_add_i32 s95, s59, -2048
    s_cmp_gt_u32 s56, 7
    s_cselect_b32 s95, 1073741824, s95
    s_add_i32 s96, s59, 0
    s_add_i32 s97, s59, 2048
    v_pk_mul_f32 v[208:209], v[224:225], v[224:225]
    s_add_u32 m0, s81, 106496
    s_add_u32 s80, s79, 1536
    buffer_load_dwordx4 v10, s[24:27], s80 offen offset:0 lds
    v_pk_mul_f32 v[210:211], v[226:227], v[226:227]
    buffer_load_dwordx4 v11, s[24:27], s80 offen offset:1024 lds
    v_pk_mul_f32 v[212:213], v[228:229], v[228:229]
    v_pk_mul_f32 v[214:215], v[230:231], v[230:231]
    v_pk_mul_f32 v[216:217], v[232:233], v[232:233]
    v_pk_mul_f32 v[218:219], v[234:235], v[234:235]
    v_pk_mul_f32 v[220:221], v[236:237], v[236:237]
    v_pk_mul_f32 v[222:223], v[238:239], v[238:239]
    v_pk_fma_f32 v[208:209], v[208:209], v[52:53], v[52:53] op_sel:[0,0,1] op_sel_hi:[1,0,1]
    v_pk_fma_f32 v[210:211], v[210:211], v[52:53], v[52:53] op_sel:[0,0,1] op_sel_hi:[1,0,1]
    v_pk_fma_f32 v[212:213], v[212:213], v[52:53], v[52:53] op_sel:[0,0,1] op_sel_hi:[1,0,1]
    v_pk_fma_f32 v[214:215], v[214:215], v[52:53], v[52:53] op_sel:[0,0,1] op_sel_hi:[1,0,1]
    v_pk_fma_f32 v[216:217], v[216:217], v[52:53], v[52:53] op_sel:[0,0,1] op_sel_hi:[1,0,1]
    v_pk_fma_f32 v[218:219], v[218:219], v[52:53], v[52:53] op_sel:[0,0,1] op_sel_hi:[1,0,1]
    v_pk_fma_f32 v[220:221], v[220:221], v[52:53], v[52:53] op_sel:[0,0,1] op_sel_hi:[1,0,1]
    v_pk_fma_f32 v[222:223], v[222:223], v[52:53], v[52:53] op_sel:[0,0,1] op_sel_hi:[1,0,1]
    v_pk_mul_f32 v[208:209], v[208:209], v[224:225]
    s_add_u32 m0, s81, 114688
    s_add_u32 s80, s79, 640
    buffer_load_dwordx4 v10, s[24:27], s80 offen offset:0 lds
    v_pk_mul_f32 v[210:211], v[210:211], v[226:227]
    v_pk_mul_f32 v[212:213], v[212:213], v[228:229]
    v_pk_mul_f32 v[214:215], v[214:215], v[230:231]
    v_pk_mul_f32 v[216:217], v[216:217], v[232:233]
    v_pk_mul_f32 v[218:219], v[218:219], v[234:235]
    v_pk_mul_f32 v[220:221], v[220:221], v[236:237]
    v_pk_mul_f32 v[222:223], v[222:223], v[238:239]
    v_exp_f32 v208, v208
    v_exp_f32 v209, v209
    v_exp_f32 v210, v210
    v_exp_f32 v211, v211
    v_exp_f32 v212, v212
    v_exp_f32 v213, v213
    buffer_load_dwordx4 v11, s[24:27], s80 offen offset:1024 lds
    v_exp_f32 v214, v214
    v_exp_f32 v215, v215
    v_exp_f32 v216, v216
    v_exp_f32 v217, v217
    v_exp_f32 v218, v218
    v_exp_f32 v219, v219
    v_exp_f32 v220, v220
    v_exp_f32 v221, v221
    v_exp_f32 v222, v222
    v_exp_f32 v223, v223
    v_pk_add_f32 v[208:209], v[208:209], 1.0 op_sel_hi:[1,0]
    s_add_u32 m0, s81, 122880
    s_add_u32 s80, s79, 1664
    buffer_load_dwordx4 v10, s[24:27], s80 offen offset:0 lds
    v_pk_add_f32 v[210:211], v[210:211], 1.0 op_sel_hi:[1,0]
    v_pk_add_f32 v[212:213], v[212:213], 1.0 op_sel_hi:[1,0]
    v_pk_add_f32 v[214:215], v[214:215], 1.0 op_sel_hi:[1,0]
    v_pk_add_f32 v[216:217], v[216:217], 1.0 op_sel_hi:[1,0]
    v_pk_add_f32 v[218:219], v[218:219], 1.0 op_sel_hi:[1,0]
    v_pk_add_f32 v[220:221], v[220:221], 1.0 op_sel_hi:[1,0]
    v_pk_add_f32 v[222:223], v[222:223], 1.0 op_sel_hi:[1,0]
    v_rcp_f32 v208, v208
    v_rcp_f32 v209, v209
    v_rcp_f32 v210, v210
    v_rcp_f32 v211, v211
    v_rcp_f32 v212, v212
    v_rcp_f32 v213, v213
    buffer_load_dwordx4 v11, s[24:27], s80 offen offset:1024 lds
    v_rcp_f32 v214, v214
    v_rcp_f32 v215, v215
    v_rcp_f32 v216, v216
    v_rcp_f32 v217, v217
    v_rcp_f32 v218, v218
    v_rcp_f32 v219, v219
    v_rcp_f32 v220, v220
    v_rcp_f32 v221, v221
    v_rcp_f32 v222, v222
    v_rcp_f32 v223, v223
    v_pk_mul_f32 v[224:225], v[224:225], v[208:209]
    s_add_u32 m0, s81, 0
    s_add_u32 s80, s79, 768
    buffer_load_dwordx4 v10, s[24:27], s80 offen offset:0 lds
    v_pk_mul_f32 v[226:227], v[226:227], v[210:211]
    v_pk_mul_f32 v[228:229], v[228:229], v[212:213]
    v_pk_mul_f32 v[230:231], v[230:231], v[214:215]
    v_pk_mul_f32 v[232:233], v[232:233], v[216:217]
    v_pk_mul_f32 v[234:235], v[234:235], v[218:219]
    v_pk_mul_f32 v[236:237], v[236:237], v[220:221]
    v_pk_mul_f32 v[238:239], v[238:239], v[222:223]
    s_waitcnt vmcnt(8)
    v_cmp_eq_u32 vcc, s6, v27
    s_nop 0
    s_and_b64 s[48:49], vcc, s[44:45]
    s_cmp_eq_u64 s[48:49], s[44:45]
    s_cbranch_scc0 L_rare_8
L_back_9:
    buffer_load_dwordx4 v11, s[24:27], s80 offen offset:1024 lds
    v_pk_mul_f32 v[208:209], v[240:241], v[240:241]
    buffer_load_dwordx4 a[0:3], v21, s[40:43], s88 offen sc1
    v_pk_mul_f32 v[210:211], v[242:243], v[242:243]
    v_pk_mul_f32 v[212:213], v[244:245], v[244:245]
    v_pk_mul_f32 v[214:215], v[246:247], v[246:247]
    v_pk_mul_f32 v[216:217], v[248:249], v[248:249]
    v_pk_mul_f32 v[218:219], v[250:251], v[250:251]
    v_pk_mul_f32 v[220:221], v[252:253], v[252:253]
    v_pk_mul_f32 v[222:223], v[254:255], v[254:255]
    v_pk_fma_f32 v[208:209], v[208:209], v[52:53], v[52:53] op_sel:[0,0,1] op_sel_hi:[1,0,1]
    v_pk_fma_f32 v[210:211], v[210:211], v[52:53], v[52:53] op_sel:[0,0,1] op_sel_hi:[1,0,1]
    v_pk_fma_f32 v[212:213], v[212:213], v[52:53], v[52:53] op_sel:[0,0,1] op_sel_hi:[1,0,1]
    v_pk_fma_f32 v[214:215], v[214:215], v[52:53], v[52:53] op_sel:[0,0,1] op_sel_hi:[1,0,1]
    v_pk_fma_f32 v[216:217], v[216:217], v[52:53], v[52:53] op_sel:[0,0,1] op_sel_hi:[1,0,1]
    buffer_load_dwordx4 a[4:7], v21, s[40:43], s89 offen sc1
    v_pk_fma_f32 v[218:219], v[218:219], v[52:53], v[52:53] op_sel:[0,0,1] op_sel_hi:[1,0,1]
    v_pk_fma_f32 v[220:221], v[220:221], v[52:53], v[52:53] op_sel:[0,0,1] op_sel_hi:[1,0,1]
    v_pk_fma_f32 v[222:223], v[222:223], v[52:53], v[52:53] op_sel:[0,0,1] op_sel_hi:[1,0,1]
    v_pk_mul_f32 v[208:209], v[208:209], v[240:241]
    v_pk_mul_f32 v[210:211], v[210:211], v[242:243]
    v_pk_mul_f32 v[212:213], v[212:213], v[244:245]
    v_pk_mul_f32 v[214:215], v[214:215], v[246:247]
    v_pk_mul_f32 v[216:217], v[216:217], v[248:249]
    v_pk_mul_f32 v[218:219], v[218:219], v[250:251]
    v_pk_mul_f32 v[220:221], v[220:221], v[252:253]
    v_pk_mul_f32 v[222:223], v[222:223], v[254:255]
    v_exp_f32 v208, v208
    v_exp_f32 v209, v209
    v_exp_f32 v210, v210
    v_exp_f32 v211, v211
    v_exp_f32 v212, v212
    buffer_load_dwordx4 a[8:11], v21, s[40:43], s90 offen sc1
    v_exp_f32 v213, v213
    v_exp_f32 v214, v214
    v_exp_f32 v215, v215
    v_exp_f32 v216, v216
    v_exp_f32 v217, v217
    v_exp_f32 v218, v218
    v_exp_f32 v219, v219
    v_exp_f32 v220, v220
    v_exp_f32 v221, v221
    v_exp_f32 v222, v222
    buffer_load_dwordx4 a[12:15], v21, s[40:43], s91 offen sc1
    v_exp_f32 v223, v223
    v_pk_add_f32 v[208:209], v[208:209], 1.0 op_sel_hi:[1,0]
    v_pk_add_f32 v[210:211], v[210:211], 1.0 op_sel_hi:[1,0]
    v_pk_add_f32 v[212:213], v[212:213], 1.0 op_sel_hi:[1,0]
    v_pk_add_f32 v[214:215], v[214:215], 1.0 op_sel_hi:[1,0]
    v_pk_add_f32 v[216:217], v[216:217], 1.0 op_sel_hi:[1,0]
    v_pk_add_f32 v[218:219], v[218:219], 1.0 op_sel_hi:[1,0]
    v_pk_add_f32 v[220:221], v[220:221], 1.0 op_sel_hi:[1,0]
    v_pk_add_f32 v[222:223], v[222:223], 1.0 op_sel_hi:[1,0]
    v_rcp_f32 v208, v208
    v_rcp_f32 v209, v209
    v_rcp_f32 v210, v210
    v_rcp_f32 v211, v211
    v_rcp_f32 v212, v212
    buffer_load_dwordx4 a[16:19], v21, s[40:43], s92 offen sc1
    v_rcp_f32 v213, v213
    v_rcp_f32 v214, v214
    v_rcp_f32 v215, v215
    v_rcp_f32 v216, v216
    v_rcp_f32 v217, v217
    v_rcp_f32 v218, v218
    v_rcp_f32 v219, v219
    v_rcp_f32 v220, v220
    v_rcp_f32 v221, v221
    v_rcp_f32 v222, v222
    buffer_load_dwordx4 a[20:23], v21, s[40:43], s93 offen sc1
    v_rcp_f32 v223, v223
    v_pk_mul_f32 v[240:241], v[240:241], v[208:209]
    v_pk_mul_f32 v[242:243], v[242:243], v[210:211]
    v_pk_mul_f32 v[244:245], v[244:245], v[212:213]
    v_pk_mul_f32 v[246:247], v[246:247], v[214:215]
    v_pk_mul_f32 v[248:249], v[248:249], v[216:217]
    v_pk_mul_f32 v[250:251], v[250:251], v[218:219]
    v_pk_mul_f32 v[252:253], v[252:253], v[220:221]
    v_pk_mul_f32 v[254:255], v[254:255], v[222:223]
    v_mov_b32 v4, 0x3f803f80
    v_accvgpr_write_b32 a176, v4
    v_accvgpr_write_b32 a177, v4
    v_accvgpr_write_b32 a178, v4
    v_accvgpr_write_b32 a179, v4
    v_and_b32 v2, 31, v0
    v_lshrrev_b32 v3, 5, v0
    v_lshlrev_b32 v3, 2, v3
    v_sub_u32 v2, v2, v3
    v_cvt_f32_i32 v2, v2
    buffer_load_dwordx4 a[24:27], v21, s[40:43], s94 offen sc1
    v_add_f32 v2, 0.5, v2
    v_mul_f32 v2, 0x71800000, v2
    v_subrev_f32 v3, 0x0, v2
    v_min_f32 v208, 0, v3
    v_min_f32 v192, 0, -v3
    v_subrev_f32 v3, 0x71800000, v2
    v_min_f32 v209, 0, v3
    v_min_f32 v193, 0, -v3
    v_subrev_f32 v3, 0x72000000, v2
    v_min_f32 v210, 0, v3
    v_min_f32 v194, 0, -v3
    v_subrev_f32 v3, 0x72400000, v2
    v_min_f32 v211, 0, v3
    v_min_f32 v195, 0, -v3
    v_subrev_f32 v3, 0x73800000, v2
    v_min_f32 v212, 0, v3
    v_min_f32 v196, 0, -v3
    v_subrev_f32 v3, 0x73880000, v2
    v_min_f32 v213, 0, v3
    v_min_f32 v197, 0, -v3
    buffer_load_dwordx4 a[28:31], v21, s[40:43], s95 offen sc1
    v_subrev_f32 v3, 0x73900000, v2
    v_min_f32 v214, 0, v3
    v_min_f32 v198, 0, -v3
    v_subrev_f32 v3, 0x73980000, v2
    v_min_f32 v215, 0, v3
    v_min_f32 v199, 0, -v3
    v_subrev_f32 v3, 0x73000000, v2
    v_min_f32 v216, 0, v3
    v_min_f32 v200, 0, -v3
    v_subrev_f32 v3, 0x73100000, v2
    v_min_f32 v217, 0, v3
    v_min_f32 v201, 0, -v3
    v_subrev_f32 v3, 0x73200000, v2
    v_min_f32 v218, 0, v3
    v_min_f32 v202, 0, -v3
    v_subrev_f32 v3, 0x73300000, v2
    v_min_f32 v219, 0, v3
    v_min_f32 v203, 0, -v3
    v_subrev_f32 v3, 0x73c00000, v2
    v_min_f32 v220, 0, v3
    buffer_load_dwordx4 a[32:35], v21, s[40:43], s96 offen sc1
    v_min_f32 v204, 0, -v3
    v_subrev_f32 v3, 0x73c80000, v2
    v_min_f32 v221, 0, v3
    v_min_f32 v205, 0, -v3
    v_subrev_f32 v3, 0x73d00000, v2
    v_min_f32 v222, 0, v3
    v_min_f32 v206, 0, -v3
    v_subrev_f32 v3, 0x73d80000, v2
    v_min_f32 v223, 0, v3
    v_min_f32 v207, 0, -v3
    v_lshlrev_b32 v2, 1, v0
    s_lshl_b32 s67, s4, 7
    buffer_load_ushort v35, v2, s[28:31], s67 offen
    v_and_b32 v2, 1, v20
    v_mul_u32_u24 v2, 45056, v2
    v_lshrrev_b32 v3, 5, v0
    v_lshl_add_u32 v3, v3, 4, v1
    v_lshl_add_u32 v32, v3, 4, v2
    s_lshl_b32 s67, s55, 9
    s_add_u32 s57, s61, s67
    s_mov_b32 s58, 0xf1800000
    s_and_b32 s76, s4, 8
    s_lshl_b32 s76, s76, 13
    s_add_u32 s60, s76, s60
    s_and_b32 s67, s4, 8
    s_lshl_b32 s67, s67, 1
    s_lshl_b32 s45, 0xffff, s67
    buffer_load_dwordx4 a[36:39], v21, s[40:43], s97 offen sc1
    s_waitcnt vmcnt(10)
    v_mfma_f32_32x32x16_bf16 v[176:191], a[0:3], v[12:15], v[192:207]
    buffer_store_dword v29, v30, s[40:43], s52 offen sc1
    s_waitcnt vmcnt(10)
    v_mfma_f32_32x32x16_bf16 v[160:175], a[4:7], v[12:15], 0
    buffer_load_dwordx4 a[40:43], v21, s[40:43], s88 offen offset:1024 sc1
    s_waitcnt vmcnt(10)
    v_mfma_f32_32x32x16_bf16 v[144:159], a[8:11], v[12:15], 0
    buffer_load_dwordx4 a[44:47], v21, s[40:43], s89 offen offset:1024 sc1
    s_cmp_gt_u32 s56, 0
    s_cbranch_scc1 L_rare_12
L_back_13:
    s_nop 2
    v_max_f32 v2, v176, v177
    v_max_f32 v3, v178, v179
    v_max_f32 v4, v180, v181
    v_max_f32 v5, v182, v183
    v_max3_f32 v2, v184, v185, v2
    v_max3_f32 v3, v186, v187, v3
    v_max3_f32 v4, v188, v189, v4
    v_max3_f32 v5, v190, v191, v5
    s_waitcnt vmcnt(10)
    v_mfma_f32_32x32x16_bf16 v[128:143], a[12:15], v[12:15], 0
    buffer_load_dwordx4 a[48:51], v21, s[40:43], s90 offen offset:1024 sc1
    s_cmp_gt_u32 s56, 1
    s_cbranch_scc1 L_rare_15
L_back_16:
    v_max3_f32 v2, v160, v161, v2
    v_max3_f32 v3, v162, v163, v3
    v_max3_f32 v4, v164, v165, v4
    v_max3_f32 v5, v166, v167, v5
    v_max3_f32 v2, v168, v169, v2
    v_max3_f32 v3, v170, v171, v3
    v_max3_f32 v4, v172, v173, v4
    v_max3_f32 v5, v174, v175, v5
    s_waitcnt vmcnt(10)
    v_mfma_f32_32x32x16_bf16 v[112:127], a[16:19], v[12:15], 0
    buffer_load_dwordx4 a[52:55], v21, s[40:43], s91 offen offset:1024 sc1
    s_cmp_gt_u32 s56, 2
    s_cbranch_scc1 L_rare_18
L_back_19:
    v_max3_f32 v2, v144, v145, v2
    v_max3_f32 v3, v146, v147, v3
    v_max3_f32 v4, v148, v149, v4
    v_max3_f32 v5, v150, v151, v5
    v_max3_f32 v2, v152, v153, v2
    v_max3_f32 v3, v154, v155, v3
    v_max3_f32 v4, v156, v157, v4
    v_max3_f32 v5, v158, v159, v5
    s_waitcnt vmcnt(10)
    v_mfma_f32_32x32x16_bf16 v[96:111], a[20:23], v[12:15], 0
    buffer_load_dwordx4 a[56:59], v21, s[40:43], s92 offen offset:1024 sc1
    s_cmp_gt_u32 s56, 3
    s_cbranch_scc1 L_rare_21
L_back_22:
    v_max3_f32 v2, v128, v129, v2
    v_max3_f32 v3, v130, v131, v3
    v_max3_f32 v4, v132, v133, v4
    v_max3_f32 v5, v134, v135, v5
    v_max3_f32 v2, v136, v137, v2
    v_max3_f32 v3, v138, v139, v3
    v_max3_f32 v4, v140, v141, v4
    v_max3_f32 v5, v142, v143, v5
    s_waitcnt vmcnt(10)
    v_mfma_f32_32x32x16_bf16 v[80:95], a[24:27], v[12:15], 0
    buffer_load_dwordx4 a[60:63], v21, s[40:43], s93 offen offset:1024 sc1
    s_cmp_gt_u32 s56, 4
    s_cbranch_scc1 L_rare_24
L_back_25:
    v_max3_f32 v2, v112, v113, v2
    v_max3_f32 v3, v114, v115, v3
    v_max3_f32 v4, v116, v117, v4
    v_max3_f32 v5, v118, v119, v5
    v_max3_f32 v2, v120, v121, v2
    v_max3_f32 v3, v122, v123, v3
    v_max3_f32 v4, v124, v125, v4
    v_max3_f32 v5, v126, v127, v5
    s_waitcnt vmcnt(10)
    v_mfma_f32_32x32x16_bf16 v[64:79], a[28:31], v[12:15], 0
    buffer_load_dwordx4 a[64:67], v21, s[40:43], s94 offen offset:1024 sc1
    s_cmp_gt_u32 s56, 5
    s_cbranch_scc1 L_rare_27
L_back_28:
    v_max3_f32 v2, v96, v97, v2
    v_max3_f32 v3, v98, v99, v3
    v_max3_f32 v4, v100, v101, v4
    v_max3_f32 v5, v102, v103, v5
    v_max3_f32 v2, v104, v105, v2
    v_max3_f32 v3, v106, v107, v3
    v_max3_f32 v4, v108, v109, v4
    v_max3_f32 v5, v110, v111, v5
    s_waitcnt vmcnt(10)
    v_mfma_f32_32x32x16_bf16 v[48:63], a[32:35], v[12:15], v[208:223]
    buffer_load_dwordx4 a[68:71], v21, s[40:43], s95 offen offset:1024 sc1
    s_cmp_gt_u32 s56, 6
    s_cbranch_scc1 L_rare_30
L_back_31:
    v_max3_f32 v2, v80, v81, v2
    v_max3_f32 v3, v82, v83, v3
    v_max3_f32 v4, v84, v85, v4
    v_max3_f32 v5, v86, v87, v5
    v_max3_f32 v2, v88, v89, v2
    v_max3_f32 v3, v90, v91, v3
    v_max3_f32 v4, v92, v93, v4
    v_max3_f32 v5, v94, v95, v5
    s_cmp_gt_u32 s56, 7
    s_cbranch_scc1 L_rare_33
L_back_34:
    v_max3_f32 v2, v64, v65, v2
    v_max3_f32 v3, v66, v67, v3
    buffer_load_dwordx4 a[72:75], v21, s[40:43], s96 offen offset:1024 sc1
    v_max3_f32 v4, v68, v69, v4
    v_max3_f32 v5, v70, v71, v5
    v_max3_f32 v2, v72, v73, v2
    v_max3_f32 v3, v74, v75, v3
    v_max3_f32 v4, v76, v77, v4
    v_max3_f32 v5, v78, v79, v5
    v_max3_f32 v2, v48, v49, v2
    v_max3_f32 v3, v50, v51, v3
    v_max3_f32 v4, v52, v53, v4
    v_max3_f32 v5, v54, v55, v5
    v_max3_f32 v2, v56, v57, v2
    v_max3_f32 v3, v58, v59, v3
    v_max3_f32 v4, v60, v61, v4
    v_max3_f32 v5, v62, v63, v5
    v_max3_f32 v2, v2, v3, v4
    v_max_f32 v2, v2, v5
    v_mov_b32 v3, v2
    s_nop 1
    v_permlane32_swap_b32 v2, v3
    v_max_f32 v2, v2, v3
    v_pk_add_f32 v[176:177], v[176:177], v[2:3] op_sel_hi:[1,0] neg_lo:[0,1] neg_hi:[0,1]
    buffer_load_dwordx4 a[76:79], v21, s[40:43], s97 offen offset:1024 sc1
    v_pk_add_f32 v[178:179], v[178:179], v[2:3] op_sel_hi:[1,0] neg_lo:[0,1] neg_hi:[0,1]
    v_pk_add_f32 v[180:181], v[180:181], v[2:3] op_sel_hi:[1,0] neg_lo:[0,1] neg_hi:[0,1]
    v_pk_add_f32 v[182:183], v[182:183], v[2:3] op_sel_hi:[1,0] neg_lo:[0,1] neg_hi:[0,1]
    v_pk_add_f32 v[184:185], v[184:185], v[2:3] op_sel_hi:[1,0] neg_lo:[0,1] neg_hi:[0,1]
    v_pk_add_f32 v[186:187], v[186:187], v[2:3] op_sel_hi:[1,0] neg_lo:[0,1] neg_hi:[0,1]
    v_pk_add_f32 v[188:189], v[188:189], v[2:3] op_sel_hi:[1,0] neg_lo:[0,1] neg_hi:[0,1]
    v_pk_add_f32 v[190:191], v[190:191], v[2:3] op_sel_hi:[1,0] neg_lo:[0,1] neg_hi:[0,1]
    v_exp_f32 v176, v176
    v_exp_f32 v177, v177
    v_exp_f32 v178, v178
    v_exp_f32 v179, v179
    v_exp_f32 v180, v180
    v_exp_f32 v181, v181
    v_exp_f32 v182, v182
    v_exp_f32 v183, v183
    v_exp_f32 v184, v184
    v_exp_f32 v185, v185
    v_exp_f32 v186, v186
    v_exp_f32 v187, v187
    v_exp_f32 v188, v188
    v_exp_f32 v189, v189
    v_exp_f32 v190, v190
    v_exp_f32 v191, v191
    v_cvt_pk_bf16_f32 v176, v176, v177
    v_cvt_pk_bf16_f32 v177, v178, v179
    v_cvt_pk_bf16_f32 v178, v180, v181
    v_cvt_pk_bf16_f32 v179, v182, v183
    v_cvt_pk_bf16_f32 v184, v184, v185
    v_cvt_pk_bf16_f32 v185, v186, v187
    v_cvt_pk_bf16_f32 v186, v188, v189
    s_lshr_b32 s69, s85, 8
    s_and_b32 s69, s69, 1
    s_xor_b32 s69, s69, 0
    s_lshl_b32 s69, s69, 11
    s_lshl_b32 s70, s85, 13
    s_add_u32 s69, s69, s70
    v_and_b32 v33, 1, v20
    v_lshlrev_b32 v33, 12, v33
    v_lshl_add_u32 v33, v1, 7, v33
    buffer_load_dword v22, v33, s[24:27], s69 offen
    v_cvt_pk_bf16_f32 v187, v190, v191
    v_pk_add_f32 v[160:161], v[160:161], v[2:3] op_sel_hi:[1,0] neg_lo:[0,1] neg_hi:[0,1]
    v_pk_add_f32 v[162:163], v[162:163], v[2:3] op_sel_hi:[1,0] neg_lo:[0,1] neg_hi:[0,1]
    v_pk_add_f32 v[164:165], v[164:165], v[2:3] op_sel_hi:[1,0] neg_lo:[0,1] neg_hi:[0,1]
    v_pk_add_f32 v[166:167], v[166:167], v[2:3] op_sel_hi:[1,0] neg_lo:[0,1] neg_hi:[0,1]
    v_pk_add_f32 v[168:169], v[168:169], v[2:3] op_sel_hi:[1,0] neg_lo:[0,1] neg_hi:[0,1]
    v_pk_add_f32 v[170:171], v[170:171], v[2:3] op_sel_hi:[1,0] neg_lo:[0,1] neg_hi:[0,1]
    v_pk_add_f32 v[172:173], v[172:173], v[2:3] op_sel_hi:[1,0] neg_lo:[0,1] neg_hi:[0,1]
    v_pk_add_f32 v[174:175], v[174:175], v[2:3] op_sel_hi:[1,0] neg_lo:[0,1] neg_hi:[0,1]
    v_exp_f32 v160, v160
    v_exp_f32 v161, v161
    v_exp_f32 v162, v162
    v_exp_f32 v163, v163
    s_waitcnt vmcnt(10)
    v_mfma_f32_32x32x16_bf16 a[80:95], a[40:43], v[176:179], 0
    v_exp_f32 v164, v164
    v_exp_f32 v165, v165
    v_exp_f32 v166, v166
    v_mfma_f32_32x32x16_bf16 a[112:127], a[176:179], v[176:179], 0
    v_exp_f32 v167, v167
    v_exp_f32 v168, v168
    v_exp_f32 v169, v169
    v_mfma_f32_32x32x16_bf16 a[96:111], a[40:43], v[184:187], 0
    v_exp_f32 v170, v170
    v_exp_f32 v171, v171
    v_exp_f32 v172, v172
    v_mfma_f32_32x32x16_bf16 a[112:127], a[176:179], v[184:187], a[112:127]
    v_exp_f32 v173, v173
    v_exp_f32 v174, v174
    v_exp_f32 v175, v175
    v_mfma_f32_32x32x16_bf16 v[176:191], a[4:7], v[16:19], v[192:207]
    v_cvt_pk_bf16_f32 v160, v160, v161
    v_cvt_pk_bf16_f32 v161, v162, v163
    v_cvt_pk_bf16_f32 v162, v164, v165
    v_cvt_pk_bf16_f32 v163, v166, v167
    v_cvt_pk_bf16_f32 v168, v168, v169
    v_cvt_pk_bf16_f32 v169, v170, v171
    v_cvt_pk_bf16_f32 v170, v172, v173
    v_cvt_pk_bf16_f32 v171, v174, v175
    v_pk_add_f32 v[144:145], v[144:145], v[2:3] op_sel_hi:[1,0] neg_lo:[0,1] neg_hi:[0,1]
    v_pk_add_f32 v[146:147], v[146:147], v[2:3] op_sel_hi:[1,0] neg_lo:[0,1] neg_hi:[0,1]
    v_pk_add_f32 v[148:149], v[148:149], v[2:3] op_sel_hi:[1,0] neg_lo:[0,1] neg_hi:[0,1]
    v_pk_add_f32 v[150:151], v[150:151], v[2:3] op_sel_hi:[1,0] neg_lo:[0,1] neg_hi:[0,1]
    v_pk_add_f32 v[152:153], v[152:153], v[2:3] op_sel_hi:[1,0] neg_lo:[0,1] neg_hi:[0,1]
    v_pk_add_f32 v[154:155], v[154:155], v[2:3] op_sel_hi:[1,0] neg_lo:[0,1] neg_hi:[0,1]
    v_pk_add_f32 v[156:157], v[156:157], v[2:3] op_sel_hi:[1,0] neg_lo:[0,1] neg_hi:[0,1]
    v_pk_add_f32 v[158:159], v[158:159], v[2:3] op_sel_hi:[1,0] neg_lo:[0,1] neg_hi:[0,1]
    v_exp_f32 v144, v144
    v_exp_f32 v145, v145
    v_exp_f32 v146, v146
    v_exp_f32 v147, v147
    s_add_u32 m0, s81, 8192
    s_add_u32 s80, s79, 1792
    buffer_load_dwordx4 v10, s[24:27], s80 offen offset:0 lds
    s_waitcnt vmcnt(10)
    v_mfma_f32_32x32x16_bf16 a[80:95], a[44:47], v[160:163], a[80:95]
    v_exp_f32 v148, v148
    v_exp_f32 v149, v149
    v_exp_f32 v150, v150
    v_mfma_f32_32x32x16_bf16 a[112:127], a[176:179], v[160:163], a[112:127]
    v_exp_f32 v151, v151
    v_exp_f32 v152, v152
    v_exp_f32 v153, v153
    buffer_load_dwordx4 v11, s[24:27], s80 offen offset:1024 lds
    v_mfma_f32_32x32x16_bf16 a[96:111], a[44:47], v[168:171], a[96:111]
    v_exp_f32 v154, v154
    v_exp_f32 v155, v155
    v_exp_f32 v156, v156
    v_mfma_f32_32x32x16_bf16 a[112:127], a[176:179], v[168:171], a[112:127]
    v_exp_f32 v157, v157
    v_exp_f32 v158, v158
    v_exp_f32 v159, v159
    v_mfma_f32_32x32x16_bf16 v[160:175], a[8:11], v[16:19], 0
    v_cvt_pk_bf16_f32 v144, v144, v145
    v_cvt_pk_bf16_f32 v145, v146, v147
    s_add_u32 m0, s81, 16384
    s_add_u32 s80, s79, 896
    buffer_load_dwordx4 v10, s[24:27], s80 offen offset:0 lds
    v_cvt_pk_bf16_f32 v146, v148, v149
    v_cvt_pk_bf16_f32 v147, v150, v151
    v_cvt_pk_bf16_f32 v152, v152, v153
    v_cvt_pk_bf16_f32 v153, v154, v155
    v_cvt_pk_bf16_f32 v154, v156, v157
    v_cvt_pk_bf16_f32 v155, v158, v159
    s_cmp_gt_u32 s56, 1
    s_cbranch_scc1 L_rare_36
L_back_37:
    v_max_f32 v6, v176, v177
    v_max_f32 v7, v178, v179
    v_max_f32 v8, v180, v181
    v_max_f32 v9, v182, v183
    v_max3_f32 v6, v184, v185, v6
    v_max3_f32 v7, v186, v187, v7
    v_max3_f32 v8, v188, v189, v8
    v_max3_f32 v9, v190, v191, v9
    v_pk_add_f32 v[128:129], v[128:129], v[2:3] op_sel_hi:[1,0] neg_lo:[0,1] neg_hi:[0,1]
    v_pk_add_f32 v[130:131], v[130:131], v[2:3] op_sel_hi:[1,0] neg_lo:[0,1] neg_hi:[0,1]
    buffer_load_dwordx4 v11, s[24:27], s80 offen offset:1024 lds
    v_pk_add_f32 v[132:133], v[132:133], v[2:3] op_sel_hi:[1,0] neg_lo:[0,1] neg_hi:[0,1]
    v_pk_add_f32 v[134:135], v[134:135], v[2:3] op_sel_hi:[1,0] neg_lo:[0,1] neg_hi:[0,1]
    v_pk_add_f32 v[136:137], v[136:137], v[2:3] op_sel_hi:[1,0] neg_lo:[0,1] neg_hi:[0,1]
    v_pk_add_f32 v[138:139], v[138:139], v[2:3] op_sel_hi:[1,0] neg_lo:[0,1] neg_hi:[0,1]
    v_pk_add_f32 v[140:141], v[140:141], v[2:3] op_sel_hi:[1,0] neg_lo:[0,1] neg_hi:[0,1]
    v_pk_add_f32 v[142:143], v[142:143], v[2:3] op_sel_hi:[1,0] neg_lo:[0,1] neg_hi:[0,1]
    v_exp_f32 v128, v128
    v_exp_f32 v129, v129
    v_exp_f32 v130, v130
    v_exp_f32 v131, v131
    s_waitcnt vmcnt(12)
    v_mfma_f32_32x32x16_bf16 a[80:95], a[48:51], v[144:147], a[80:95]
    v_exp_f32 v132, v132
    v_exp_f32 v133, v133
    s_add_u32 m0, s81, 24576
    s_add_u32 s80, s79, 1920
    buffer_load_dwordx4 v10, s[24:27], s80 offen offset:0 lds
    v_exp_f32 v134, v134
    v_mfma_f32_32x32x16_bf16 a[112:127], a[176:179], v[144:147], a[112:127]
    v_exp_f32 v135, v135
    v_exp_f32 v136, v136
    v_exp_f32 v137, v137
    v_mfma_f32_32x32x16_bf16 a[96:111], a[48:51], v[152:155], a[96:111]
    v_exp_f32 v138, v138
    v_exp_f32 v139, v139
    v_exp_f32 v140, v140
    buffer_load_dwordx4 v11, s[24:27], s80 offen offset:1024 lds
    v_mfma_f32_32x32x16_bf16 a[112:127], a[176:179], v[152:155], a[112:127]
    v_exp_f32 v141, v141
    v_exp_f32 v142, v142
    v_exp_f32 v143, v143
    v_mfma_f32_32x32x16_bf16 v[144:159], a[12:15], v[16:19], 0
    v_cvt_pk_bf16_f32 v128, v128, v129
    v_cvt_pk_bf16_f32 v129, v130, v131
    v_cvt_pk_bf16_f32 v130, v132, v133
    v_cvt_pk_bf16_f32 v131, v134, v135
    v_cvt_pk_bf16_f32 v136, v136, v137
    v_cvt_pk_bf16_f32 v137, v138, v139
    v_cvt_pk_bf16_f32 v138, v140, v141
    v_cvt_pk_bf16_f32 v139, v142, v143
    s_cmp_gt_u32 s56, 2
    s_cbranch_scc1 L_rare_39
L_back_40:
    v_max3_f32 v6, v160, v161, v6
    v_max3_f32 v7, v162, v163, v7
    v_max3_f32 v8, v164, v165, v8
    v_max3_f32 v9, v166, v167, v9
    v_max3_f32 v6, v168, v169, v6
    v_max3_f32 v7, v170, v171, v7
    v_max3_f32 v8, v172, v173, v8
    v_max3_f32 v9, v174, v175, v9
    v_pk_add_f32 v[112:113], v[112:113], v[2:3] op_sel_hi:[1,0] neg_lo:[0,1] neg_hi:[0,1]
    v_pk_add_f32 v[114:115], v[114:115], v[2:3] op_sel_hi:[1,0] neg_lo:[0,1] neg_hi:[0,1]
    v_pk_add_f32 v[116:117], v[116:117], v[2:3] op_sel_hi:[1,0] neg_lo:[0,1] neg_hi:[0,1]
    v_pk_add_f32 v[118:119], v[118:119], v[2:3] op_sel_hi:[1,0] neg_lo:[0,1] neg_hi:[0,1]
    v_pk_add_f32 v[120:121], v[120:121], v[2:3] op_sel_hi:[1,0] neg_lo:[0,1] neg_hi:[0,1]
    v_pk_add_f32 v[122:123], v[122:123], v[2:3] op_sel_hi:[1,0] neg_lo:[0,1] neg_hi:[0,1]
    v_pk_add_f32 v[124:125], v[124:125], v[2:3] op_sel_hi:[1,0] neg_lo:[0,1] neg_hi:[0,1]
    v_pk_add_f32 v[126:127], v[126:127], v[2:3] op_sel_hi:[1,0] neg_lo:[0,1] neg_hi:[0,1]
    v_exp_f32 v112, v112
    v_exp_f32 v113, v113
    v_exp_f32 v114, v114
    v_exp_f32 v115, v115
    s_waitcnt vmcnt(13)
    v_mfma_f32_32x32x16_bf16 a[80:95], a[52:55], v[128:131], a[80:95]
    v_exp_f32 v116, v116
    v_exp_f32 v117, v117
    v_exp_f32 v118, v118
    v_mfma_f32_32x32x16_bf16 a[112:127], a[176:179], v[128:131], a[112:127]
    v_exp_f32 v119, v119
    v_exp_f32 v120, v120
    v_exp_f32 v121, v121
    v_mfma_f32_32x32x16_bf16 a[96:111], a[52:55], v[136:139], a[96:111]
    v_exp_f32 v122, v122
    v_exp_f32 v123, v123
    v_exp_f32 v124, v124
    v_mfma_f32_32x32x16_bf16 a[112:127], a[176:179], v[136:139], a[112:127]
    v_exp_f32 v125, v125
    v_exp_f32 v126, v126
    v_exp_f32 v127, v127
    v_mfma_f32_32x32x16_bf16 v[128:143], a[16:19], v[16:19], 0
    v_cvt_pk_bf16_f32 v112, v112, v113
    v_cvt_pk_bf16_f32 v113, v114, v115
    v_cvt_pk_bf16_f32 v114, v116, v117
    v_cvt_pk_bf16_f32 v115, v118, v119
    v_cvt_pk_bf16_f32 v120, v120, v121
    v_cvt_pk_bf16_f32 v121, v122, v123
    v_cvt_pk_bf16_f32 v122, v124, v125
    v_cvt_pk_bf16_f32 v123, v126, v127
    s_cmp_gt_u32 s56, 3
    s_cbranch_scc1 L_rare_42
L_back_43:
    v_max3_f32 v6, v144, v145, v6
    v_max3_f32 v7, v146, v147, v7
    v_max3_f32 v8, v148, v149, v8
    v_max3_f32 v9, v150, v151, v9
    v_max3_f32 v6, v152, v153, v6
    v_max3_f32 v7, v154, v155, v7
    v_max3_f32 v8, v156, v157, v8
    v_max3_f32 v9, v158, v159, v9
    buffer_load_dword v27, v28, s[40:43], s51 offen sc1
    v_pk_add_f32 v[96:97], v[96:97], v[2:3] op_sel_hi:[1,0] neg_lo:[0,1] neg_hi:[0,1]
    v_pk_add_f32 v[98:99], v[98:99], v[2:3] op_sel_hi:[1,0] neg_lo:[0,1] neg_hi:[0,1]
    v_pk_add_f32 v[100:101], v[100:101], v[2:3] op_sel_hi:[1,0] neg_lo:[0,1] neg_hi:[0,1]
    v_pk_add_f32 v[102:103], v[102:103], v[2:3] op_sel_hi:[1,0] neg_lo:[0,1] neg_hi:[0,1]
    v_pk_add_f32 v[104:105], v[104:105], v[2:3] op_sel_hi:[1,0] neg_lo:[0,1] neg_hi:[0,1]
    v_pk_add_f32 v[106:107], v[106:107], v[2:3] op_sel_hi:[1,0] neg_lo:[0,1] neg_hi:[0,1]
    v_pk_add_f32 v[108:109], v[108:109], v[2:3] op_sel_hi:[1,0] neg_lo:[0,1] neg_hi:[0,1]
    v_pk_add_f32 v[110:111], v[110:111], v[2:3] op_sel_hi:[1,0] neg_lo:[0,1] neg_hi:[0,1]
    v_exp_f32 v96, v96
    v_exp_f32 v97, v97
    v_exp_f32 v98, v98
    v_exp_f32 v99, v99
    s_waitcnt vmcnt(13)
    v_mfma_f32_32x32x16_bf16 a[80:95], a[56:59], v[112:115], a[80:95]
    v_exp_f32 v100, v100
    v_exp_f32 v101, v101
    v_exp_f32 v102, v102
    v_mfma_f32_32x32x16_bf16 a[112:127], a[176:179], v[112:115], a[112:127]
    v_exp_f32 v103, v103
    v_exp_f32 v104, v104
    v_exp_f32 v105, v105
    v_mfma_f32_32x32x16_bf16 a[96:111], a[56:59], v[120:123], a[96:111]
    v_exp_f32 v106, v106
    v_exp_f32 v107, v107
    v_exp_f32 v108, v108
    v_mfma_f32_32x32x16_bf16 a[112:127], a[176:179], v[120:123], a[112:127]
    v_exp_f32 v109, v109
    v_exp_f32 v110, v110
    v_exp_f32 v111, v111
    v_mfma_f32_32x32x16_bf16 v[112:127], a[20:23], v[16:19], 0
    v_cvt_pk_bf16_f32 v96, v96, v97
    v_cvt_pk_bf16_f32 v97, v98, v99
    v_cvt_pk_bf16_f32 v98, v100, v101
    v_cvt_pk_bf16_f32 v99, v102, v103
    v_cvt_pk_bf16_f32 v104, v104, v105
    v_cvt_pk_bf16_f32 v105, v106, v107
    v_cvt_pk_bf16_f32 v106, v108, v109
    v_cvt_pk_bf16_f32 v107, v110, v111
    s_cmp_gt_u32 s56, 4
    s_cbranch_scc1 L_rare_45
L_back_46:
    v_max3_f32 v6, v128, v129, v6
    v_max3_f32 v7, v130, v131, v7
    v_max3_f32 v8, v132, v133, v8
    v_max3_f32 v9, v134, v135, v9
    v_max3_f32 v6, v136, v137, v6
    v_max3_f32 v7, v138, v139, v7
    v_max3_f32 v8, v140, v141, v8
    v_max3_f32 v9, v142, v143, v9
    v_pk_add_f32 v[80:81], v[80:81], v[2:3] op_sel_hi:[1,0] neg_lo:[0,1] neg_hi:[0,1]
    s_xor_b32 s79, s79, 2097152
    s_add_u32 m0, s81, 32768
    s_add_u32 s80, s79, 0
    buffer_load_dwordx4 v10, s[24:27], s80 offen offset:0 lds
    v_pk_add_f32 v[82:83], v[82:83], v[2:3] op_sel_hi:[1,0] neg_lo:[0,1] neg_hi:[0,1]
    buffer_load_dwordx4 v11, s[24:27], s80 offen offset:1024 lds
    v_pk_add_f32 v[84:85], v[84:85], v[2:3] op_sel_hi:[1,0] neg_lo:[0,1] neg_hi:[0,1]
    v_pk_add_f32 v[86:87], v[86:87], v[2:3] op_sel_hi:[1,0] neg_lo:[0,1] neg_hi:[0,1]
    v_pk_add_f32 v[88:89], v[88:89], v[2:3] op_sel_hi:[1,0] neg_lo:[0,1] neg_hi:[0,1]
    v_pk_add_f32 v[90:91], v[90:91], v[2:3] op_sel_hi:[1,0] neg_lo:[0,1] neg_hi:[0,1]
    v_pk_add_f32 v[92:93], v[92:93], v[2:3] op_sel_hi:[1,0] neg_lo:[0,1] neg_hi:[0,1]
    v_pk_add_f32 v[94:95], v[94:95], v[2:3] op_sel_hi:[1,0] neg_lo:[0,1] neg_hi:[0,1]
    v_exp_f32 v80, v80
    v_exp_f32 v81, v81
    v_exp_f32 v82, v82
    s_add_u32 m0, s81, 40960
    s_add_u32 s80, s79, 1024
    buffer_load_dwordx4 v10, s[24:27], s80 offen offset:0 lds
    v_exp_f32 v83, v83
    s_waitcnt vmcnt(15)
    v_mfma_f32_32x32x16_bf16 a[80:95], a[60:63], v[96:99], a[80:95]
    v_exp_f32 v84, v84
    v_exp_f32 v85, v85
    v_exp_f32 v86, v86
    v_mfma_f32_32x32x16_bf16 a[112:127], a[176:179], v[96:99], a[112:127]
    v_exp_f32 v87, v87
    v_exp_f32 v88, v88
    v_exp_f32 v89, v89
    buffer_load_dwordx4 v11, s[24:27], s80 offen offset:1024 lds
    v_mfma_f32_32x32x16_bf16 a[96:111], a[60:63], v[104:107], a[96:111]
    v_exp_f32 v90, v90
    v_exp_f32 v91, v91
    v_exp_f32 v92, v92
    v_mfma_f32_32x32x16_bf16 a[112:127], a[176:179], v[104:107], a[112:127]
    v_exp_f32 v93, v93
    v_exp_f32 v94, v94
    v_exp_f32 v95, v95
    v_mfma_f32_32x32x16_bf16 v[96:111], a[24:27], v[16:19], 0
    v_cvt_pk_bf16_f32 v80, v80, v81
    v_cvt_pk_bf16_f32 v81, v82, v83
    v_cvt_pk_bf16_f32 v82, v84, v85
    s_add_u32 m0, s81, 49152
    s_add_u32 s80, s79, 128
    buffer_load_dwordx4 v10, s[24:27], s80 offen offset:0 lds
    v_cvt_pk_bf16_f32 v83, v86, v87
    v_cvt_pk_bf16_f32 v88, v88, v89
    v_cvt_pk_bf16_f32 v89, v90, v91
    v_cvt_pk_bf16_f32 v90, v92, v93
    v_cvt_pk_bf16_f32 v91, v94, v95
    s_cmp_gt_u32 s56, 5
    s_cbranch_scc1 L_rare_48
L_back_49:
    v_max3_f32 v6, v112, v113, v6
    v_max3_f32 v7, v114, v115, v7
    v_max3_f32 v8, v116, v117, v8
    v_max3_f32 v9, v118, v119, v9
    v_max3_f32 v6, v120, v121, v6
    v_max3_f32 v7, v122, v123, v7
    v_max3_f32 v8, v124, v125, v8
    v_max3_f32 v9, v126, v127, v9
    v_pk_add_f32 v[64:65], v[64:65], v[2:3] op_sel_hi:[1,0] neg_lo:[0,1] neg_hi:[0,1]
    v_pk_add_f32 v[66:67], v[66:67], v[2:3] op_sel_hi:[1,0] neg_lo:[0,1] neg_hi:[0,1]
    v_pk_add_f32 v[68:69], v[68:69], v[2:3] op_sel_hi:[1,0] neg_lo:[0,1] neg_hi:[0,1]
    v_pk_add_f32 v[70:71], v[70:71], v[2:3] op_sel_hi:[1,0] neg_lo:[0,1] neg_hi:[0,1]
    buffer_load_dwordx4 v11, s[24:27], s80 offen offset:1024 lds
    v_pk_add_f32 v[72:73], v[72:73], v[2:3] op_sel_hi:[1,0] neg_lo:[0,1] neg_hi:[0,1]
    v_pk_add_f32 v[74:75], v[74:75], v[2:3] op_sel_hi:[1,0] neg_lo:[0,1] neg_hi:[0,1]
    v_pk_add_f32 v[76:77], v[76:77], v[2:3] op_sel_hi:[1,0] neg_lo:[0,1] neg_hi:[0,1]
    v_pk_add_f32 v[78:79], v[78:79], v[2:3] op_sel_hi:[1,0] neg_lo:[0,1] neg_hi:[0,1]
    v_exp_f32 v64, v64
    v_exp_f32 v65, v65
    v_exp_f32 v66, v66
    v_exp_f32 v67, v67
    s_waitcnt vmcnt(17)
    v_mfma_f32_32x32x16_bf16 a[80:95], a[64:67], v[80:83], a[80:95]
    v_exp_f32 v68, v68
    v_exp_f32 v69, v69
    v_exp_f32 v70, v70
    v_mfma_f32_32x32x16_bf16 a[112:127], a[176:179], v[80:83], a[112:127]
    v_exp_f32 v71, v71
    v_exp_f32 v72, v72
    v_exp_f32 v73, v73
    v_mfma_f32_32x32x16_bf16 a[96:111], a[64:67], v[88:91], a[96:111]
    v_exp_f32 v74, v74
    v_exp_f32 v75, v75
    v_exp_f32 v76, v76
    v_mfma_f32_32x32x16_bf16 a[112:127], a[176:179], v[88:91], a[112:127]
    v_exp_f32 v77, v77
    v_exp_f32 v78, v78
    v_exp_f32 v79, v79
    v_mfma_f32_32x32x16_bf16 v[80:95], a[28:31], v[16:19], 0
    v_cvt_pk_bf16_f32 v64, v64, v65
    v_cvt_pk_bf16_f32 v65, v66, v67
    v_cvt_pk_bf16_f32 v66, v68, v69
    v_cvt_pk_bf16_f32 v67, v70, v71
    v_cvt_pk_bf16_f32 v72, v72, v73
    v_cvt_pk_bf16_f32 v73, v74, v75
    v_cvt_pk_bf16_f32 v74, v76, v77
    v_cvt_pk_bf16_f32 v75, v78, v79
    s_cmp_gt_u32 s56, 6
    s_cbranch_scc1 L_rare_51
L_back_52:
    v_max3_f32 v6, v96, v97, v6
    v_max3_f32 v7, v98, v99, v7
    v_max3_f32 v8, v100, v101, v8
    v_max3_f32 v9, v102, v103, v9
    v_max3_f32 v6, v104, v105, v6
    v_max3_f32 v7, v106, v107, v7
    v_max3_f32 v8, v108, v109, v8
    v_max3_f32 v9, v110, v111, v9
    s_mov_b32 s44, s45
    s_mov_b32 s45, 0
    s_waitcnt vmcnt(6)
    v_cmp_eq_u32 vcc, s6, v27
    s_nop 0
    s_and_b64 s[48:49], vcc, s[44:45]
    s_cmp_eq_u64 s[48:49], s[44:45]
    s_cbranch_scc0 L_rare_54
L_back_55:
    v_pk_add_f32 v[48:49], v[48:49], v[2:3] op_sel_hi:[1,0] neg_lo:[0,1] neg_hi:[0,1]
    s_add_u32 s76, s60, 0
    buffer_load_dwordx4 a[180:183], v31, s[40:43], s76 offen offset:0 sc1
    v_pk_add_f32 v[50:51], v[50:51], v[2:3] op_sel_hi:[1,0] neg_lo:[0,1] neg_hi:[0,1]
    buffer_load_dwordx4 a[184:187], v31, s[40:43], s76 offen offset:1024 sc1
    v_pk_add_f32 v[52:53], v[52:53], v[2:3] op_sel_hi:[1,0] neg_lo:[0,1] neg_hi:[0,1]
    v_pk_add_f32 v[54:55], v[54:55], v[2:3] op_sel_hi:[1,0] neg_lo:[0,1] neg_hi:[0,1]
    v_pk_add_f32 v[56:57], v[56:57], v[2:3] op_sel_hi:[1,0] neg_lo:[0,1] neg_hi:[0,1]
    v_pk_add_f32 v[58:59], v[58:59], v[2:3] op_sel_hi:[1,0] neg_lo:[0,1] neg_hi:[0,1]
    v_pk_add_f32 v[60:61], v[60:61], v[2:3] op_sel_hi:[1,0] neg_lo:[0,1] neg_hi:[0,1]
    v_pk_add_f32 v[62:63], v[62:63], v[2:3] op_sel_hi:[1,0] neg_lo:[0,1] neg_hi:[0,1]
    v_exp_f32 v48, v48
    v_exp_f32 v49, v49
    v_exp_f32 v50, v50
    buffer_load_dwordx4 a[188:191], v31, s[40:43], s76 offen offset:2048 sc1
    v_exp_f32 v51, v51
    v_mfma_f32_32x32x16_bf16 a[80:95], a[68:71], v[64:67], a[80:95]
    v_exp_f32 v52, v52
    v_exp_f32 v53, v53
    v_exp_f32 v54, v54
    v_mfma_f32_32x32x16_bf16 a[112:127], a[176:179], v[64:67], a[112:127]
    v_exp_f32 v55, v55
    v_exp_f32 v56, v56
    v_exp_f32 v57, v57
    v_mfma_f32_32x32x16_bf16 a[96:111], a[68:71], v[72:75], a[96:111]
    buffer_load_dwordx4 a[192:195], v31, s[40:43], s76 offen offset:3072 sc1
    v_exp_f32 v58, v58
    v_exp_f32 v59, v59
    v_exp_f32 v60, v60
    v_mfma_f32_32x32x16_bf16 a[112:127], a[176:179], v[72:75], a[112:127]
    v_exp_f32 v61, v61
    v_exp_f32 v62, v62
    v_exp_f32 v63, v63
    v_mfma_f32_32x32x16_bf16 v[64:79], a[32:35], v[16:19], 0
    v_cvt_pk_bf16_f32 v48, v48, v49
    v_cvt_pk_bf16_f32 v49, v50, v51
    v_cvt_pk_bf16_f32 v50, v52, v53
    s_add_u32 s76, s60, 32768
    buffer_load_dwordx4 a[196:199], v31, s[40:43], s76 offen offset:0 sc1
    v_cvt_pk_bf16_f32 v51, v54, v55
    v_cvt_pk_bf16_f32 v56, v56, v57
    v_cvt_pk_bf16_f32 v57, v58, v59
    v_cvt_pk_bf16_f32 v58, v60, v61
    v_cvt_pk_bf16_f32 v59, v62, v63
    s_cmp_gt_u32 s56, 7
    s_cbranch_scc1 L_rare_58
L_back_59:
    v_max3_f32 v6, v80, v81, v6
    v_max3_f32 v7, v82, v83, v7
    v_max3_f32 v8, v84, v85, v8
    v_max3_f32 v9, v86, v87, v9
    v_max3_f32 v6, v88, v89, v6
    v_max3_f32 v7, v90, v91, v7
    v_max3_f32 v8, v92, v93, v8
    v_max3_f32 v9, v94, v95, v9
    v_max3_f32 v6, v64, v65, v6
    v_max3_f32 v7, v66, v67, v7
    v_mfma_f32_32x32x16_bf16 a[80:95], a[72:75], v[48:51], a[80:95]
    v_max3_f32 v8, v68, v69, v8
    buffer_load_dwordx4 a[200:203], v31, s[40:43], s76 offen offset:1024 sc1
    v_max3_f32 v9, v70, v71, v9
    v_mfma_f32_32x32x16_bf16 a[112:127], a[176:179], v[48:51], a[112:127]
    v_max3_f32 v6, v72, v73, v6
    v_mfma_f32_32x32x16_bf16 a[96:111], a[72:75], v[56:59], a[96:111]
    v_max3_f32 v7, v74, v75, v7
    v_max3_f32 v8, v76, v77, v8
    v_mfma_f32_32x32x16_bf16 a[112:127], a[176:179], v[56:59], a[112:127]
    buffer_load_dwordx4 a[204:207], v31, s[40:43], s76 offen offset:2048 sc1
    v_max3_f32 v9, v78, v79, v9
    v_mfma_f32_32x32x16_bf16 v[48:63], a[36:39], v[16:19], v[208:223]
    s_nop 8
    v_accvgpr_read_b32 v192, a112
    v_accvgpr_read_b32 v196, a80
    v_accvgpr_read_b32 v204, a104
    v_add_f32 v196, v196, v204
    v_accvgpr_read_b32 v197, a81
    v_accvgpr_read_b32 v205, a105
    v_add_f32 v197, v197, v205
    v_accvgpr_read_b32 v198, a82
    v_accvgpr_read_b32 v206, a106
    v_add_f32 v198, v198, v206
    v_accvgpr_read_b32 v199, a83
    buffer_load_dwordx4 a[208:211], v31, s[40:43], s76 offen offset:3072 sc1
    v_accvgpr_read_b32 v207, a107
    v_add_f32 v199, v199, v207
    v_accvgpr_read_b32 v200, a84
    v_accvgpr_read_b32 v204, a108
    v_add_f32 v200, v200, v204
    v_accvgpr_read_b32 v201, a85
    v_accvgpr_read_b32 v205, a109
    v_add_f32 v201, v201, v205
    v_accvgpr_read_b32 v202, a86
    v_accvgpr_read_b32 v206, a110
    v_add_f32 v202, v202, v206
    v_accvgpr_read_b32 v203, a87
    v_accvgpr_read_b32 v207, a111
    v_add_f32 v203, v203, v207
    v_rcp_f32 v192, v192
    s_nop 0
    v_pk_mul_f32 v[196:197], v[196:197], v[192:193] op_sel_hi:[1,0]
    v_pk_mul_f32 v[198:199], v[198:199], v[192:193] op_sel_hi:[1,0]
    v_pk_mul_f32 v[200:201], v[200:201], v[192:193] op_sel_hi:[1,0]
    v_pk_mul_f32 v[202:203], v[202:203], v[192:193] op_sel_hi:[1,0]
    s_add_u32 s76, s60, 4096
    buffer_load_dwordx4 a[212:215], v31, s[40:43], s76 offen offset:0 sc1
    v_cvt_pk_bf16_f32 v192, v196, v197
    v_cvt_pk_bf16_f32 v193, v198, v199
    v_cvt_pk_bf16_f32 v194, v200, v201
    v_cvt_pk_bf16_f32 v195, v202, v203
    buffer_store_dwordx4 v[192:195], v32, s[40:43], s57 offen sc1
    v_max3_f32 v6, v48, v49, v6
    v_max3_f32 v7, v50, v51, v7
    v_max3_f32 v8, v52, v53, v8
    v_max3_f32 v9, v54, v55, v9
    v_max3_f32 v6, v56, v57, v6
    v_max3_f32 v7, v58, v59, v7
    v_max3_f32 v8, v60, v61, v8
    v_max3_f32 v9, v62, v63, v9
    v_max3_f32 v6, v6, v7, v8
    v_max_f32 v6, v6, v9
    v_mov_b32 v7, v6
    s_nop 1
    v_permlane32_swap_b32 v6, v7
    v_max_f32 v6, v6, v7
    s_mov_b32 s44, -1
    s_mov_b32 s45, 0
    v_pk_add_f32 v[176:177], v[176:177], v[6:7] op_sel_hi:[1,0] neg_lo:[0,1] neg_hi:[0,1]
    v_pk_add_f32 v[178:179], v[178:179], v[6:7] op_sel_hi:[1,0] neg_lo:[0,1] neg_hi:[0,1]
    v_pk_add_f32 v[180:181], v[180:181], v[6:7] op_sel_hi:[1,0] neg_lo:[0,1] neg_hi:[0,1]
    v_pk_add_f32 v[182:183], v[182:183], v[6:7] op_sel_hi:[1,0] neg_lo:[0,1] neg_hi:[0,1]
    v_pk_add_f32 v[184:185], v[184:185], v[6:7] op_sel_hi:[1,0] neg_lo:[0,1] neg_hi:[0,1]
    v_pk_add_f32 v[186:187], v[186:187], v[6:7] op_sel_hi:[1,0] neg_lo:[0,1] neg_hi:[0,1]
    v_pk_add_f32 v[188:189], v[188:189], v[6:7] op_sel_hi:[1,0] neg_lo:[0,1] neg_hi:[0,1]
    v_pk_add_f32 v[190:191], v[190:191], v[6:7] op_sel_hi:[1,0] neg_lo:[0,1] neg_hi:[0,1]
    v_exp_f32 v176, v176
    v_exp_f32 v177, v177
    v_exp_f32 v178, v178
    v_exp_f32 v179, v179
    v_exp_f32 v180, v180
    buffer_load_dwordx4 a[216:219], v31, s[40:43], s76 offen offset:1024 sc1
    v_exp_f32 v181, v181
    v_exp_f32 v182, v182
    v_exp_f32 v183, v183
    v_exp_f32 v184, v184
    v_exp_f32 v185, v185
    v_exp_f32 v186, v186
    v_exp_f32 v187, v187
    v_exp_f32 v188, v188
    v_exp_f32 v189, v189
    v_exp_f32 v190, v190
    v_exp_f32 v191, v191
    v_cvt_pk_bf16_f32 v176, v176, v177
    v_cvt_pk_bf16_f32 v177, v178, v179
    v_cvt_pk_bf16_f32 v178, v180, v181
    v_cvt_pk_bf16_f32 v179, v182, v183
    v_cvt_pk_bf16_f32 v184, v184, v185
    v_cvt_pk_bf16_f32 v185, v186, v187
    buffer_load_dwordx4 a[220:223], v31, s[40:43], s76 offen offset:2048 sc1
    v_cvt_pk_bf16_f32 v186, v188, v189
    v_cvt_pk_bf16_f32 v187, v190, v191
    v_pk_add_f32 v[160:161], v[160:161], v[6:7] op_sel_hi:[1,0] neg_lo:[0,1] neg_hi:[0,1]
    v_pk_add_f32 v[162:163], v[162:163], v[6:7] op_sel_hi:[1,0] neg_lo:[0,1] neg_hi:[0,1]
    v_pk_add_f32 v[164:165], v[164:165], v[6:7] op_sel_hi:[1,0] neg_lo:[0,1] neg_hi:[0,1]
    v_pk_add_f32 v[166:167], v[166:167], v[6:7] op_sel_hi:[1,0] neg_lo:[0,1] neg_hi:[0,1]
    v_pk_add_f32 v[168:169], v[168:169], v[6:7] op_sel_hi:[1,0] neg_lo:[0,1] neg_hi:[0,1]
    v_pk_add_f32 v[170:171], v[170:171], v[6:7] op_sel_hi:[1,0] neg_lo:[0,1] neg_hi:[0,1]
    v_pk_add_f32 v[172:173], v[172:173], v[6:7] op_sel_hi:[1,0] neg_lo:[0,1] neg_hi:[0,1]
    v_pk_add_f32 v[174:175], v[174:175], v[6:7] op_sel_hi:[1,0] neg_lo:[0,1] neg_hi:[0,1]
    v_exp_f32 v160, v160
    v_exp_f32 v161, v161
    v_exp_f32 v162, v162
    v_exp_f32 v163, v163
    v_mfma_f32_32x32x16_bf16 a[128:143], a[44:47], v[176:179], 0
    buffer_load_dwordx4 a[224:227], v31, s[40:43], s76 offen offset:3072 sc1
    v_exp_f32 v164, v164
    v_exp_f32 v165, v165
    v_exp_f32 v166, v166
    v_exp_f32 v167, v167
    v_mfma_f32_32x32x16_bf16 a[160:175], a[176:179], v[176:179], 0
    v_exp_f32 v168, v168
    v_exp_f32 v169, v169
    v_exp_f32 v170, v170
    v_exp_f32 v171, v171
    v_mfma_f32_32x32x16_bf16 a[144:159], a[44:47], v[184:187], 0
    v_exp_f32 v172, v172
    s_add_u32 s76, s60, 36864
    buffer_load_dwordx4 a[228:231], v31, s[40:43], s76 offen offset:0 sc1
    v_exp_f32 v173, v173
    v_exp_f32 v174, v174
    v_exp_f32 v175, v175
    v_mfma_f32_32x32x16_bf16 a[160:175], a[176:179], v[184:187], a[160:175]
    v_cvt_pk_bf16_f32 v160, v160, v161
    v_cvt_pk_bf16_f32 v161, v162, v163
    v_cvt_pk_bf16_f32 v162, v164, v165
    v_cvt_pk_bf16_f32 v163, v166, v167
    v_cvt_pk_bf16_f32 v168, v168, v169
    v_cvt_pk_bf16_f32 v169, v170, v171
    v_cvt_pk_bf16_f32 v170, v172, v173
    v_cvt_pk_bf16_f32 v171, v174, v175
    v_pk_add_f32 v[144:145], v[144:145], v[6:7] op_sel_hi:[1,0] neg_lo:[0,1] neg_hi:[0,1]
    v_pk_add_f32 v[146:147], v[146:147], v[6:7] op_sel_hi:[1,0] neg_lo:[0,1] neg_hi:[0,1]
    buffer_load_dwordx4 a[232:235], v31, s[40:43], s76 offen offset:1024 sc1
    v_pk_add_f32 v[148:149], v[148:149], v[6:7] op_sel_hi:[1,0] neg_lo:[0,1] neg_hi:[0,1]
    v_pk_add_f32 v[150:151], v[150:151], v[6:7] op_sel_hi:[1,0] neg_lo:[0,1] neg_hi:[0,1]
    v_pk_add_f32 v[152:153], v[152:153], v[6:7] op_sel_hi:[1,0] neg_lo:[0,1] neg_hi:[0,1]
    v_pk_add_f32 v[154:155], v[154:155], v[6:7] op_sel_hi:[1,0] neg_lo:[0,1] neg_hi:[0,1]
    v_pk_add_f32 v[156:157], v[156:157], v[6:7] op_sel_hi:[1,0] neg_lo:[0,1] neg_hi:[0,1]
    v_pk_add_f32 v[158:159], v[158:159], v[6:7] op_sel_hi:[1,0] neg_lo:[0,1] neg_hi:[0,1]
    v_exp_f32 v144, v144
    v_exp_f32 v145, v145
    v_exp_f32 v146, v146
    v_exp_f32 v147, v147
    v_mfma_f32_32x32x16_bf16 a[128:143], a[48:51], v[160:163], a[128:143]
    v_exp_f32 v148, v148
    v_exp_f32 v149, v149
    buffer_load_dwordx4 a[236:239], v31, s[40:43], s76 offen offset:2048 sc1
    v_exp_f32 v150, v150
    v_exp_f32 v151, v151
    v_mfma_f32_32x32x16_bf16 a[160:175], a[176:179], v[160:163], a[160:175]
    v_exp_f32 v152, v152
    v_exp_f32 v153, v153
    v_exp_f32 v154, v154
    v_exp_f32 v155, v155
    v_mfma_f32_32x32x16_bf16 a[144:159], a[48:51], v[168:171], a[144:159]
    v_exp_f32 v156, v156
    v_exp_f32 v157, v157
    buffer_load_dwordx4 a[240:243], v31, s[40:43], s76 offen offset:3072 sc1
    v_exp_f32 v158, v158
    v_exp_f32 v159, v159
    v_mfma_f32_32x32x16_bf16 a[160:175], a[176:179], v[168:171], a[160:175]
    v_cvt_pk_bf16_f32 v144, v144, v145
    v_cvt_pk_bf16_f32 v145, v146, v147
    v_cvt_pk_bf16_f32 v146, v148, v149
    v_cvt_pk_bf16_f32 v147, v150, v151
    v_cvt_pk_bf16_f32 v152, v152, v153
    v_cvt_pk_bf16_f32 v153, v154, v155
    v_cvt_pk_bf16_f32 v154, v156, v157
    v_cvt_pk_bf16_f32 v155, v158, v159
    v_pk_add_f32 v[128:129], v[128:129], v[6:7] op_sel_hi:[1,0] neg_lo:[0,1] neg_hi:[0,1]
    v_pk_add_f32 v[130:131], v[130:131], v[6:7] op_sel_hi:[1,0] neg_lo:[0,1] neg_hi:[0,1]
    v_pk_add_f32 v[132:133], v[132:133], v[6:7] op_sel_hi:[1,0] neg_lo:[0,1] neg_hi:[0,1]
    v_pk_add_f32 v[134:135], v[134:135], v[6:7] op_sel_hi:[1,0] neg_lo:[0,1] neg_hi:[0,1]
    v_pk_add_f32 v[136:137], v[136:137], v[6:7] op_sel_hi:[1,0] neg_lo:[0,1] neg_hi:[0,1]
    v_pk_add_f32 v[138:139], v[138:139], v[6:7] op_sel_hi:[1,0] neg_lo:[0,1] neg_hi:[0,1]
    v_pk_add_f32 v[140:141], v[140:141], v[6:7] op_sel_hi:[1,0] neg_lo:[0,1] neg_hi:[0,1]
    s_add_u32 s76, s60, 8192
    buffer_load_dwordx4 a[244:247], v31, s[40:43], s76 offen offset:0 sc1
    v_pk_add_f32 v[142:143], v[142:143], v[6:7] op_sel_hi:[1,0] neg_lo:[0,1] neg_hi:[0,1]
    v_exp_f32 v128, v128
    v_exp_f32 v129, v129
    v_exp_f32 v130, v130
    v_exp_f32 v131, v131
    v_mfma_f32_32x32x16_bf16 a[128:143], a[52:55], v[144:147], a[128:143]
    v_exp_f32 v132, v132
    v_exp_f32 v133, v133
    v_exp_f32 v134, v134
    v_exp_f32 v135, v135
    buffer_load_dwordx4 a[248:251], v31, s[40:43], s76 offen offset:1024 sc1
    v_mfma_f32_32x32x16_bf16 a[160:175], a[176:179], v[144:147], a[160:175]
    v_exp_f32 v136, v136
    v_exp_f32 v137, v137
    v_exp_f32 v138, v138
    v_exp_f32 v139, v139
    v_mfma_f32_32x32x16_bf16 a[144:159], a[52:55], v[152:155], a[144:159]
    v_exp_f32 v140, v140
    v_exp_f32 v141, v141
    v_exp_f32 v142, v142
    v_exp_f32 v143, v143
    buffer_load_dwordx4 a[252:255], v31, s[40:43], s76 offen offset:2048 sc1
    v_mfma_f32_32x32x16_bf16 a[160:175], a[176:179], v[152:155], a[160:175]
    v_cvt_pk_bf16_f32 v128, v128, v129
    v_cvt_pk_bf16_f32 v129, v130, v131
    v_cvt_pk_bf16_f32 v130, v132, v133
    v_cvt_pk_bf16_f32 v131, v134, v135
    v_cvt_pk_bf16_f32 v136, v136, v137
    v_cvt_pk_bf16_f32 v137, v138, v139
    v_cvt_pk_bf16_f32 v138, v140, v141
    v_cvt_pk_bf16_f32 v139, v142, v143
    v_pk_add_f32 v[112:113], v[112:113], v[6:7] op_sel_hi:[1,0] neg_lo:[0,1] neg_hi:[0,1]
    v_pk_add_f32 v[114:115], v[114:115], v[6:7] op_sel_hi:[1,0] neg_lo:[0,1] neg_hi:[0,1]
    v_pk_add_f32 v[116:117], v[116:117], v[6:7] op_sel_hi:[1,0] neg_lo:[0,1] neg_hi:[0,1]
    v_pk_add_f32 v[118:119], v[118:119], v[6:7] op_sel_hi:[1,0] neg_lo:[0,1] neg_hi:[0,1]
    v_pk_add_f32 v[120:121], v[120:121], v[6:7] op_sel_hi:[1,0] neg_lo:[0,1] neg_hi:[0,1]
    v_pk_add_f32 v[122:123], v[122:123], v[6:7] op_sel_hi:[1,0] neg_lo:[0,1] neg_hi:[0,1]
    v_pk_add_f32 v[124:125], v[124:125], v[6:7] op_sel_hi:[1,0] neg_lo:[0,1] neg_hi:[0,1]
    v_pk_add_f32 v[126:127], v[126:127], v[6:7] op_sel_hi:[1,0] neg_lo:[0,1] neg_hi:[0,1]
    v_exp_f32 v112, v112
    v_exp_f32 v113, v113
    v_exp_f32 v114, v114
    v_exp_f32 v115, v115
    v_mfma_f32_32x32x16_bf16 a[128:143], a[56:59], v[128:131], a[128:143]
    v_exp_f32 v116, v116
    v_exp_f32 v117, v117
    v_exp_f32 v118, v118
    v_exp_f32 v119, v119
    v_mfma_f32_32x32x16_bf16 a[160:175], a[176:179], v[128:131], a[160:175]
    v_exp_f32 v120, v120
    v_exp_f32 v121, v121
    buffer_load_dwordx4 a[0:3], v31, s[40:43], s76 offen offset:3072 sc1
    v_exp_f32 v122, v122
    v_exp_f32 v123, v123
    v_mfma_f32_32x32x16_bf16 a[144:159], a[56:59], v[136:139], a[144:159]
    v_exp_f32 v124, v124
    v_exp_f32 v125, v125
    v_exp_f32 v126, v126
    v_exp_f32 v127, v127
    v_mfma_f32_32x32x16_bf16 a[160:175], a[176:179], v[136:139], a[160:175]
    v_cvt_pk_bf16_f32 v112, v112, v113
    v_cvt_pk_bf16_f32 v113, v114, v115
    v_cvt_pk_bf16_f32 v114, v116, v117
    v_cvt_pk_bf16_f32 v115, v118, v119
    s_add_u32 s76, s60, 40960
    buffer_load_dwordx4 a[4:7], v31, s[40:43], s76 offen offset:0 sc1
    v_cvt_pk_bf16_f32 v120, v120, v121
    v_cvt_pk_bf16_f32 v121, v122, v123
    v_cvt_pk_bf16_f32 v122, v124, v125
    v_cvt_pk_bf16_f32 v123, v126, v127
    v_pk_add_f32 v[96:97], v[96:97], v[6:7] op_sel_hi:[1,0] neg_lo:[0,1] neg_hi:[0,1]
    v_pk_add_f32 v[98:99], v[98:99], v[6:7] op_sel_hi:[1,0] neg_lo:[0,1] neg_hi:[0,1]
    v_pk_add_f32 v[100:101], v[100:101], v[6:7] op_sel_hi:[1,0] neg_lo:[0,1] neg_hi:[0,1]
    v_pk_add_f32 v[102:103], v[102:103], v[6:7] op_sel_hi:[1,0] neg_lo:[0,1] neg_hi:[0,1]
    v_pk_add_f32 v[104:105], v[104:105], v[6:7] op_sel_hi:[1,0] neg_lo:[0,1] neg_hi:[0,1]
    v_pk_add_f32 v[106:107], v[106:107], v[6:7] op_sel_hi:[1,0] neg_lo:[0,1] neg_hi:[0,1]
    v_pk_add_f32 v[108:109], v[108:109], v[6:7] op_sel_hi:[1,0] neg_lo:[0,1] neg_hi:[0,1]
    v_pk_add_f32 v[110:111], v[110:111], v[6:7] op_sel_hi:[1,0] neg_lo:[0,1] neg_hi:[0,1]
    v_exp_f32 v96, v96
    v_exp_f32 v97, v97
    v_exp_f32 v98, v98
    v_exp_f32 v99, v99
    buffer_load_dwordx4 a[8:11], v31, s[40:43], s76 offen offset:1024 sc1
    v_mfma_f32_32x32x16_bf16 a[128:143], a[60:63], v[112:115], a[128:143]
    v_exp_f32 v100, v100
    v_exp_f32 v101, v101
    v_exp_f32 v102, v102
    v_exp_f32 v103, v103
    v_mfma_f32_32x32x16_bf16 a[160:175], a[176:179], v[112:115], a[160:175]
    v_exp_f32 v104, v104
    v_exp_f32 v105, v105
    v_exp_f32 v106, v106
    v_exp_f32 v107, v107
    buffer_load_dwordx4 a[12:15], v31, s[40:43], s76 offen offset:2048 sc1
    v_mfma_f32_32x32x16_bf16 a[144:159], a[60:63], v[120:123], a[144:159]
    v_exp_f32 v108, v108
    v_exp_f32 v109, v109
    v_exp_f32 v110, v110
    v_exp_f32 v111, v111
    v_mfma_f32_32x32x16_bf16 a[160:175], a[176:179], v[120:123], a[160:175]
    v_cvt_pk_bf16_f32 v96, v96, v97
    v_cvt_pk_bf16_f32 v97, v98, v99
    v_cvt_pk_bf16_f32 v98, v100, v101
    v_cvt_pk_bf16_f32 v99, v102, v103
    v_cvt_pk_bf16_f32 v104, v104, v105
    v_cvt_pk_bf16_f32 v105, v106, v107
    v_cvt_pk_bf16_f32 v106, v108, v109
    v_cvt_pk_bf16_f32 v107, v110, v111
    buffer_load_dwordx4 a[16:19], v31, s[40:43], s76 offen offset:3072 sc1
    v_pk_add_f32 v[80:81], v[80:81], v[6:7] op_sel_hi:[1,0] neg_lo:[0,1] neg_hi:[0,1]
    v_pk_add_f32 v[82:83], v[82:83], v[6:7] op_sel_hi:[1,0] neg_lo:[0,1] neg_hi:[0,1]
    v_pk_add_f32 v[84:85], v[84:85], v[6:7] op_sel_hi:[1,0] neg_lo:[0,1] neg_hi:[0,1]
    v_pk_add_f32 v[86:87], v[86:87], v[6:7] op_sel_hi:[1,0] neg_lo:[0,1] neg_hi:[0,1]
    v_pk_add_f32 v[88:89], v[88:89], v[6:7] op_sel_hi:[1,0] neg_lo:[0,1] neg_hi:[0,1]
    v_pk_add_f32 v[90:91], v[90:91], v[6:7] op_sel_hi:[1,0] neg_lo:[0,1] neg_hi:[0,1]
    v_pk_add_f32 v[92:93], v[92:93], v[6:7] op_sel_hi:[1,0] neg_lo:[0,1] neg_hi:[0,1]
    v_pk_add_f32 v[94:95], v[94:95], v[6:7] op_sel_hi:[1,0] neg_lo:[0,1] neg_hi:[0,1]
    v_exp_f32 v80, v80
    v_exp_f32 v81, v81
    v_exp_f32 v82, v82
    v_exp_f32 v83, v83
    v_mfma_f32_32x32x16_bf16 a[128:143], a[64:67], v[96:99], a[128:143]
    v_exp_f32 v84, v84
    s_add_u32 s76, s60, 12288
    buffer_load_dwordx4 a[20:23], v31, s[40:43], s76 offen offset:0 sc1
    v_exp_f32 v85, v85
    v_exp_f32 v86, v86
    v_exp_f32 v87, v87
    v_mfma_f32_32x32x16_bf16 a[160:175], a[176:179], v[96:99], a[160:175]
    v_exp_f32 v88, v88
    v_exp_f32 v89, v89
    v_exp_f32 v90, v90
    v_exp_f32 v91, v91
    v_mfma_f32_32x32x16_bf16 a[144:159], a[64:67], v[104:107], a[144:159]
    v_exp_f32 v92, v92
    buffer_load_dwordx4 a[24:27], v31, s[40:43], s76 offen offset:1024 sc1
    v_exp_f32 v93, v93
    v_exp_f32 v94, v94
    v_exp_f32 v95, v95
    v_mfma_f32_32x32x16_bf16 a[160:175], a[176:179], v[104:107], a[160:175]
    v_cvt_pk_bf16_f32 v80, v80, v81
    v_cvt_pk_bf16_f32 v81, v82, v83
    v_cvt_pk_bf16_f32 v82, v84, v85
    v_cvt_pk_bf16_f32 v83, v86, v87
    v_cvt_pk_bf16_f32 v88, v88, v89
    v_cvt_pk_bf16_f32 v89, v90, v91
    v_cvt_pk_bf16_f32 v90, v92, v93
    v_cvt_pk_bf16_f32 v91, v94, v95
    v_pk_add_f32 v[64:65], v[64:65], v[6:7] op_sel_hi:[1,0] neg_lo:[0,1] neg_hi:[0,1]
    v_pk_add_f32 v[66:67], v[66:67], v[6:7] op_sel_hi:[1,0] neg_lo:[0,1] neg_hi:[0,1]
    v_pk_add_f32 v[68:69], v[68:69], v[6:7] op_sel_hi:[1,0] neg_lo:[0,1] neg_hi:[0,1]
    v_pk_add_f32 v[70:71], v[70:71], v[6:7] op_sel_hi:[1,0] neg_lo:[0,1] neg_hi:[0,1]
    buffer_load_dwordx4 a[28:31], v31, s[40:43], s76 offen offset:2048 sc1
    v_pk_add_f32 v[72:73], v[72:73], v[6:7] op_sel_hi:[1,0] neg_lo:[0,1] neg_hi:[0,1]
    v_pk_add_f32 v[74:75], v[74:75], v[6:7] op_sel_hi:[1,0] neg_lo:[0,1] neg_hi:[0,1]
    v_pk_add_f32 v[76:77], v[76:77], v[6:7] op_sel_hi:[1,0] neg_lo:[0,1] neg_hi:[0,1]
    v_pk_add_f32 v[78:79], v[78:79], v[6:7] op_sel_hi:[1,0] neg_lo:[0,1] neg_hi:[0,1]
    v_exp_f32 v64, v64
    v_exp_f32 v65, v65
    v_exp_f32 v66, v66
    v_exp_f32 v67, v67
    v_mfma_f32_32x32x16_bf16 a[128:143], a[68:71], v[80:83], a[128:143]
    v_exp_f32 v68, v68
    v_exp_f32 v69, v69
    v_exp_f32 v70, v70
    buffer_load_dwordx4 a[32:35], v31, s[40:43], s76 offen offset:3072 sc1
    v_exp_f32 v71, v71
    v_mfma_f32_32x32x16_bf16 a[160:175], a[176:179], v[80:83], a[160:175]
    v_exp_f32 v72, v72
    v_exp_f32 v73, v73
    v_exp_f32 v74, v74
    v_exp_f32 v75, v75
    v_mfma_f32_32x32x16_bf16 a[144:159], a[68:71], v[88:91], a[144:159]
    v_exp_f32 v76, v76
    v_exp_f32 v77, v77
    v_exp_f32 v78, v78
    s_add_u32 s76, s60, 45056
    buffer_load_dwordx4 a[36:39], v31, s[40:43], s76 offen offset:0 sc1
    v_exp_f32 v79, v79
    v_mfma_f32_32x32x16_bf16 a[160:175], a[176:179], v[88:91], a[160:175]
    v_cvt_pk_bf16_f32 v64, v64, v65
    v_cvt_pk_bf16_f32 v65, v66, v67
    v_cvt_pk_bf16_f32 v66, v68, v69
    v_cvt_pk_bf16_f32 v67, v70, v71
    v_cvt_pk_bf16_f32 v72, v72, v73
    v_cvt_pk_bf16_f32 v73, v74, v75
    v_cvt_pk_bf16_f32 v74, v76, v77
    v_cvt_pk_bf16_f32 v75, v78, v79
    v_pk_add_f32 v[48:49], v[48:49], v[6:7] op_sel_hi:[1,0] neg_lo:[0,1] neg_hi:[0,1]
    v_pk_add_f32 v[50:51], v[50:51], v[6:7] op_sel_hi:[1,0] neg_lo:[0,1] neg_hi:[0,1]
    v_pk_add_f32 v[52:53], v[52:53], v[6:7] op_sel_hi:[1,0] neg_lo:[0,1] neg_hi:[0,1]
    v_pk_add_f32 v[54:55], v[54:55], v[6:7] op_sel_hi:[1,0] neg_lo:[0,1] neg_hi:[0,1]
    v_pk_add_f32 v[56:57], v[56:57], v[6:7] op_sel_hi:[1,0] neg_lo:[0,1] neg_hi:[0,1]
    v_pk_add_f32 v[58:59], v[58:59], v[6:7] op_sel_hi:[1,0] neg_lo:[0,1] neg_hi:[0,1]
    v_pk_add_f32 v[60:61], v[60:61], v[6:7] op_sel_hi:[1,0] neg_lo:[0,1] neg_hi:[0,1]
    buffer_load_dwordx4 a[40:43], v31, s[40:43], s76 offen offset:1024 sc1
    v_pk_add_f32 v[62:63], v[62:63], v[6:7] op_sel_hi:[1,0] neg_lo:[0,1] neg_hi:[0,1]
    v_exp_f32 v48, v48
    v_exp_f32 v49, v49
    v_exp_f32 v50, v50
    v_exp_f32 v51, v51
    v_mfma_f32_32x32x16_bf16 a[128:143], a[72:75], v[64:67], a[128:143]
    v_exp_f32 v52, v52
    v_exp_f32 v53, v53
    v_exp_f32 v54, v54
    v_exp_f32 v55, v55
    v_mfma_f32_32x32x16_bf16 a[160:175], a[176:179], v[64:67], a[160:175]
    s_add_u32 s76, s60, 20480
    buffer_load_dwordx4 a[84:87], v31, s[40:43], s76 offen offset:0 sc1
    v_exp_f32 v56, v56
    v_exp_f32 v57, v57
    v_exp_f32 v58, v58
    v_exp_f32 v59, v59
    v_mfma_f32_32x32x16_bf16 a[144:159], a[72:75], v[72:75], a[144:159]
    v_exp_f32 v60, v60
    v_exp_f32 v61, v61
    v_exp_f32 v62, v62
    v_exp_f32 v63, v63
    v_mfma_f32_32x32x16_bf16 a[160:175], a[176:179], v[72:75], a[160:175]
    buffer_load_dwordx4 a[88:91], v31, s[40:43], s76 offen offset:1024 sc1
    v_cvt_pk_bf16_f32 v48, v48, v49
    v_cvt_pk_bf16_f32 v49, v50, v51
    v_cvt_pk_bf16_f32 v50, v52, v53
    v_cvt_pk_bf16_f32 v51, v54, v55
    v_cvt_pk_bf16_f32 v56, v56, v57
    v_cvt_pk_bf16_f32 v57, v58, v59
    v_cvt_pk_bf16_f32 v58, v60, v61
    v_cvt_pk_bf16_f32 v59, v62, v63
    v_mfma_f32_32x32x16_bf16 a[128:143], a[76:79], v[48:51], a[128:143]
    v_mfma_f32_32x32x16_bf16 a[160:175], a[176:179], v[48:51], a[160:175]
    v_mfma_f32_32x32x16_bf16 a[144:159], a[76:79], v[56:59], a[144:159]
    buffer_load_dwordx4 a[92:95], v31, s[40:43], s76 offen offset:2048 sc1
    v_mfma_f32_32x32x16_bf16 a[160:175], a[176:179], v[56:59], a[160:175]
    v_lshrrev_b32 v2, 1, v1
    v_xor_b32 v2, v2, v20
    v_lshlrev_b32 v2, 4, v2
    v_lshl_add_u32 v12, v1, 7, v2
    v_xor_b32 v13, 64, v12
    v_add_u32 v14, 57344, v12
    buffer_load_dwordx4 a[96:99], v31, s[40:43], s76 offen offset:3072 sc1
    v_add_u32 v15, 57344, v13
    v_add_u32 v16, 114688, v12
    v_add_u32 v17, 114688, v13
    v_lshlrev_b32 v80, 16, v35
    v_lshlrev_b32 v84, 16, v35
    s_nop 1
    v_permlane16_swap_b32 v80, v84
    v_mov_b32 v88, v80
    v_mov_b32 v92, v84
    s_nop 0
    v_permlane32_swap_b32 v80, v88
    v_permlane32_swap_b32 v84, v92
    v_mov_b32 v81, v80
    v_mov_b32 v82, v80
    v_mov_b32 v83, v80
    v_mov_b32 v85, v84
    v_mov_b32 v86, v84
    v_mov_b32 v87, v84
    v_mov_b32 v89, v88
    v_mov_b32 v90, v88
    v_mov_b32 v91, v88
    v_mov_b32 v93, v92
    v_mov_b32 v94, v92
    s_add_u32 s76, s60, 53248
    buffer_load_dwordx4 a[100:103], v31, s[40:43], s76 offen offset:0 sc1
    v_mov_b32 v95, v92
    v_mov_b32 v6, -1
    v_mov_b32 v7, -1
    v_mov_b32 v8, -1
    v_mov_b32 v9, -1
    s_mov_b32 s70, s63
    buffer_store_dwordx4 v[6:9], v31, s[40:43], s70 offen sc1
    s_add_u32 s70, s70, 45056
    buffer_store_dwordx4 v[6:9], v31, s[40:43], s70 offen sc1
    s_add_u32 s70, s70, 45056
    buffer_store_dwordx4 v[6:9], v31, s[40:43], s70 offen sc1
    s_add_u32 s70, s70, 45056
    buffer_store_dwordx4 v[6:9], v31, s[40:43], s70 offen sc1
    v_accvgpr_read_b32 v208, a160
    v_accvgpr_read_b32 v212, a128
    v_accvgpr_read_b32 v220, a152
    v_add_f32 v212, v212, v220
    v_accvgpr_read_b32 v213, a129
    v_accvgpr_read_b32 v221, a153
    v_add_f32 v213, v213, v221
    v_accvgpr_read_b32 v214, a130
    v_accvgpr_read_b32 v222, a154
    v_add_f32 v214, v214, v222
    v_accvgpr_read_b32 v215, a131
    v_accvgpr_read_b32 v223, a155
    v_add_f32 v215, v215, v223
    v_accvgpr_read_b32 v216, a132
    v_accvgpr_read_b32 v220, a156
    v_add_f32 v216, v216, v220
    v_accvgpr_read_b32 v217, a133
    v_accvgpr_read_b32 v221, a157
    v_add_f32 v217, v217, v221
    v_accvgpr_read_b32 v218, a134
    v_accvgpr_read_b32 v222, a158
    buffer_load_dwordx4 a[104:107], v31, s[40:43], s76 offen offset:1024 sc1
    v_add_f32 v218, v218, v222
    v_accvgpr_read_b32 v219, a135
    v_accvgpr_read_b32 v223, a159
    v_add_f32 v219, v219, v223
    v_rcp_f32 v208, v208
    s_nop 0
    v_pk_mul_f32 v[212:213], v[212:213], v[208:209] op_sel_hi:[1,0]
    v_pk_mul_f32 v[214:215], v[214:215], v[208:209] op_sel_hi:[1,0]
    v_pk_mul_f32 v[216:217], v[216:217], v[208:209] op_sel_hi:[1,0]
    v_pk_mul_f32 v[218:219], v[218:219], v[208:209] op_sel_hi:[1,0]
    v_cvt_pk_bf16_f32 v208, v212, v213
    v_cvt_pk_bf16_f32 v209, v214, v215
    v_cvt_pk_bf16_f32 v210, v216, v217
    v_cvt_pk_bf16_f32 v211, v218, v219
    s_add_u32 s57, s57, 90112
    buffer_store_dwordx4 v[208:211], v32, s[40:43], s57 offen sc1
    s_lshl_b32 s67, s5, 7
    s_and_b32 s68, s3, 1
    s_lshl_b32 s68, s68, 14
    s_add_u32 s56, s67, s68
    s_lshr_b32 s68, s3, 1
    s_lshl_b32 s68, s68, 13
    s_add_u32 s56, s56, s68
    s_lshl_b32 s68, s3, 13
    s_add_u32 s58, s67, s68
    s_mul_i32 s64, s3, 45056
    s_add_u32 s64, s64, s61
    s_lshl_b32 s72, s4, 5
    s_add_u32 s72, s72, s55
    s_lshl_b32 s72, s72, 13
    s_add_u32 s72, s72, 16777216
    s_xor_b32 s65, s72, 2097152
    s_mov_b32 s74, 0xffff
    v_add_u32 v19, 4096, v21
    s_lshl_b32 s67, s5, 7
    s_add_u32 s75, s66, s67
    s_add_u32 s77, s81, 57344
    v_bfe_u32 v2, v0, 1, 2
    buffer_load_dwordx4 a[108:111], v31, s[40:43], s76 offen offset:2048 sc1
    v_lshlrev_b32 v2, 5, v2
    v_lshl_add_u32 v2, v1, 7, v2
    v_lshl_add_u32 v2, v20, 3, v2
    v_add_u32 v44, s77, v2
    s_barrier
    ds_read_b128 v[128:131], v16 offset:16384
    ds_read_b128 v[132:135], v16 offset:18432
    ds_read_b128 v[136:139], v16 offset:20480
    ds_read_b128 v[140:143], v16 offset:22528
    ds_read_b128 v[144:147], v17 offset:16384
    ds_read_b128 v[148:151], v17 offset:18432
    ds_read_b128 v[152:155], v17 offset:20480
    ds_read_b128 v[156:159], v17 offset:22528
    s_waitcnt vmcnt(41) lgkmcnt(4)
    v_mfma_f32_16x16x32_bf16 v[96:99], a[180:183], v[128:131], 0
    s_add_u32 m0, s77, 1024
    s_add_u32 s69, s75, 8192
    buffer_load_dwordx4 v24, s[8:11], s69 offen lds
    v_mfma_f32_16x16x32_bf16 v[100:103], a[180:183], v[132:135], 0
    ds_read_b128 v[160:163], v16 offset:24576
    v_mfma_f32_16x16x32_bf16 v[104:107], a[180:183], v[136:139], 0
    s_add_u32 m0, s77, 0
    s_add_u32 s69, s75, 0
    buffer_load_dwordx4 v24, s[8:11], s69 offen lds
    ds_read_b128 v[164:167], v16 offset:26624
    v_mfma_f32_16x16x32_bf16 v[108:111], a[180:183], v[140:143], 0
    ds_read_b128 v[168:171], v16 offset:28672
    v_mfma_f32_16x16x32_bf16 v[112:115], a[184:187], v[128:131], 0
    ds_read_b128 v[172:175], v16 offset:30720
    v_mfma_f32_16x16x32_bf16 v[116:119], a[184:187], v[132:135], 0
    v_mfma_f32_16x16x32_bf16 v[120:123], a[184:187], v[136:139], 0
    v_mfma_f32_16x16x32_bf16 v[124:127], a[184:187], v[140:143], 0
    buffer_load_dwordx4 a[112:115], v31, s[40:43], s76 offen offset:3072 sc1
    s_waitcnt vmcnt(42) lgkmcnt(4)
    v_mfma_f32_16x16x32_bf16 v[96:99], a[188:191], v[144:147], v[96:99]
    v_mfma_f32_16x16x32_bf16 v[100:103], a[188:191], v[148:151], v[100:103]
    ds_read_b128 v[128:131], v17 offset:24576
    v_mfma_f32_16x16x32_bf16 v[104:107], a[188:191], v[152:155], v[104:107]
    ds_read_b128 v[132:135], v17 offset:26624
    v_mfma_f32_16x16x32_bf16 v[108:111], a[188:191], v[156:159], v[108:111]
    ds_read_b128 v[136:139], v17 offset:28672
    v_mfma_f32_16x16x32_bf16 v[112:115], a[192:195], v[144:147], v[112:115]
    s_add_u32 s76, s60, 24576
    buffer_load_dwordx4 a[116:119], v31, s[40:43], s76 offen offset:0 sc1
    ds_read_b128 v[140:143], v17 offset:30720
    v_mfma_f32_16x16x32_bf16 v[116:119], a[192:195], v[148:151], v[116:119]
    v_mfma_f32_16x16x32_bf16 v[120:123], a[192:195], v[152:155], v[120:123]
    v_mfma_f32_16x16x32_bf16 v[124:127], a[192:195], v[156:159], v[124:127]
    s_barrier
    s_waitcnt vmcnt(41) lgkmcnt(4)
    v_mfma_f32_16x16x32_bf16 v[96:99], a[196:199], v[160:163], v[96:99]
    v_mfma_f32_16x16x32_bf16 v[100:103], a[196:199], v[164:167], v[100:103]
    ds_read_b128 v[144:147], v16 offset:32768
    v_mfma_f32_16x16x32_bf16 v[104:107], a[196:199], v[168:171], v[104:107]
    buffer_load_dwordx4 a[120:123], v31, s[40:43], s76 offen offset:1024 sc1
    ds_read_b128 v[148:151], v16 offset:34816
    v_mfma_f32_16x16x32_bf16 v[108:111], a[196:199], v[172:175], v[108:111]
    ds_read_b128 v[152:155], v16 offset:36864
    v_mfma_f32_16x16x32_bf16 v[112:115], a[200:203], v[160:163], v[112:115]
    ds_read_b128 v[156:159], v16 offset:38912
    v_mfma_f32_16x16x32_bf16 v[116:119], a[200:203], v[164:167], v[116:119]
    v_mfma_f32_16x16x32_bf16 v[120:123], a[200:203], v[168:171], v[120:123]
    v_mfma_f32_16x16x32_bf16 v[124:127], a[200:203], v[172:175], v[124:127]
    s_add_u32 s76, s60, 45056
    buffer_load_dwordx4 a[44:47], v31, s[40:43], s76 offen offset:2048 sc1
    s_waitcnt vmcnt(41) lgkmcnt(4)
    v_mfma_f32_16x16x32_bf16 v[96:99], a[204:207], v[128:131], v[96:99]
    v_mfma_f32_16x16x32_bf16 v[100:103], a[204:207], v[132:135], v[100:103]
    ds_read_b128 v[160:163], v17 offset:32768
    v_mfma_f32_16x16x32_bf16 v[104:107], a[204:207], v[136:139], v[104:107]
    ds_read_b128 v[164:167], v17 offset:34816
    v_mfma_f32_16x16x32_bf16 v[108:111], a[204:207], v[140:143], v[108:111]
    ds_read_b128 v[168:171], v17 offset:36864
    v_mfma_f32_16x16x32_bf16 v[112:115], a[208:211], v[128:131], v[112:115]
    buffer_load_dwordx4 a[48:51], v31, s[40:43], s76 offen offset:3072 sc1
    ds_read_b128 v[172:175], v17 offset:38912
    v_mfma_f32_16x16x32_bf16 v[116:119], a[208:211], v[132:135], v[116:119]
    v_mfma_f32_16x16x32_bf16 v[120:123], a[208:211], v[136:139], v[120:123]
    v_mfma_f32_16x16x32_bf16 v[124:127], a[208:211], v[140:143], v[124:127]
    s_waitcnt vmcnt(39) lgkmcnt(4)
    v_mfma_f32_16x16x32_bf16 v[96:99], a[212:215], v[144:147], v[96:99]
    v_mfma_f32_16x16x32_bf16 v[100:103], a[212:215], v[148:151], v[100:103]
    ds_read_b128 v[128:131], v16 offset:40960
    s_add_u32 s76, s60, 16384
    buffer_load_dwordx4 a[52:55], v31, s[40:43], s76 offen offset:0 sc1
    v_mfma_f32_16x16x32_bf16 v[104:107], a[212:215], v[152:155], v[104:107]
    ds_read_b128 v[132:135], v16 offset:43008
    v_mfma_f32_16x16x32_bf16 v[108:111], a[212:215], v[156:159], v[108:111]
    ds_read_b128 v[136:139], v16 offset:45056
    v_mfma_f32_16x16x32_bf16 v[112:115], a[216:219], v[144:147], v[112:115]
    ds_read_b128 v[140:143], v16 offset:47104
    v_mfma_f32_16x16x32_bf16 v[116:119], a[216:219], v[148:151], v[116:119]
    v_mfma_f32_16x16x32_bf16 v[120:123], a[216:219], v[152:155], v[120:123]
    v_mfma_f32_16x16x32_bf16 v[124:127], a[216:219], v[156:159], v[124:127]
    buffer_load_dwordx4 a[56:59], v31, s[40:43], s76 offen offset:1024 sc1
    s_waitcnt vmcnt(39) lgkmcnt(4)
    v_mfma_f32_16x16x32_bf16 v[96:99], a[220:223], v[160:163], v[96:99]
    v_mfma_f32_16x16x32_bf16 v[100:103], a[220:223], v[164:167], v[100:103]
    ds_read_b128 v[144:147], v17 offset:40960
    v_mfma_f32_16x16x32_bf16 v[104:107], a[220:223], v[168:171], v[104:107]
    ds_read_b128 v[148:151], v17 offset:43008
    v_mfma_f32_16x16x32_bf16 v[108:111], a[220:223], v[172:175], v[108:111]
    buffer_load_dwordx4 a[60:63], v31, s[40:43], s76 offen offset:2048 sc1
    ds_read_b128 v[152:155], v17 offset:45056
    v_mfma_f32_16x16x32_bf16 v[112:115], a[224:227], v[160:163], v[112:115]
    ds_read_b128 v[156:159], v17 offset:47104
    v_mfma_f32_16x16x32_bf16 v[116:119], a[224:227], v[164:167], v[116:119]
    v_mfma_f32_16x16x32_bf16 v[120:123], a[224:227], v[168:171], v[120:123]
    v_mfma_f32_16x16x32_bf16 v[124:127], a[224:227], v[172:175], v[124:127]
    s_barrier
    s_waitcnt vmcnt(38) lgkmcnt(4)
    v_mfma_f32_16x16x32_bf16 v[96:99], a[228:231], v[128:131], v[96:99]
    buffer_load_dwordx4 a[64:67], v31, s[40:43], s76 offen offset:3072 sc1
    v_mfma_f32_16x16x32_bf16 v[100:103], a[228:231], v[132:135], v[100:103]
    ds_read_b128 v[160:163], v14 offset:8192
    v_mfma_f32_16x16x32_bf16 v[104:107], a[228:231], v[136:139], v[104:107]
    ds_read_b128 v[164:167], v14 offset:10240
    v_mfma_f32_16x16x32_bf16 v[108:111], a[228:231], v[140:143], v[108:111]
    ds_read_b128 v[168:171], v14 offset:12288
    v_mfma_f32_16x16x32_bf16 v[112:115], a[232:235], v[128:131], v[112:115]
    s_add_u32 s76, s60, 49152
    buffer_load_dwordx4 a[68:71], v31, s[40:43], s76 offen offset:0 sc1
    ds_read_b128 v[172:175], v14 offset:14336
    v_mfma_f32_16x16x32_bf16 v[116:119], a[232:235], v[132:135], v[116:119]
    v_mfma_f32_16x16x32_bf16 v[120:123], a[232:235], v[136:139], v[120:123]
    v_mfma_f32_16x16x32_bf16 v[124:127], a[232:235], v[140:143], v[124:127]
    s_waitcnt vmcnt(38) lgkmcnt(4)
    v_mfma_f32_16x16x32_bf16 v[96:99], a[236:239], v[144:147], v[96:99]
    v_mfma_f32_16x16x32_bf16 v[100:103], a[236:239], v[148:151], v[100:103]
    buffer_load_dwordx4 a[72:75], v31, s[40:43], s76 offen offset:1024 sc1
    ds_read_b128 v[128:131], v15 offset:8192
    v_mfma_f32_16x16x32_bf16 v[104:107], a[236:239], v[152:155], v[104:107]
    ds_read_b128 v[132:135], v15 offset:10240
    v_mfma_f32_16x16x32_bf16 v[108:111], a[236:239], v[156:159], v[108:111]
    ds_read_b128 v[136:139], v15 offset:12288
    v_mfma_f32_16x16x32_bf16 v[112:115], a[240:243], v[144:147], v[112:115]
    ds_read_b128 v[140:143], v15 offset:14336
    v_mfma_f32_16x16x32_bf16 v[116:119], a[240:243], v[148:151], v[116:119]
    v_mfma_f32_16x16x32_bf16 v[120:123], a[240:243], v[152:155], v[120:123]
    buffer_load_dwordx4 a[76:79], v31, s[40:43], s76 offen offset:2048 sc1
    v_mfma_f32_16x16x32_bf16 v[124:127], a[240:243], v[156:159], v[124:127]
    s_waitcnt vmcnt(38) lgkmcnt(4)
    v_mfma_f32_16x16x32_bf16 v[96:99], a[244:247], v[160:163], v[96:99]
    v_mfma_f32_16x16x32_bf16 v[100:103], a[244:247], v[164:167], v[100:103]
    ds_read_b128 v[144:147], v14 offset:16384
    v_mfma_f32_16x16x32_bf16 v[104:107], a[244:247], v[168:171], v[104:107]
    ds_read_b128 v[148:151], v14 offset:18432
    v_mfma_f32_16x16x32_bf16 v[108:111], a[244:247], v[172:175], v[108:111]
    buffer_load_dwordx4 a[80:83], v31, s[40:43], s76 offen offset:3072 sc1
    ds_read_b128 v[152:155], v14 offset:20480
    v_mfma_f32_16x16x32_bf16 v[112:115], a[248:251], v[160:163], v[112:115]
    ds_read_b128 v[156:159], v14 offset:22528
    v_mfma_f32_16x16x32_bf16 v[116:119], a[248:251], v[164:167], v[116:119]
    v_mfma_f32_16x16x32_bf16 v[120:123], a[248:251], v[168:171], v[120:123]
    v_mfma_f32_16x16x32_bf16 v[124:127], a[248:251], v[172:175], v[124:127]
    s_waitcnt vmcnt(37) lgkmcnt(4)
    v_mfma_f32_16x16x32_bf16 v[96:99], a[252:255], v[128:131], v[96:99]
    s_add_u32 s76, s60, 24576
    buffer_load_dwordx4 a[124:127], v31, s[40:43], s76 offen offset:2048 sc1
    v_mfma_f32_16x16x32_bf16 v[100:103], a[252:255], v[132:135], v[100:103]
    ds_read_b128 v[160:163], v15 offset:16384
    v_mfma_f32_16x16x32_bf16 v[104:107], a[252:255], v[136:139], v[104:107]
    ds_read_b128 v[164:167], v15 offset:18432
    v_mfma_f32_16x16x32_bf16 v[108:111], a[252:255], v[140:143], v[108:111]
    ds_read_b128 v[168:171], v15 offset:20480
    v_mfma_f32_16x16x32_bf16 v[112:115], a[0:3], v[128:131], v[112:115]
    ds_read_b128 v[172:175], v15 offset:22528
    v_mfma_f32_16x16x32_bf16 v[116:119], a[0:3], v[132:135], v[116:119]
    buffer_load_dwordx4 a[128:131], v31, s[40:43], s76 offen offset:3072 sc1
    v_mfma_f32_16x16x32_bf16 v[120:123], a[0:3], v[136:139], v[120:123]
    v_mfma_f32_16x16x32_bf16 v[124:127], a[0:3], v[140:143], v[124:127]
    s_barrier
    s_waitcnt vmcnt(37) lgkmcnt(4)
    v_mfma_f32_16x16x32_bf16 v[96:99], a[4:7], v[144:147], v[96:99]
    ds_read_b128 v[128:131], v14 offset:24576
    s_add_u32 s76, s60, 57344
    buffer_load_dwordx4 a[132:135], v31, s[40:43], s76 offen offset:0 sc1
    v_mfma_f32_16x16x32_bf16 v[100:103], a[4:7], v[148:151], v[100:103]
    ds_read_b128 v[132:135], v14 offset:26624
    v_mfma_f32_16x16x32_bf16 v[104:107], a[4:7], v[152:155], v[104:107]
    ds_read_b128 v[136:139], v14 offset:28672
    v_mfma_f32_16x16x32_bf16 v[108:111], a[4:7], v[156:159], v[108:111]
    ds_read_b128 v[140:143], v14 offset:30720
    v_mfma_f32_16x16x32_bf16 v[112:115], a[8:11], v[144:147], v[112:115]
    s_waitcnt vmcnt(16)
    ds_read_b64 v[36:37], v44
    v_mfma_f32_16x16x32_bf16 v[116:119], a[8:11], v[148:151], v[116:119]
    buffer_load_dwordx4 a[136:139], v31, s[40:43], s76 offen offset:1024 sc1
    v_xor_b32 v44, 32, v44
    ds_read_b64 v[38:39], v44
    v_mfma_f32_16x16x32_bf16 v[120:123], a[8:11], v[152:155], v[120:123]
    v_xor_b32 v44, 96, v44
    ds_read_b64 v[40:41], v44
    v_mfma_f32_16x16x32_bf16 v[124:127], a[8:11], v[156:159], v[124:127]
    v_xor_b32 v44, 32, v44
    ds_read_b64 v[42:43], v44
    s_waitcnt lgkmcnt(8)
    v_mfma_f32_16x16x32_bf16 v[96:99], a[12:15], v[160:163], v[96:99]
    v_mfma_f32_16x16x32_bf16 v[100:103], a[12:15], v[164:167], v[100:103]
    ds_read_b128 v[144:147], v15 offset:24576
    v_mfma_f32_16x16x32_bf16 v[104:107], a[12:15], v[168:171], v[104:107]
    buffer_load_dwordx4 a[140:143], v31, s[40:43], s76 offen offset:2048 sc1
    ds_read_b128 v[148:151], v15 offset:26624
    v_mfma_f32_16x16x32_bf16 v[108:111], a[12:15], v[172:175], v[108:111]
    ds_read_b128 v[152:155], v15 offset:28672
    v_mfma_f32_16x16x32_bf16 v[112:115], a[16:19], v[160:163], v[112:115]
    ds_read_b128 v[156:159], v15 offset:30720
    v_mfma_f32_16x16x32_bf16 v[116:119], a[16:19], v[164:167], v[116:119]
    v_mfma_f32_16x16x32_bf16 v[120:123], a[16:19], v[168:171], v[120:123]
    v_mfma_f32_16x16x32_bf16 v[124:127], a[16:19], v[172:175], v[124:127]
    buffer_load_dwordx4 a[144:147], v31, s[40:43], s76 offen offset:3072 sc1
    s_waitcnt lgkmcnt(8)
    v_mfma_f32_16x16x32_bf16 v[96:99], a[20:23], v[128:131], v[96:99]
    ds_read_b128 v[160:163], v14 offset:32768
    v_mfma_f32_16x16x32_bf16 v[100:103], a[20:23], v[132:135], v[100:103]
    ds_read_b128 v[164:167], v14 offset:34816
    v_mfma_f32_16x16x32_bf16 v[104:107], a[20:23], v[136:139], v[104:107]
    ds_read_b128 v[168:171], v14 offset:36864
    v_mfma_f32_16x16x32_bf16 v[108:111], a[20:23], v[140:143], v[108:111]
    ds_read_b128 v[172:175], v14 offset:38912
    v_mfma_f32_16x16x32_bf16 v[112:115], a[24:27], v[128:131], v[112:115]
    s_add_u32 s76, s60, 28672
    buffer_load_dwordx4 a[148:151], v31, s[40:43], s76 offen offset:0 sc1
    buffer_store_dword v29, v30, s[40:43], s54 offen sc1
    v_mfma_f32_16x16x32_bf16 v[116:119], a[24:27], v[132:135], v[116:119]
    v_mfma_f32_16x16x32_bf16 v[120:123], a[24:27], v[136:139], v[120:123]
    v_mfma_f32_16x16x32_bf16 v[124:127], a[24:27], v[140:143], v[124:127]
    s_waitcnt lgkmcnt(4)
    v_mfma_f32_16x16x32_bf16 v[96:99], a[28:31], v[144:147], v[96:99]
    v_mfma_f32_16x16x32_bf16 v[100:103], a[28:31], v[148:151], v[100:103]
    ds_read_b128 v[128:131], v15 offset:32768
    buffer_load_dwordx4 a[152:155], v31, s[40:43], s76 offen offset:1024 sc1
    v_mfma_f32_16x16x32_bf16 v[104:107], a[28:31], v[152:155], v[104:107]
    ds_read_b128 v[132:135], v15 offset:34816
    v_mfma_f32_16x16x32_bf16 v[108:111], a[28:31], v[156:159], v[108:111]
    ds_read_b128 v[136:139], v15 offset:36864
    v_mfma_f32_16x16x32_bf16 v[112:115], a[32:35], v[144:147], v[112:115]
    ds_read_b128 v[140:143], v15 offset:38912
    v_mfma_f32_16x16x32_bf16 v[116:119], a[32:35], v[148:151], v[116:119]
    v_mfma_f32_16x16x32_bf16 v[120:123], a[32:35], v[152:155], v[120:123]
    v_mfma_f32_16x16x32_bf16 v[124:127], a[32:35], v[156:159], v[124:127]
    buffer_load_dwordx4 a[156:159], v31, s[40:43], s76 offen offset:2048 sc1
    s_barrier
    s_waitcnt lgkmcnt(4)
    v_mfma_f32_16x16x32_bf16 v[96:99], a[36:39], v[160:163], v[96:99]
    v_mfma_f32_16x16x32_bf16 v[100:103], a[36:39], v[164:167], v[100:103]
    ds_read_b128 v[144:147], v14 offset:40960
    v_mfma_f32_16x16x32_bf16 v[104:107], a[36:39], v[168:171], v[104:107]
    buffer_load_dwordx4 a[160:163], v31, s[40:43], s76 offen offset:3072 sc1
    ds_read_b128 v[148:151], v14 offset:43008
    v_mfma_f32_16x16x32_bf16 v[108:111], a[36:39], v[172:175], v[108:111]
    ds_read_b128 v[152:155], v14 offset:45056
    v_mfma_f32_16x16x32_bf16 v[112:115], a[40:43], v[160:163], v[112:115]
    ds_read_b128 v[156:159], v14 offset:47104
    v_mfma_f32_16x16x32_bf16 v[116:119], a[40:43], v[164:167], v[116:119]
    v_mfma_f32_16x16x32_bf16 v[120:123], a[40:43], v[168:171], v[120:123]
    v_mfma_f32_16x16x32_bf16 v[124:127], a[40:43], v[172:175], v[124:127]
    s_add_u32 s76, s60, 61440
    buffer_load_dwordx4 a[164:167], v31, s[40:43], s76 offen offset:0 sc1
    s_waitcnt vmcnt(20) lgkmcnt(4)
    v_mfma_f32_16x16x32_bf16 v[96:99], a[44:47], v[128:131], v[96:99]
    v_mfma_f32_16x16x32_bf16 v[100:103], a[44:47], v[132:135], v[100:103]
    ds_read_b128 v[160:163], v15 offset:40960
    v_mfma_f32_16x16x32_bf16 v[104:107], a[44:47], v[136:139], v[104:107]
    ds_read_b128 v[164:167], v15 offset:43008
    v_mfma_f32_16x16x32_bf16 v[108:111], a[44:47], v[140:143], v[108:111]
    ds_read_b128 v[168:171], v15 offset:45056
    v_mfma_f32_16x16x32_bf16 v[112:115], a[48:51], v[128:131], v[112:115]
    buffer_load_dwordx4 a[168:171], v31, s[40:43], s76 offen offset:1024 sc1
    ds_read_b128 v[172:175], v15 offset:47104
    v_mfma_f32_16x16x32_bf16 v[116:119], a[48:51], v[132:135], v[116:119]
    v_mfma_f32_16x16x32_bf16 v[120:123], a[48:51], v[136:139], v[120:123]
    v_mfma_f32_16x16x32_bf16 v[124:127], a[48:51], v[140:143], v[124:127]
    s_waitcnt vmcnt(19) lgkmcnt(4)
    v_mfma_f32_16x16x32_bf16 v[96:99], a[52:55], v[144:147], v[96:99]
    v_mfma_f32_16x16x32_bf16 v[100:103], a[52:55], v[148:151], v[100:103]
    buffer_load_dwordx4 a[172:175], v31, s[40:43], s76 offen offset:2048 sc1
    ds_read_b128 v[128:131], v14 offset:49152
    v_mfma_f32_16x16x32_bf16 v[104:107], a[52:55], v[152:155], v[104:107]
    ds_read_b128 v[132:135], v14 offset:51200
    v_mfma_f32_16x16x32_bf16 v[108:111], a[52:55], v[156:159], v[108:111]
    ds_read_b128 v[136:139], v14 offset:53248
    v_mfma_f32_16x16x32_bf16 v[112:115], a[56:59], v[144:147], v[112:115]
    ds_read_b128 v[140:143], v14 offset:55296
    v_mfma_f32_16x16x32_bf16 v[116:119], a[56:59], v[148:151], v[116:119]
    v_mfma_f32_16x16x32_bf16 v[120:123], a[56:59], v[152:155], v[120:123]
    buffer_load_dwordx4 a[176:179], v31, s[40:43], s76 offen offset:3072 sc1
    v_mfma_f32_16x16x32_bf16 v[124:127], a[56:59], v[156:159], v[124:127]
    s_waitcnt vmcnt(19) lgkmcnt(4)
    v_mfma_f32_16x16x32_bf16 v[96:99], a[60:63], v[160:163], v[96:99]
    v_mfma_f32_16x16x32_bf16 v[100:103], a[60:63], v[164:167], v[100:103]
    ds_read_b128 v[144:147], v15 offset:49152
    v_mfma_f32_16x16x32_bf16 v[104:107], a[60:63], v[168:171], v[104:107]
    ds_read_b128 v[148:151], v15 offset:51200
    v_mfma_f32_16x16x32_bf16 v[108:111], a[60:63], v[172:175], v[108:111]
    s_add_u32 m0, s81, 131072
    s_add_u32 s80, s79, 1152
    buffer_load_dwordx4 v10, s[24:27], s80 offen offset:0 lds
    ds_read_b128 v[152:155], v15 offset:53248
    v_mfma_f32_16x16x32_bf16 v[112:115], a[64:67], v[160:163], v[112:115]
    ds_read_b128 v[156:159], v15 offset:55296
    v_mfma_f32_16x16x32_bf16 v[116:119], a[64:67], v[164:167], v[116:119]
    v_mfma_f32_16x16x32_bf16 v[120:123], a[64:67], v[168:171], v[120:123]
    v_mfma_f32_16x16x32_bf16 v[124:127], a[64:67], v[172:175], v[124:127]
    buffer_load_dwordx4 v11, s[24:27], s80 offen offset:1024 lds
    s_barrier
    s_waitcnt vmcnt(19) lgkmcnt(4)
    v_mfma_f32_16x16x32_bf16 v[96:99], a[68:71], v[128:131], v[96:99]
    v_mfma_f32_16x16x32_bf16 v[100:103], a[68:71], v[132:135], v[100:103]
    ds_read_b128 v[160:163], v16 offset:0
    v_mfma_f32_16x16x32_bf16 v[104:107], a[68:71], v[136:139], v[104:107]
    ds_read_b128 v[164:167], v16 offset:2048
    v_mfma_f32_16x16x32_bf16 v[108:111], a[68:71], v[140:143], v[108:111]
    s_add_u32 m0, s81, 139264
    s_add_u32 s80, s79, 256
    buffer_load_dwordx4 v10, s[24:27], s80 offen offset:0 lds
    ds_read_b128 v[168:171], v16 offset:4096
    v_mfma_f32_16x16x32_bf16 v[112:115], a[72:75], v[128:131], v[112:115]
    ds_read_b128 v[172:175], v16 offset:6144
    v_mfma_f32_16x16x32_bf16 v[116:119], a[72:75], v[132:135], v[116:119]
    v_mfma_f32_16x16x32_bf16 v[120:123], a[72:75], v[136:139], v[120:123]
    v_mfma_f32_16x16x32_bf16 v[124:127], a[72:75], v[140:143], v[124:127]
    buffer_load_dwordx4 v11, s[24:27], s80 offen offset:1024 lds
    s_waitcnt vmcnt(19) lgkmcnt(4)
    v_mfma_f32_16x16x32_bf16 v[96:99], a[76:79], v[144:147], v[96:99]
    v_mfma_f32_16x16x32_bf16 v[100:103], a[76:79], v[148:151], v[100:103]
    ds_read_b128 v[128:131], v17 offset:0
    v_mfma_f32_16x16x32_bf16 v[104:107], a[76:79], v[152:155], v[104:107]
    ds_read_b128 v[132:135], v17 offset:2048
    v_mfma_f32_16x16x32_bf16 v[108:111], a[76:79], v[156:159], v[108:111]
    ds_read_b128 v[136:139], v17 offset:4096
    v_mfma_f32_16x16x32_bf16 v[112:115], a[80:83], v[144:147], v[112:115]
    s_add_u32 m0, s81, 147456
    s_add_u32 s80, s79, 1280
    buffer_load_dwordx4 v10, s[24:27], s80 offen offset:0 lds
    ds_read_b128 v[140:143], v17 offset:6144
    v_mfma_f32_16x16x32_bf16 v[116:119], a[80:83], v[148:151], v[116:119]
    v_mfma_f32_16x16x32_bf16 v[120:123], a[80:83], v[152:155], v[120:123]
    v_mfma_f32_16x16x32_bf16 v[124:127], a[80:83], v[156:159], v[124:127]
    s_waitcnt lgkmcnt(4)
    v_mfma_f32_16x16x32_bf16 v[96:99], a[84:87], v[160:163], v[96:99]
    buffer_load_dwordx4 v11, s[24:27], s80 offen offset:1024 lds
    v_mfma_f32_16x16x32_bf16 v[100:103], a[84:87], v[164:167], v[100:103]
    ds_read_b128 v[144:147], v16 offset:8192
    v_mfma_f32_16x16x32_bf16 v[104:107], a[84:87], v[168:171], v[104:107]
    ds_read_b128 v[148:151], v16 offset:10240
    v_mfma_f32_16x16x32_bf16 v[108:111], a[84:87], v[172:175], v[108:111]
    ds_read_b128 v[152:155], v16 offset:12288
    v_mfma_f32_16x16x32_bf16 v[112:115], a[88:91], v[160:163], v[112:115]
    ds_read_b128 v[156:159], v16 offset:14336
    v_mfma_f32_16x16x32_bf16 v[116:119], a[88:91], v[164:167], v[116:119]
    s_add_u32 m0, s81, 155648
    s_add_u32 s80, s79, 384
    buffer_load_dwordx4 v10, s[24:27], s80 offen offset:0 lds
    v_mfma_f32_16x16x32_bf16 v[120:123], a[88:91], v[168:171], v[120:123]
    v_mfma_f32_16x16x32_bf16 v[124:127], a[88:91], v[172:175], v[124:127]
    s_waitcnt lgkmcnt(4)
    v_mfma_f32_16x16x32_bf16 v[96:99], a[92:95], v[128:131], v[96:99]
    v_mfma_f32_16x16x32_bf16 v[100:103], a[92:95], v[132:135], v[100:103]
    ds_read_b128 v[160:163], v17 offset:8192
    v_mfma_f32_16x16x32_bf16 v[104:107], a[92:95], v[136:139], v[104:107]
    buffer_load_dwordx4 v11, s[24:27], s80 offen offset:1024 lds
    ds_read_b128 v[164:167], v17 offset:10240
    v_mfma_f32_16x16x32_bf16 v[108:111], a[92:95], v[140:143], v[108:111]
    ds_read_b128 v[168:171], v17 offset:12288
    v_mfma_f32_16x16x32_bf16 v[112:115], a[96:99], v[128:131], v[112:115]
    ds_read_b128 v[172:175], v17 offset:14336
    v_mfma_f32_16x16x32_bf16 v[116:119], a[96:99], v[132:135], v[116:119]
    v_mfma_f32_16x16x32_bf16 v[120:123], a[96:99], v[136:139], v[120:123]
    v_mfma_f32_16x16x32_bf16 v[124:127], a[96:99], v[140:143], v[124:127]
    s_add_u32 m0, s81, 65536
    s_add_u32 s80, s79, 1408
    buffer_load_dwordx4 v10, s[24:27], s80 offen offset:0 lds
    s_barrier
    s_waitcnt lgkmcnt(4)
    v_mfma_f32_16x16x32_bf16 v[96:99], a[100:103], v[144:147], v[96:99]
    v_mfma_f32_16x16x32_bf16 v[100:103], a[100:103], v[148:151], v[100:103]
    ds_read_b128 v[128:131], v12 offset:0
    v_mfma_f32_16x16x32_bf16 v[104:107], a[100:103], v[152:155], v[104:107]
    buffer_load_dwordx4 v11, s[24:27], s80 offen offset:1024 lds
    ds_read_b128 v[132:135], v12 offset:2048
    v_mfma_f32_16x16x32_bf16 v[108:111], a[100:103], v[156:159], v[108:111]
    ds_read_b128 v[136:139], v12 offset:4096
    v_mfma_f32_16x16x32_bf16 v[112:115], a[104:107], v[144:147], v[112:115]
    ds_read_b128 v[140:143], v12 offset:6144
    v_mfma_f32_16x16x32_bf16 v[116:119], a[104:107], v[148:151], v[116:119]
    v_mfma_f32_16x16x32_bf16 v[120:123], a[104:107], v[152:155], v[120:123]
    v_mfma_f32_16x16x32_bf16 v[124:127], a[104:107], v[156:159], v[124:127]
    s_add_u32 m0, s81, 73728
    s_add_u32 s80, s79, 512
    buffer_load_dwordx4 v10, s[24:27], s80 offen offset:0 lds
    s_waitcnt lgkmcnt(4)
    v_mfma_f32_16x16x32_bf16 v[96:99], a[108:111], v[160:163], v[96:99]
    v_mfma_f32_16x16x32_bf16 v[100:103], a[108:111], v[164:167], v[100:103]
    ds_read_b128 v[144:147], v13 offset:0
    v_mfma_f32_16x16x32_bf16 v[104:107], a[108:111], v[168:171], v[104:107]
    ds_read_b128 v[148:151], v13 offset:2048
    v_mfma_f32_16x16x32_bf16 v[108:111], a[108:111], v[172:175], v[108:111]
    ds_read_b128 v[152:155], v13 offset:4096
    v_mfma_f32_16x16x32_bf16 v[112:115], a[112:115], v[160:163], v[112:115]
    buffer_load_dwordx4 v11, s[24:27], s80 offen offset:1024 lds
    ds_read_b128 v[156:159], v13 offset:6144
    v_mfma_f32_16x16x32_bf16 v[116:119], a[112:115], v[164:167], v[116:119]
    v_mfma_f32_16x16x32_bf16 v[120:123], a[112:115], v[168:171], v[120:123]
    v_mfma_f32_16x16x32_bf16 v[124:127], a[112:115], v[172:175], v[124:127]
    s_waitcnt lgkmcnt(4)
    v_mfma_f32_16x16x32_bf16 v[96:99], a[116:119], v[128:131], v[96:99]
    v_mfma_f32_16x16x32_bf16 v[100:103], a[116:119], v[132:135], v[100:103]
    s_add_u32 m0, s81, 81920
    s_add_u32 s80, s79, 1536
    buffer_load_dwordx4 v10, s[24:27], s80 offen offset:0 lds
    ds_read_b128 v[160:163], v12 offset:8192
    v_mfma_f32_16x16x32_bf16 v[104:107], a[116:119], v[136:139], v[104:107]
    ds_read_b128 v[164:167], v12 offset:10240
    v_mfma_f32_16x16x32_bf16 v[108:111], a[116:119], v[140:143], v[108:111]
    ds_read_b128 v[168:171], v12 offset:12288
    v_mfma_f32_16x16x32_bf16 v[112:115], a[120:123], v[128:131], v[112:115]
    ds_read_b128 v[172:175], v12 offset:14336
    v_mfma_f32_16x16x32_bf16 v[116:119], a[120:123], v[132:135], v[116:119]
    v_mfma_f32_16x16x32_bf16 v[120:123], a[120:123], v[136:139], v[120:123]
    buffer_load_dwordx4 v11, s[24:27], s80 offen offset:1024 lds
    v_mfma_f32_16x16x32_bf16 v[124:127], a[120:123], v[140:143], v[124:127]
    s_waitcnt vmcnt(27) lgkmcnt(4)
    v_mfma_f32_16x16x32_bf16 v[96:99], a[124:127], v[144:147], v[96:99]
    v_mfma_f32_16x16x32_bf16 v[100:103], a[124:127], v[148:151], v[100:103]
    ds_read_b128 v[128:131], v13 offset:8192
    v_mfma_f32_16x16x32_bf16 v[104:107], a[124:127], v[152:155], v[104:107]
    ds_read_b128 v[132:135], v13 offset:10240
    v_mfma_f32_16x16x32_bf16 v[108:111], a[124:127], v[156:159], v[108:111]
    s_add_u32 m0, s81, 90112
    s_add_u32 s80, s79, 640
    buffer_load_dwordx4 v10, s[24:27], s80 offen offset:0 lds
    ds_read_b128 v[136:139], v13 offset:12288
    v_mfma_f32_16x16x32_bf16 v[112:115], a[128:131], v[144:147], v[112:115]
    ds_read_b128 v[140:143], v13 offset:14336
    v_mfma_f32_16x16x32_bf16 v[116:119], a[128:131], v[148:151], v[116:119]
    v_mfma_f32_16x16x32_bf16 v[120:123], a[128:131], v[152:155], v[120:123]
    v_mfma_f32_16x16x32_bf16 v[124:127], a[128:131], v[156:159], v[124:127]
    s_barrier
    s_waitcnt vmcnt(26) lgkmcnt(4)
    v_mfma_f32_16x16x32_bf16 v[96:99], a[132:135], v[160:163], v[96:99]
    buffer_load_dwordx4 v11, s[24:27], s80 offen offset:1024 lds
    ds_read_b128 v[144:147], v12 offset:16384
    v_mfma_f32_16x16x32_bf16 v[100:103], a[132:135], v[164:167], v[100:103]
    ds_read_b128 v[148:151], v12 offset:18432
    v_mfma_f32_16x16x32_bf16 v[104:107], a[132:135], v[168:171], v[104:107]
    ds_read_b128 v[152:155], v12 offset:20480
    v_mfma_f32_16x16x32_bf16 v[108:111], a[132:135], v[172:175], v[108:111]
    ds_read_b128 v[156:159], v12 offset:22528
    s_add_u32 m0, s81, 98304
    s_add_u32 s80, s79, 1664
    buffer_load_dwordx4 v10, s[24:27], s80 offen offset:0 lds
    v_mfma_f32_16x16x32_bf16 v[112:115], a[136:139], v[160:163], v[112:115]
    buffer_load_dword v27, v28, s[40:43], s53 offen sc1
    v_mfma_f32_16x16x32_bf16 v[116:119], a[136:139], v[164:167], v[116:119]
    v_mfma_f32_16x16x32_bf16 v[120:123], a[136:139], v[168:171], v[120:123]
    v_mfma_f32_16x16x32_bf16 v[124:127], a[136:139], v[172:175], v[124:127]
    s_waitcnt vmcnt(27) lgkmcnt(4)
    v_mfma_f32_16x16x32_bf16 v[96:99], a[140:143], v[128:131], v[96:99]
    v_mfma_f32_16x16x32_bf16 v[100:103], a[140:143], v[132:135], v[100:103]
    ds_read_b128 v[160:163], v13 offset:16384
    v_mfma_f32_16x16x32_bf16 v[104:107], a[140:143], v[136:139], v[104:107]
    buffer_load_dwordx4 v11, s[24:27], s80 offen offset:1024 lds
    ds_read_b128 v[164:167], v13 offset:18432
    v_mfma_f32_16x16x32_bf16 v[108:111], a[140:143], v[140:143], v[108:111]
    ds_read_b128 v[168:171], v13 offset:20480
    v_mfma_f32_16x16x32_bf16 v[112:115], a[144:147], v[128:131], v[112:115]
    ds_read_b128 v[172:175], v13 offset:22528
    v_mfma_f32_16x16x32_bf16 v[116:119], a[144:147], v[132:135], v[116:119]
    v_mfma_f32_16x16x32_bf16 v[120:123], a[144:147], v[136:139], v[120:123]
    v_mfma_f32_16x16x32_bf16 v[124:127], a[144:147], v[140:143], v[124:127]
    s_add_u32 m0, s81, 106496
    s_add_u32 s80, s79, 768
    buffer_load_dwordx4 v10, s[24:27], s80 offen offset:0 lds
    s_waitcnt vmcnt(26) lgkmcnt(4)
    v_mfma_f32_16x16x32_bf16 v[96:99], a[148:151], v[144:147], v[96:99]
    v_mfma_f32_16x16x32_bf16 v[100:103], a[148:151], v[148:151], v[100:103]
    ds_read_b128 v[128:131], v12 offset:24576
    v_mfma_f32_16x16x32_bf16 v[104:107], a[148:151], v[152:155], v[104:107]
    ds_read_b128 v[132:135], v12 offset:26624
    v_mfma_f32_16x16x32_bf16 v[108:111], a[148:151], v[156:159], v[108:111]
    ds_read_b128 v[136:139], v12 offset:28672
    v_mfma_f32_16x16x32_bf16 v[112:115], a[152:155], v[144:147], v[112:115]
    buffer_load_dwordx4 v11, s[24:27], s80 offen offset:1024 lds
    ds_read_b128 v[140:143], v12 offset:30720
    v_mfma_f32_16x16x32_bf16 v[116:119], a[152:155], v[148:151], v[116:119]
    v_mfma_f32_16x16x32_bf16 v[120:123], a[152:155], v[152:155], v[120:123]
    v_mfma_f32_16x16x32_bf16 v[124:127], a[152:155], v[156:159], v[124:127]
    s_waitcnt vmcnt(25) lgkmcnt(4)
    v_mfma_f32_16x16x32_bf16 v[96:99], a[156:159], v[160:163], v[96:99]
    v_mfma_f32_16x16x32_bf16 v[100:103], a[156:159], v[164:167], v[100:103]
    s_add_u32 m0, s81, 114688
    s_add_u32 s80, s79, 1792
    buffer_load_dwordx4 v10, s[24:27], s80 offen offset:0 lds
    ds_read_b128 v[144:147], v13 offset:24576
    v_mfma_f32_16x16x32_bf16 v[104:107], a[156:159], v[168:171], v[104:107]
    ds_read_b128 v[148:151], v13 offset:26624
    v_mfma_f32_16x16x32_bf16 v[108:111], a[156:159], v[172:175], v[108:111]
    ds_read_b128 v[152:155], v13 offset:28672
    v_mfma_f32_16x16x32_bf16 v[112:115], a[160:163], v[160:163], v[112:115]
    ds_read_b128 v[156:159], v13 offset:30720
    v_mfma_f32_16x16x32_bf16 v[116:119], a[160:163], v[164:167], v[116:119]
    v_mfma_f32_16x16x32_bf16 v[120:123], a[160:163], v[168:171], v[120:123]
    buffer_load_dwordx4 v11, s[24:27], s80 offen offset:1024 lds
    v_mfma_f32_16x16x32_bf16 v[124:127], a[160:163], v[172:175], v[124:127]
    s_barrier
    s_waitcnt vmcnt(25) lgkmcnt(4)
    v_mfma_f32_16x16x32_bf16 v[96:99], a[164:167], v[128:131], v[96:99]
    v_mfma_f32_16x16x32_bf16 v[100:103], a[164:167], v[132:135], v[100:103]
    ds_read_b128 v[160:163], v12 offset:32768
    s_add_u32 m0, s81, 122880
    s_add_u32 s80, s79, 896
    buffer_load_dwordx4 v10, s[24:27], s80 offen offset:0 lds
    v_mfma_f32_16x16x32_bf16 v[104:107], a[164:167], v[136:139], v[104:107]
    ds_read_b128 v[164:167], v12 offset:34816
    v_mfma_f32_16x16x32_bf16 v[108:111], a[164:167], v[140:143], v[108:111]
    ds_read_b128 v[168:171], v12 offset:36864
    v_mfma_f32_16x16x32_bf16 v[112:115], a[168:171], v[128:131], v[112:115]
    ds_read_b128 v[172:175], v12 offset:38912
    v_mfma_f32_16x16x32_bf16 v[116:119], a[168:171], v[132:135], v[116:119]
    v_mfma_f32_16x16x32_bf16 v[120:123], a[168:171], v[136:139], v[120:123]
    buffer_load_dwordx4 v11, s[24:27], s80 offen offset:1024 lds
    v_mfma_f32_16x16x32_bf16 v[124:127], a[168:171], v[140:143], v[124:127]
    s_waitcnt vmcnt(25) lgkmcnt(4)
    v_mfma_f32_16x16x32_bf16 v[96:99], a[172:175], v[144:147], v[96:99]
    v_mfma_f32_16x16x32_bf16 v[100:103], a[172:175], v[148:151], v[100:103]
    ds_read_b128 v[128:131], v13 offset:32768
    v_mfma_f32_16x16x32_bf16 v[104:107], a[172:175], v[152:155], v[104:107]
    ds_read_b128 v[132:135], v13 offset:34816
    v_mfma_f32_16x16x32_bf16 v[108:111], a[172:175], v[156:159], v[108:111]
    s_add_u32 m0, s81, 0
    s_add_u32 s80, s79, 1920
    buffer_load_dwordx4 v10, s[24:27], s80 offen offset:0 lds
    ds_read_b128 v[136:139], v13 offset:36864
    v_mfma_f32_16x16x32_bf16 v[112:115], a[176:179], v[144:147], v[112:115]
    ds_read_b128 v[140:143], v13 offset:38912
    v_mfma_f32_16x16x32_bf16 v[116:119], a[176:179], v[148:151], v[116:119]
    v_mfma_f32_16x16x32_bf16 v[120:123], a[176:179], v[152:155], v[120:123]
    v_mfma_f32_16x16x32_bf16 v[124:127], a[176:179], v[156:159], v[124:127]
    s_waitcnt lgkmcnt(4)
    v_mfma_f32_16x16x32_bf16 v[176:179], a[180:183], v[160:163], v[80:83]
    buffer_load_dwordx4 v11, s[24:27], s80 offen offset:1024 lds
    v_mfma_f32_16x16x32_bf16 v[180:183], a[180:183], v[164:167], v[84:87]
    ds_read_b128 v[144:147], v12 offset:40960
    v_mfma_f32_16x16x32_bf16 v[184:187], a[180:183], v[168:171], v[88:91]
    ds_read_b128 v[148:151], v12 offset:43008
    v_mfma_f32_16x16x32_bf16 v[188:191], a[180:183], v[172:175], v[92:95]
    ds_read_b128 v[152:155], v12 offset:45056
    v_mfma_f32_16x16x32_bf16 v[192:195], a[184:187], v[160:163], v[80:83]
    ds_read_b128 v[156:159], v12 offset:47104
    v_mfma_f32_16x16x32_bf16 v[196:199], a[184:187], v[164:167], v[84:87]
    s_add_u32 m0, s7, 8192
    s_add_u32 s69, s56, 0
    buffer_load_dwordx4 v24, s[16:19], s69 offen lds
    v_mfma_f32_16x16x32_bf16 v[200:203], a[184:187], v[168:171], v[88:91]
    v_mfma_f32_16x16x32_bf16 v[204:207], a[184:187], v[172:175], v[92:95]
    s_waitcnt vmcnt(10)
    v_cmp_eq_u32 vcc, s6, v27
    s_nop 0
    s_and_b64 s[48:49], vcc, s[44:45]
    s_cmp_eq_u64 s[48:49], s[44:45]
    s_cbranch_scc0 L_rare_61
L_back_62:
    s_waitcnt lgkmcnt(4)
    v_mfma_f32_16x16x32_bf16 v[176:179], a[188:191], v[128:131], v[176:179]
    ds_read_b128 v[160:163], v13 offset:40960
    v_mfma_f32_16x16x32_bf16 v[180:183], a[188:191], v[132:135], v[180:183]
    ds_read_b128 v[164:167], v13 offset:43008
    v_mfma_f32_16x16x32_bf16 v[184:187], a[188:191], v[136:139], v[184:187]
    ds_read_b128 v[168:171], v13 offset:45056
    v_mfma_f32_16x16x32_bf16 v[188:191], a[188:191], v[140:143], v[188:191]
    ds_read_b128 v[172:175], v13 offset:47104
    v_cvt_pk_bf16_f32 v60, v96, v97
    v_mfma_f32_16x16x32_bf16 v[192:195], a[192:195], v[128:131], v[192:195]
    v_cvt_pk_bf16_f32 v61, v98, v99
    v_mfma_f32_16x16x32_bf16 v[196:199], a[192:195], v[132:135], v[196:199]
    v_cvt_pk_bf16_f32 v62, v100, v101
    v_mfma_f32_16x16x32_bf16 v[200:203], a[192:195], v[136:139], v[200:203]
    v_cvt_pk_bf16_f32 v63, v102, v102
    v_mfma_f32_16x16x32_bf16 v[204:207], a[192:195], v[140:143], v[204:207]
    v_bfi_b32 v63, s74, v29, v63
    buffer_store_dwordx4 v[60:63], v21, s[40:43], s65 offen offset:0 sc1
    s_barrier
    s_waitcnt lgkmcnt(4)
    v_mfma_f32_16x16x32_bf16 v[176:179], a[196:199], v[144:147], v[176:179]
    buffer_load_dwordx4 a[180:183], v21, s[40:43], s64 offen offset:0 sc1
    ds_read_b128 v[128:131], v12 offset:49152
    s_add_u32 m0, s7, 12288
    s_add_u32 s69, s56, 32768
    buffer_load_dwordx4 v24, s[16:19], s69 offen lds
    v_mfma_f32_16x16x32_bf16 v[180:183], a[196:199], v[148:151], v[180:183]
    ds_read_b128 v[132:135], v12 offset:51200
    v_mfma_f32_16x16x32_bf16 v[184:187], a[196:199], v[152:155], v[184:187]
    ds_read_b128 v[136:139], v12 offset:53248
    v_mfma_f32_16x16x32_bf16 v[188:191], a[196:199], v[156:159], v[188:191]
    ds_read_b128 v[140:143], v12 offset:55296
    buffer_load_dwordx4 a[184:187], v21, s[40:43], s64 offen offset:1024 sc1
    v_cvt_pk_bf16_f32 v64, v103, v104
    v_mfma_f32_16x16x32_bf16 v[192:195], a[200:203], v[144:147], v[192:195]
    v_cvt_pk_bf16_f32 v65, v105, v106
    v_mfma_f32_16x16x32_bf16 v[196:199], a[200:203], v[148:151], v[196:199]
    v_cvt_pk_bf16_f32 v66, v107, v108
    v_mfma_f32_16x16x32_bf16 v[200:203], a[200:203], v[152:155], v[200:203]
    v_cvt_pk_bf16_f32 v67, v109, v109
    v_mfma_f32_16x16x32_bf16 v[204:207], a[200:203], v[156:159], v[204:207]
    v_bfi_b32 v67, s74, v29, v67
    buffer_store_dwordx4 v[64:67], v21, s[40:43], s65 offen offset:1024 sc1
    s_waitcnt lgkmcnt(4)
    v_mfma_f32_16x16x32_bf16 v[176:179], a[204:207], v[160:163], v[176:179]
    ds_read_b128 v[144:147], v13 offset:49152
    v_mfma_f32_16x16x32_bf16 v[180:183], a[204:207], v[164:167], v[180:183]
    ds_read_b128 v[148:151], v13 offset:51200
    v_mfma_f32_16x16x32_bf16 v[184:187], a[204:207], v[168:171], v[184:187]
    ds_read_b128 v[152:155], v13 offset:53248
    v_mfma_f32_16x16x32_bf16 v[188:191], a[204:207], v[172:175], v[188:191]
    ds_read_b128 v[156:159], v13 offset:55296
    v_cvt_pk_bf16_f32 v68, v110, v111
    v_mfma_f32_16x16x32_bf16 v[192:195], a[208:211], v[160:163], v[192:195]
    v_cvt_pk_bf16_f32 v69, v112, v113
    s_add_u32 m0, s7, 16384
    s_add_u32 s69, s56, 65536
    buffer_load_dwordx4 v24, s[16:19], s69 offen lds
    v_mfma_f32_16x16x32_bf16 v[196:199], a[208:211], v[164:167], v[196:199]
    v_cvt_pk_bf16_f32 v70, v114, v115
    v_mfma_f32_16x16x32_bf16 v[200:203], a[208:211], v[168:171], v[200:203]
    v_cvt_pk_bf16_f32 v71, v116, v116
    v_mfma_f32_16x16x32_bf16 v[204:207], a[208:211], v[172:175], v[204:207]
    v_bfi_b32 v71, s74, v29, v71
    buffer_store_dwordx4 v[68:71], v21, s[40:43], s65 offen offset:2048 sc1
    s_waitcnt lgkmcnt(4)
    v_mfma_f32_16x16x32_bf16 v[176:179], a[212:215], v[128:131], v[176:179]
    ds_read_b128 v[160:163], v16 offset:16384
    v_mfma_f32_16x16x32_bf16 v[180:183], a[212:215], v[132:135], v[180:183]
    ds_read_b128 v[164:167], v16 offset:18432
    v_mfma_f32_16x16x32_bf16 v[184:187], a[212:215], v[136:139], v[184:187]
    ds_read_b128 v[168:171], v16 offset:20480
    v_mfma_f32_16x16x32_bf16 v[188:191], a[212:215], v[140:143], v[188:191]
    ds_read_b128 v[172:175], v16 offset:22528
    v_cvt_pk_bf16_f32 v72, v117, v118
    v_mfma_f32_16x16x32_bf16 v[192:195], a[216:219], v[128:131], v[192:195]
    v_cvt_pk_bf16_f32 v73, v119, v120
    buffer_load_dwordx4 a[188:191], v21, s[40:43], s64 offen offset:2048 sc1
    v_mfma_f32_16x16x32_bf16 v[196:199], a[216:219], v[132:135], v[196:199]
    v_cvt_pk_bf16_f32 v74, v121, v122
    v_mfma_f32_16x16x32_bf16 v[200:203], a[216:219], v[136:139], v[200:203]
    v_cvt_pk_bf16_f32 v75, v123, v123
    v_mfma_f32_16x16x32_bf16 v[204:207], a[216:219], v[140:143], v[204:207]
    v_bfi_b32 v75, s74, v29, v75
    buffer_store_dwordx4 v[72:75], v21, s[40:43], s65 offen offset:3072 sc1
    s_waitcnt lgkmcnt(4)
    v_mfma_f32_16x16x32_bf16 v[176:179], a[220:223], v[144:147], v[176:179]
    ds_read_b128 v[128:131], v17 offset:16384
    v_mfma_f32_16x16x32_bf16 v[180:183], a[220:223], v[148:151], v[180:183]
    ds_read_b128 v[132:135], v17 offset:18432
    v_mfma_f32_16x16x32_bf16 v[184:187], a[220:223], v[152:155], v[184:187]
    ds_read_b128 v[136:139], v17 offset:20480
    v_mfma_f32_16x16x32_bf16 v[188:191], a[220:223], v[156:159], v[188:191]
    ds_read_b128 v[140:143], v17 offset:22528
    v_mfma_f32_16x16x32_bf16 v[192:195], a[224:227], v[144:147], v[192:195]
    v_cvt_pk_bf16_f32 v76, v124, v125
    s_add_u32 m0, s7, 20480
    s_add_u32 s69, s56, 98304
    buffer_load_dwordx4 v24, s[16:19], s69 offen lds
    v_mfma_f32_16x16x32_bf16 v[196:199], a[224:227], v[148:151], v[196:199]
    v_cvt_pk_bf16_f32 v77, v126, v127
    v_mfma_f32_16x16x32_bf16 v[200:203], a[224:227], v[152:155], v[200:203]
    v_cvt_pk_bf16_f32 v79, v127, v127
    v_mfma_f32_16x16x32_bf16 v[204:207], a[224:227], v[156:159], v[204:207]
    v_bfi_b32 v79, s74, v29, v79
    buffer_store_dwordx4 v[76:79], v19, s[40:43], s65 offen offset:0 sc1
    s_barrier
    s_waitcnt lgkmcnt(4)
    v_mfma_f32_16x16x32_bf16 v[176:179], a[228:231], v[160:163], v[176:179]
    v_mfma_f32_16x16x32_bf16 v[180:183], a[228:231], v[164:167], v[180:183]
    ds_read_b128 v[144:147], v16 offset:24576
    v_mfma_f32_16x16x32_bf16 v[184:187], a[228:231], v[168:171], v[184:187]
    ds_read_b128 v[148:151], v16 offset:26624
    v_mfma_f32_16x16x32_bf16 v[188:191], a[228:231], v[172:175], v[188:191]
    ds_read_b128 v[152:155], v16 offset:28672
    v_mfma_f32_16x16x32_bf16 v[192:195], a[232:235], v[160:163], v[192:195]
    ds_read_b128 v[156:159], v16 offset:30720
    v_mfma_f32_16x16x32_bf16 v[196:199], a[232:235], v[164:167], v[196:199]
    v_mfma_f32_16x16x32_bf16 v[200:203], a[232:235], v[168:171], v[200:203]
    v_mfma_f32_16x16x32_bf16 v[204:207], a[232:235], v[172:175], v[204:207]
    s_waitcnt lgkmcnt(4)
    v_mfma_f32_16x16x32_bf16 v[176:179], a[236:239], v[128:131], v[176:179]
    v_mfma_f32_16x16x32_bf16 v[180:183], a[236:239], v[132:135], v[180:183]
    ds_read_b128 v[160:163], v17 offset:24576
    v_mfma_f32_16x16x32_bf16 v[184:187], a[236:239], v[136:139], v[184:187]
    ds_read_b128 v[164:167], v17 offset:26624
    v_mfma_f32_16x16x32_bf16 v[188:191], a[236:239], v[140:143], v[188:191]
    ds_read_b128 v[168:171], v17 offset:28672
    v_mfma_f32_16x16x32_bf16 v[192:195], a[240:243], v[128:131], v[192:195]
    ds_read_b128 v[172:175], v17 offset:30720
    v_mfma_f32_16x16x32_bf16 v[196:199], a[240:243], v[132:135], v[196:199]
    buffer_load_dwordx4 a[192:195], v21, s[40:43], s64 offen offset:3072 sc1
    v_mfma_f32_16x16x32_bf16 v[200:203], a[240:243], v[136:139], v[200:203]
    v_mfma_f32_16x16x32_bf16 v[204:207], a[240:243], v[140:143], v[204:207]
    s_waitcnt lgkmcnt(4)
    v_mfma_f32_16x16x32_bf16 v[176:179], a[244:247], v[144:147], v[176:179]
    v_mfma_f32_16x16x32_bf16 v[180:183], a[244:247], v[148:151], v[180:183]
    ds_read_b128 v[128:131], v16 offset:32768
    v_mfma_f32_16x16x32_bf16 v[184:187], a[244:247], v[152:155], v[184:187]
    s_add_u32 m0, s7, 24576
    s_add_u32 s69, s56, 131072
    buffer_load_dwordx4 v24, s[16:19], s69 offen lds
    ds_read_b128 v[132:135], v16 offset:34816
    v_mfma_f32_16x16x32_bf16 v[188:191], a[244:247], v[156:159], v[188:191]
    ds_read_b128 v[136:139], v16 offset:36864
    v_mfma_f32_16x16x32_bf16 v[192:195], a[248:251], v[144:147], v[192:195]
    ds_read_b128 v[140:143], v16 offset:38912
    v_mfma_f32_16x16x32_bf16 v[196:199], a[248:251], v[148:151], v[196:199]
    v_mfma_f32_16x16x32_bf16 v[200:203], a[248:251], v[152:155], v[200:203]
    v_mfma_f32_16x16x32_bf16 v[204:207], a[248:251], v[156:159], v[204:207]
    s_add_u32 s64, s64, 4096
    buffer_load_dwordx4 a[196:199], v21, s[40:43], s64 offen offset:0 sc1
    s_waitcnt lgkmcnt(4)
    v_mfma_f32_16x16x32_bf16 v[176:179], a[252:255], v[160:163], v[176:179]
    v_mfma_f32_16x16x32_bf16 v[180:183], a[252:255], v[164:167], v[180:183]
    ds_read_b128 v[144:147], v17 offset:32768
    v_mfma_f32_16x16x32_bf16 v[184:187], a[252:255], v[168:171], v[184:187]
    ds_read_b128 v[148:151], v17 offset:34816
    v_mfma_f32_16x16x32_bf16 v[188:191], a[252:255], v[172:175], v[188:191]
    ds_read_b128 v[152:155], v17 offset:36864
    s_add_u32 m0, s7, 28672
    s_add_u32 s69, s56, 163840
    buffer_load_dwordx4 v24, s[16:19], s69 offen lds
    v_mfma_f32_16x16x32_bf16 v[192:195], a[0:3], v[160:163], v[192:195]
    ds_read_b128 v[156:159], v17 offset:38912
    v_mfma_f32_16x16x32_bf16 v[196:199], a[0:3], v[164:167], v[196:199]
    v_mfma_f32_16x16x32_bf16 v[200:203], a[0:3], v[168:171], v[200:203]
    v_mfma_f32_16x16x32_bf16 v[204:207], a[0:3], v[172:175], v[204:207]
    s_barrier
    s_waitcnt lgkmcnt(4)
    v_mfma_f32_16x16x32_bf16 v[176:179], a[4:7], v[128:131], v[176:179]
    buffer_load_dwordx4 a[200:203], v21, s[40:43], s64 offen offset:1024 sc1
    v_mfma_f32_16x16x32_bf16 v[180:183], a[4:7], v[132:135], v[180:183]
    ds_read_b128 v[160:163], v16 offset:40960
    v_mfma_f32_16x16x32_bf16 v[184:187], a[4:7], v[136:139], v[184:187]
    ds_read_b128 v[164:167], v16 offset:43008
    v_mfma_f32_16x16x32_bf16 v[188:191], a[4:7], v[140:143], v[188:191]
    s_add_u32 m0, s7, 32768
    s_add_u32 s69, s56, 196608
    buffer_load_dwordx4 v24, s[16:19], s69 offen lds
    ds_read_b128 v[168:171], v16 offset:45056
    v_mfma_f32_16x16x32_bf16 v[192:195], a[8:11], v[128:131], v[192:195]
    ds_read_b128 v[172:175], v16 offset:47104
    v_mfma_f32_16x16x32_bf16 v[196:199], a[8:11], v[132:135], v[196:199]
    v_mfma_f32_16x16x32_bf16 v[200:203], a[8:11], v[136:139], v[200:203]
    v_mfma_f32_16x16x32_bf16 v[204:207], a[8:11], v[140:143], v[204:207]
    buffer_load_dwordx4 a[204:207], v21, s[40:43], s64 offen offset:2048 sc1
    s_waitcnt lgkmcnt(4)
    v_mfma_f32_16x16x32_bf16 v[176:179], a[12:15], v[144:147], v[176:179]
    v_mfma_f32_16x16x32_bf16 v[180:183], a[12:15], v[148:151], v[180:183]
    ds_read_b128 v[128:131], v17 offset:40960
    v_mfma_f32_16x16x32_bf16 v[184:187], a[12:15], v[152:155], v[184:187]
    ds_read_b128 v[132:135], v17 offset:43008
    v_mfma_f32_16x16x32_bf16 v[188:191], a[12:15], v[156:159], v[188:191]
    ds_read_b128 v[136:139], v17 offset:45056
    v_mfma_f32_16x16x32_bf16 v[192:195], a[16:19], v[144:147], v[192:195]
    s_add_u32 m0, s7, 36864
    s_add_u32 s69, s56, 229376
    buffer_load_dwordx4 v24, s[16:19], s69 offen lds
    ds_read_b128 v[140:143], v17 offset:47104
    v_mfma_f32_16x16x32_bf16 v[196:199], a[16:19], v[148:151], v[196:199]
    v_mfma_f32_16x16x32_bf16 v[200:203], a[16:19], v[152:155], v[200:203]
    v_mfma_f32_16x16x32_bf16 v[204:207], a[16:19], v[156:159], v[204:207]
    s_waitcnt lgkmcnt(4)
    v_mfma_f32_16x16x32_bf16 v[176:179], a[20:23], v[160:163], v[176:179]
    buffer_load_dwordx4 a[208:211], v21, s[40:43], s64 offen offset:3072 sc1
    v_mfma_f32_16x16x32_bf16 v[180:183], a[20:23], v[164:167], v[180:183]
    ds_read_b128 v[144:147], v14 offset:8192
    v_mfma_f32_16x16x32_bf16 v[184:187], a[20:23], v[168:171], v[184:187]
    ds_read_b128 v[148:151], v14 offset:10240
    v_mfma_f32_16x16x32_bf16 v[188:191], a[20:23], v[172:175], v[188:191]
    ds_read_b128 v[152:155], v14 offset:12288
    v_mfma_f32_16x16x32_bf16 v[192:195], a[24:27], v[160:163], v[192:195]
    ds_read_b128 v[156:159], v14 offset:14336
    v_mfma_f32_16x16x32_bf16 v[196:199], a[24:27], v[164:167], v[196:199]
    s_add_u32 m0, s7, 40960
    s_add_u32 s69, s56, 262144
    buffer_load_dwordx4 v24, s[16:19], s69 offen lds
    v_mfma_f32_16x16x32_bf16 v[200:203], a[24:27], v[168:171], v[200:203]
    v_mfma_f32_16x16x32_bf16 v[204:207], a[24:27], v[172:175], v[204:207]
    s_waitcnt lgkmcnt(4)
    v_mfma_f32_16x16x32_bf16 v[176:179], a[28:31], v[128:131], v[176:179]
    v_mfma_f32_16x16x32_bf16 v[180:183], a[28:31], v[132:135], v[180:183]
    s_add_u32 s64, s64, 4096
    buffer_load_dwordx4 a[212:215], v21, s[40:43], s64 offen offset:0 sc1
    ds_read_b128 v[160:163], v15 offset:8192
    v_mfma_f32_16x16x32_bf16 v[184:187], a[28:31], v[136:139], v[184:187]
    ds_read_b128 v[164:167], v15 offset:10240
    v_mfma_f32_16x16x32_bf16 v[188:191], a[28:31], v[140:143], v[188:191]
    ds_read_b128 v[168:171], v15 offset:12288
    v_mfma_f32_16x16x32_bf16 v[192:195], a[32:35], v[128:131], v[192:195]
    ds_read_b128 v[172:175], v15 offset:14336
    v_mfma_f32_16x16x32_bf16 v[196:199], a[32:35], v[132:135], v[196:199]
    v_mfma_f32_16x16x32_bf16 v[200:203], a[32:35], v[136:139], v[200:203]
    s_add_u32 m0, s7, 45056
    s_add_u32 s69, s56, 294912
    buffer_load_dwordx4 v24, s[16:19], s69 offen lds
    v_mfma_f32_16x16x32_bf16 v[204:207], a[32:35], v[140:143], v[204:207]
    s_barrier
    s_waitcnt lgkmcnt(4)
    v_mfma_f32_16x16x32_bf16 v[176:179], a[36:39], v[144:147], v[176:179]
    v_mfma_f32_16x16x32_bf16 v[180:183], a[36:39], v[148:151], v[180:183]
    ds_read_b128 v[128:131], v14 offset:16384
    buffer_load_dwordx4 v[60:63], v21, s[40:43], s72 offen offset:0 sc1
    v_mfma_f32_16x16x32_bf16 v[184:187], a[36:39], v[152:155], v[184:187]
    ds_read_b128 v[132:135], v14 offset:18432
    v_mfma_f32_16x16x32_bf16 v[188:191], a[36:39], v[156:159], v[188:191]
    ds_read_b128 v[136:139], v14 offset:20480
    v_mfma_f32_16x16x32_bf16 v[192:195], a[40:43], v[144:147], v[192:195]
    ds_read_b128 v[140:143], v14 offset:22528
    v_mfma_f32_16x16x32_bf16 v[196:199], a[40:43], v[148:151], v[196:199]
    v_mfma_f32_16x16x32_bf16 v[200:203], a[40:43], v[152:155], v[200:203]
    v_mfma_f32_16x16x32_bf16 v[204:207], a[40:43], v[156:159], v[204:207]
    buffer_load_dwordx4 v[64:67], v21, s[40:43], s72 offen offset:1024 sc1
    s_waitcnt lgkmcnt(4)
    v_mfma_f32_16x16x32_bf16 v[176:179], a[44:47], v[160:163], v[176:179]
    v_mfma_f32_16x16x32_bf16 v[180:183], a[44:47], v[164:167], v[180:183]
    ds_read_b128 v[144:147], v15 offset:16384
    v_mfma_f32_16x16x32_bf16 v[184:187], a[44:47], v[168:171], v[184:187]
    ds_read_b128 v[148:151], v15 offset:18432
    v_mfma_f32_16x16x32_bf16 v[188:191], a[44:47], v[172:175], v[188:191]
    ds_read_b128 v[152:155], v15 offset:20480
    buffer_load_dwordx4 v[68:71], v21, s[40:43], s72 offen offset:2048 sc1
    v_mfma_f32_16x16x32_bf16 v[192:195], a[48:51], v[160:163], v[192:195]
    ds_read_b128 v[156:159], v15 offset:22528
    v_mfma_f32_16x16x32_bf16 v[196:199], a[48:51], v[164:167], v[196:199]
    v_mfma_f32_16x16x32_bf16 v[200:203], a[48:51], v[168:171], v[200:203]
    v_mfma_f32_16x16x32_bf16 v[204:207], a[48:51], v[172:175], v[204:207]
    s_waitcnt lgkmcnt(4)
    v_mfma_f32_16x16x32_bf16 v[176:179], a[52:55], v[128:131], v[176:179]
    v_mfma_f32_16x16x32_bf16 v[180:183], a[52:55], v[132:135], v[180:183]
    buffer_load_dwordx4 v[72:75], v21, s[40:43], s72 offen offset:3072 sc1
    ds_read_b128 v[160:163], v14 offset:24576
    v_mfma_f32_16x16x32_bf16 v[184:187], a[52:55], v[136:139], v[184:187]
    ds_read_b128 v[164:167], v14 offset:26624
    v_mfma_f32_16x16x32_bf16 v[188:191], a[52:55], v[140:143], v[188:191]
    ds_read_b128 v[168:171], v14 offset:28672
    v_mfma_f32_16x16x32_bf16 v[192:195], a[56:59], v[128:131], v[192:195]
    ds_read_b128 v[172:175], v14 offset:30720
    v_mfma_f32_16x16x32_bf16 v[196:199], a[56:59], v[132:135], v[196:199]
    v_mfma_f32_16x16x32_bf16 v[200:203], a[56:59], v[136:139], v[200:203]
    buffer_load_dwordx4 v[76:79], v19, s[40:43], s72 offen offset:0 sc1
    v_mfma_f32_16x16x32_bf16 v[204:207], a[56:59], v[140:143], v[204:207]
    s_waitcnt lgkmcnt(4)
    v_mfma_f32_16x16x32_bf16 v[176:179], a[60:63], v[144:147], v[176:179]
    v_mfma_f32_16x16x32_bf16 v[180:183], a[60:63], v[148:151], v[180:183]
    ds_read_b128 v[128:131], v15 offset:24576
    v_mfma_f32_16x16x32_bf16 v[184:187], a[60:63], v[152:155], v[184:187]
    ds_read_b128 v[132:135], v15 offset:26624
    v_mfma_f32_16x16x32_bf16 v[188:191], a[60:63], v[156:159], v[188:191]
    ds_read_b128 v[136:139], v15 offset:28672
    v_mfma_f32_16x16x32_bf16 v[192:195], a[64:67], v[144:147], v[192:195]
    ds_read_b128 v[140:143], v15 offset:30720
    v_mfma_f32_16x16x32_bf16 v[196:199], a[64:67], v[148:151], v[196:199]
    buffer_load_dwordx4 a[216:219], v21, s[40:43], s64 offen offset:1024 sc1
    v_mfma_f32_16x16x32_bf16 v[200:203], a[64:67], v[152:155], v[200:203]
    v_mfma_f32_16x16x32_bf16 v[204:207], a[64:67], v[156:159], v[204:207]
    s_waitcnt vmcnt(38)
    s_barrier
    s_waitcnt lgkmcnt(4)
    v_mfma_f32_16x16x32_bf16 v[176:179], a[68:71], v[160:163], v[176:179]
    s_add_u32 m0, s7, 49152
    s_add_u32 s69, s56, 327680
    buffer_load_dwordx4 v24, s[16:19], s69 offen lds
    v_mfma_f32_16x16x32_bf16 v[180:183], a[68:71], v[164:167], v[180:183]
    ds_read_b128 v[144:147], v14 offset:32768
    v_mfma_f32_16x16x32_bf16 v[184:187], a[68:71], v[168:171], v[184:187]
    ds_read_b128 v[148:151], v14 offset:34816
    v_mfma_f32_16x16x32_bf16 v[188:191], a[68:71], v[172:175], v[188:191]
    ds_read_b128 v[152:155], v14 offset:36864
    v_mfma_f32_16x16x32_bf16 v[192:195], a[72:75], v[160:163], v[192:195]
    ds_read_b128 v[156:159], v14 offset:38912
    v_mfma_f32_16x16x32_bf16 v[196:199], a[72:75], v[164:167], v[196:199]
    buffer_load_dwordx4 a[220:223], v21, s[40:43], s64 offen offset:2048 sc1
    v_mfma_f32_16x16x32_bf16 v[200:203], a[72:75], v[168:171], v[200:203]
    v_mfma_f32_16x16x32_bf16 v[204:207], a[72:75], v[172:175], v[204:207]
    s_waitcnt lgkmcnt(4)
    v_mfma_f32_16x16x32_bf16 v[176:179], a[76:79], v[128:131], v[176:179]
    v_mfma_f32_16x16x32_bf16 v[180:183], a[76:79], v[132:135], v[180:183]
    ds_read_b128 v[160:163], v15 offset:32768
    v_mfma_f32_16x16x32_bf16 v[184:187], a[76:79], v[136:139], v[184:187]
    s_add_u32 m0, s7, 53248
    s_add_u32 s69, s56, 360448
    buffer_load_dwordx4 v24, s[16:19], s69 offen lds
    ds_read_b128 v[164:167], v15 offset:34816
    v_mfma_f32_16x16x32_bf16 v[188:191], a[76:79], v[140:143], v[188:191]
    ds_read_b128 v[168:171], v15 offset:36864
    v_mfma_f32_16x16x32_bf16 v[192:195], a[80:83], v[128:131], v[192:195]
    ds_read_b128 v[172:175], v15 offset:38912
    v_mfma_f32_16x16x32_bf16 v[196:199], a[80:83], v[132:135], v[196:199]
    v_mfma_f32_16x16x32_bf16 v[200:203], a[80:83], v[136:139], v[200:203]
    v_mfma_f32_16x16x32_bf16 v[204:207], a[80:83], v[140:143], v[204:207]
    buffer_load_dwordx4 a[224:227], v21, s[40:43], s64 offen offset:3072 sc1
    s_waitcnt lgkmcnt(4)
    v_mfma_f32_16x16x32_bf16 v[176:179], a[84:87], v[144:147], v[176:179]
    v_mfma_f32_16x16x32_bf16 v[180:183], a[84:87], v[148:151], v[180:183]
    ds_read_b128 v[128:131], v14 offset:40960
    v_mfma_f32_16x16x32_bf16 v[184:187], a[84:87], v[152:155], v[184:187]
    ds_read_b128 v[132:135], v14 offset:43008
    v_mfma_f32_16x16x32_bf16 v[188:191], a[84:87], v[156:159], v[188:191]
    ds_read_b128 v[136:139], v14 offset:45056
    s_add_u32 m0, s7, 131072
    s_add_u32 s69, s56, 393216
    buffer_load_dwordx4 v24, s[16:19], s69 offen lds
    v_mfma_f32_16x16x32_bf16 v[192:195], a[88:91], v[144:147], v[192:195]
    ds_read_b128 v[140:143], v14 offset:47104
    v_mfma_f32_16x16x32_bf16 v[196:199], a[88:91], v[148:151], v[196:199]
    v_mfma_f32_16x16x32_bf16 v[200:203], a[88:91], v[152:155], v[200:203]
    v_mfma_f32_16x16x32_bf16 v[204:207], a[88:91], v[156:159], v[204:207]
    s_waitcnt lgkmcnt(4)
    v_mfma_f32_16x16x32_bf16 v[176:179], a[92:95], v[160:163], v[176:179]
    v_mfma_f32_16x16x32_bf16 v[180:183], a[92:95], v[164:167], v[180:183]
    s_add_u32 s64, s64, 4096
    buffer_load_dwordx4 a[228:231], v21, s[40:43], s64 offen offset:0 sc1
    ds_read_b128 v[144:147], v15 offset:40960
    v_mfma_f32_16x16x32_bf16 v[184:187], a[92:95], v[168:171], v[184:187]
    ds_read_b128 v[148:151], v15 offset:43008
    v_mfma_f32_16x16x32_bf16 v[188:191], a[92:95], v[172:175], v[188:191]
    ds_read_b128 v[152:155], v15 offset:45056
    v_mfma_f32_16x16x32_bf16 v[192:195], a[96:99], v[160:163], v[192:195]
    ds_read_b128 v[156:159], v15 offset:47104
    v_mfma_f32_16x16x32_bf16 v[196:199], a[96:99], v[164:167], v[196:199]
    v_mfma_f32_16x16x32_bf16 v[200:203], a[96:99], v[168:171], v[200:203]
    v_mfma_f32_16x16x32_bf16 v[204:207], a[96:99], v[172:175], v[204:207]
    s_waitcnt vmcnt(40)
    s_barrier
    s_waitcnt lgkmcnt(4)
    v_mfma_f32_16x16x32_bf16 v[176:179], a[100:103], v[128:131], v[176:179]
    s_add_u32 m0, s7, 135168
    s_add_u32 s69, s56, 425984
    buffer_load_dwordx4 v24, s[16:19], s69 offen lds
    v_mfma_f32_16x16x32_bf16 v[180:183], a[100:103], v[132:135], v[180:183]
    ds_read_b128 v[160:163], v14 offset:49152
    v_mfma_f32_16x16x32_bf16 v[184:187], a[100:103], v[136:139], v[184:187]
    ds_read_b128 v[164:167], v14 offset:51200
    v_mfma_f32_16x16x32_bf16 v[188:191], a[100:103], v[140:143], v[188:191]
    ds_read_b128 v[168:171], v14 offset:53248
    v_mfma_f32_16x16x32_bf16 v[192:195], a[104:107], v[128:131], v[192:195]
    ds_read_b128 v[172:175], v14 offset:55296
    v_mfma_f32_16x16x32_bf16 v[196:199], a[104:107], v[132:135], v[196:199]
    buffer_load_dwordx4 a[232:235], v21, s[40:43], s64 offen offset:1024 sc1
    v_mfma_f32_16x16x32_bf16 v[200:203], a[104:107], v[136:139], v[200:203]
    v_mfma_f32_16x16x32_bf16 v[204:207], a[104:107], v[140:143], v[204:207]
    s_waitcnt lgkmcnt(4)
    v_mfma_f32_16x16x32_bf16 v[176:179], a[108:111], v[144:147], v[176:179]
    v_mfma_f32_16x16x32_bf16 v[180:183], a[108:111], v[148:151], v[180:183]
    ds_read_b128 v[128:131], v15 offset:49152
    v_mfma_f32_16x16x32_bf16 v[184:187], a[108:111], v[152:155], v[184:187]
    ds_read_b128 v[132:135], v15 offset:51200
    v_mfma_f32_16x16x32_bf16 v[188:191], a[108:111], v[156:159], v[188:191]
    ds_read_b128 v[136:139], v15 offset:53248
    v_mfma_f32_16x16x32_bf16 v[192:195], a[112:115], v[144:147], v[192:195]
    s_add_u32 m0, s7, 139264
    s_add_u32 s69, s56, 458752
    buffer_load_dwordx4 v24, s[16:19], s69 offen lds
    ds_read_b128 v[140:143], v15 offset:55296
    v_mfma_f32_16x16x32_bf16 v[196:199], a[112:115], v[148:151], v[196:199]
    v_mfma_f32_16x16x32_bf16 v[200:203], a[112:115], v[152:155], v[200:203]
    v_mfma_f32_16x16x32_bf16 v[204:207], a[112:115], v[156:159], v[204:207]
    s_waitcnt lgkmcnt(4)
    v_mfma_f32_16x16x32_bf16 v[176:179], a[116:119], v[160:163], v[176:179]
    v_mfma_f32_16x16x32_bf16 v[180:183], a[116:119], v[164:167], v[180:183]
    ds_read_b128 v[144:147], v16 offset:0
    v_mfma_f32_16x16x32_bf16 v[184:187], a[116:119], v[168:171], v[184:187]
    ds_read_b128 v[148:151], v16 offset:2048
    v_mfma_f32_16x16x32_bf16 v[188:191], a[116:119], v[172:175], v[188:191]
    buffer_load_dwordx4 a[236:239], v21, s[40:43], s64 offen offset:2048 sc1
    ds_read_b128 v[152:155], v16 offset:4096
    v_mfma_f32_16x16x32_bf16 v[192:195], a[120:123], v[160:163], v[192:195]
    ds_read_b128 v[156:159], v16 offset:6144
    v_mfma_f32_16x16x32_bf16 v[196:199], a[120:123], v[164:167], v[196:199]
    v_mfma_f32_16x16x32_bf16 v[200:203], a[120:123], v[168:171], v[200:203]
    v_mfma_f32_16x16x32_bf16 v[204:207], a[120:123], v[172:175], v[204:207]
    s_waitcnt vmcnt(11)
    v_xor_b32 v18, v63, v29
    s_add_u32 m0, s7, 143360
    s_add_u32 s69, s56, 491520
    buffer_load_dwordx4 v24, s[16:19], s69 offen lds
    v_bitop3_b32 v18, v67, v29, v18 bitop3:0xbe
    v_bitop3_b32 v18, v71, v29, v18 bitop3:0xbe
    v_bitop3_b32 v18, v75, v29, v18 bitop3:0xbe
    v_bitop3_b32 v18, v79, v29, v18 bitop3:0xbe
    v_and_b32 v18, s74, v18
    v_cmp_ne_u32 vcc, 0, v18
    s_nop 0
    s_cmp_eq_u64 vcc, 0
    s_cbranch_scc0 L_rare_65
L_back_66:
    s_or_b32 s67, s4, s55
    s_cmp_eq_u32 s67, 0
    s_cselect_b32 s67, 0, 1073741824
    s_add_u32 s84, s84, 1
    v_mov_b32 v27, s84
    buffer_store_dword v27, v30, s[40:43], s67 offen sc1
    s_waitcnt lgkmcnt(4)
    v_mfma_f32_16x16x32_bf16 v[176:179], a[124:127], v[128:131], v[176:179]
    ds_read_b128 v[160:163], v17 offset:0
    v_mfma_f32_16x16x32_bf16 v[180:183], a[124:127], v[132:135], v[180:183]
    ds_read_b128 v[164:167], v17 offset:2048
    ds_read_b128 v[168:171], v17 offset:4096
    v_mfma_f32_16x16x32_bf16 v[184:187], a[124:127], v[136:139], v[184:187]
    ds_read_b128 v[172:175], v17 offset:6144
    v_lshlrev_b32 v96, 16, v60
    v_mfma_f32_16x16x32_bf16 v[188:191], a[124:127], v[140:143], v[188:191]
    v_mul_f32 v96, v96, v224
    v_and_b32 v97, s62, v60
    v_mfma_f32_16x16x32_bf16 v[192:195], a[128:131], v[128:131], v[192:195]
    buffer_load_dwordx4 a[240:243], v21, s[40:43], s64 offen offset:3072 sc1
    v_mul_f32 v97, v97, v225
    v_mfma_f32_16x16x32_bf16 v[196:199], a[128:131], v[132:135], v[196:199]
    v_lshlrev_b32 v98, 16, v61
    v_mul_f32 v98, v98, v226
    v_mfma_f32_16x16x32_bf16 v[200:203], a[128:131], v[136:139], v[200:203]
    v_and_b32 v99, s62, v61
    v_mul_f32 v99, v99, v227
    v_mfma_f32_16x16x32_bf16 v[204:207], a[128:131], v[140:143], v[204:207]
    v_lshlrev_b32 v100, 16, v62
    v_mul_f32 v100, v100, v228
    s_barrier
    s_waitcnt lgkmcnt(4)
    v_mfma_f32_16x16x32_bf16 v[176:179], a[132:135], v[144:147], v[176:179]
    s_add_u32 m0, s7, 57344
    s_add_u32 s69, s58, 0
    buffer_load_dwordx4 v24, s[32:35], s69 offen lds
    ds_read_b128 v[128:131], v16 offset:8192
    v_mfma_f32_16x16x32_bf16 v[180:183], a[132:135], v[148:151], v[180:183]
    ds_read_b128 v[132:135], v16 offset:10240
    ds_read_b128 v[136:139], v16 offset:12288
    v_mfma_f32_16x16x32_bf16 v[184:187], a[132:135], v[152:155], v[184:187]
    ds_read_b128 v[140:143], v16 offset:14336
    v_and_b32 v101, s62, v62
    v_mfma_f32_16x16x32_bf16 v[188:191], a[132:135], v[156:159], v[188:191]
    v_mul_f32 v101, v101, v229
    v_and_b32 v102, s62, v63
    v_mfma_f32_16x16x32_bf16 v[192:195], a[136:139], v[144:147], v[192:195]
    s_add_u32 m0, s7, 61440
    s_add_u32 s69, s58, 32768
    buffer_load_dwordx4 v24, s[32:35], s69 offen lds
    v_mul_f32 v102, v102, v230
    v_mfma_f32_16x16x32_bf16 v[196:199], a[136:139], v[148:151], v[196:199]
    v_lshlrev_b32 v103, 16, v64
    v_mul_f32 v103, v103, v231
    v_mfma_f32_16x16x32_bf16 v[200:203], a[136:139], v[152:155], v[200:203]
    v_and_b32 v104, s62, v64
    v_mul_f32 v104, v104, v232
    v_mfma_f32_16x16x32_bf16 v[204:207], a[136:139], v[156:159], v[204:207]
    v_lshlrev_b32 v105, 16, v65
    v_mul_f32 v105, v105, v233
    s_waitcnt lgkmcnt(4)
    v_mfma_f32_16x16x32_bf16 v[176:179], a[140:143], v[160:163], v[176:179]
    s_add_u32 m0, s7, 147456
    s_add_u32 s69, s58, 65536
    buffer_load_dwordx4 v24, s[32:35], s69 offen lds
    ds_read_b128 v[144:147], v17 offset:8192
    v_mfma_f32_16x16x32_bf16 v[180:183], a[140:143], v[164:167], v[180:183]
    ds_read_b128 v[148:151], v17 offset:10240
    ds_read_b128 v[152:155], v17 offset:12288
    v_mfma_f32_16x16x32_bf16 v[184:187], a[140:143], v[168:171], v[184:187]
    ds_read_b128 v[156:159], v17 offset:14336
    v_and_b32 v106, s62, v65
    v_mfma_f32_16x16x32_bf16 v[188:191], a[140:143], v[172:175], v[188:191]
    v_mul_f32 v106, v106, v234
    v_lshlrev_b32 v107, 16, v66
    v_mfma_f32_16x16x32_bf16 v[192:195], a[144:147], v[160:163], v[192:195]
    v_mul_f32 v107, v107, v235
    v_mfma_f32_16x16x32_bf16 v[196:199], a[144:147], v[164:167], v[196:199]
    s_add_u32 m0, s7, 151552
    s_add_u32 s69, s58, 98304
    buffer_load_dwordx4 v24, s[32:35], s69 offen lds
    v_and_b32 v108, s62, v66
    v_mul_f32 v108, v108, v236
    v_mfma_f32_16x16x32_bf16 v[200:203], a[144:147], v[168:171], v[200:203]
    v_and_b32 v109, s62, v67
    v_mul_f32 v109, v109, v237
    v_mfma_f32_16x16x32_bf16 v[204:207], a[144:147], v[172:175], v[204:207]
    v_lshlrev_b32 v110, 16, v68
    v_mul_f32 v110, v110, v238
    s_waitcnt lgkmcnt(4)
    v_mfma_f32_16x16x32_bf16 v[176:179], a[148:151], v[128:131], v[176:179]
    ds_read_b128 v[160:163], v12 offset:0
    v_mfma_f32_16x16x32_bf16 v[180:183], a[148:151], v[132:135], v[180:183]
    s_add_u32 m0, s7, 155648
    s_add_u32 s69, s58, 131072
    buffer_load_dwordx4 v24, s[32:35], s69 offen lds
    ds_read_b128 v[164:167], v12 offset:2048
    ds_read_b128 v[168:171], v12 offset:4096
    v_mfma_f32_16x16x32_bf16 v[184:187], a[148:151], v[136:139], v[184:187]
    ds_read_b128 v[172:175], v12 offset:6144
    v_and_b32 v111, s62, v68
    v_mfma_f32_16x16x32_bf16 v[188:191], a[148:151], v[140:143], v[188:191]
    v_mul_f32 v111, v111, v239
    v_lshlrev_b32 v112, 16, v69
    v_mfma_f32_16x16x32_bf16 v[192:195], a[152:155], v[128:131], v[192:195]
    v_mul_f32 v112, v112, v240
    v_mfma_f32_16x16x32_bf16 v[196:199], a[152:155], v[132:135], v[196:199]
    s_add_u32 m0, s7, 159744
    s_add_u32 s69, s58, 163840
    buffer_load_dwordx4 v24, s[32:35], s69 offen lds
    v_and_b32 v113, s62, v69
    v_mul_f32 v113, v113, v241
    v_mfma_f32_16x16x32_bf16 v[200:203], a[152:155], v[136:139], v[200:203]
    v_lshlrev_b32 v114, 16, v70
    v_mul_f32 v114, v114, v242
    v_mfma_f32_16x16x32_bf16 v[204:207], a[152:155], v[140:143], v[204:207]
    v_and_b32 v115, s62, v70
    v_mul_f32 v115, v115, v243
    s_waitcnt lgkmcnt(4)
    v_mfma_f32_16x16x32_bf16 v[176:179], a[156:159], v[144:147], v[176:179]
    ds_read_b128 v[128:131], v13 offset:0
    v_mfma_f32_16x16x32_bf16 v[180:183], a[156:159], v[148:151], v[180:183]
    s_add_u32 m0, s7, 65536
    s_add_u32 s69, s58, 196608
    buffer_load_dwordx4 v24, s[32:35], s69 offen lds
    ds_read_b128 v[132:135], v13 offset:2048
    ds_read_b128 v[136:139], v13 offset:4096
    v_mfma_f32_16x16x32_bf16 v[184:187], a[156:159], v[152:155], v[184:187]
    ds_read_b128 v[140:143], v13 offset:6144
    v_and_b32 v116, s62, v71
    v_mfma_f32_16x16x32_bf16 v[188:191], a[156:159], v[156:159], v[188:191]
    v_mul_f32 v116, v116, v244
    v_lshlrev_b32 v117, 16, v72
    v_mfma_f32_16x16x32_bf16 v[192:195], a[160:163], v[144:147], v[192:195]
    v_mul_f32 v117, v117, v245
    v_mfma_f32_16x16x32_bf16 v[196:199], a[160:163], v[148:151], v[196:199]
    s_add_u32 m0, s7, 69632
    s_add_u32 s69, s58, 229376
    buffer_load_dwordx4 v24, s[32:35], s69 offen lds
    v_and_b32 v118, s62, v72
    v_mul_f32 v118, v118, v246
    v_mfma_f32_16x16x32_bf16 v[200:203], a[160:163], v[152:155], v[200:203]
    v_lshlrev_b32 v119, 16, v73
    v_mul_f32 v119, v119, v247
    v_mfma_f32_16x16x32_bf16 v[204:207], a[160:163], v[156:159], v[204:207]
    v_and_b32 v120, s62, v73
    v_mul_f32 v120, v120, v248
    s_waitcnt lgkmcnt(4)
    v_mfma_f32_16x16x32_bf16 v[176:179], a[164:167], v[160:163], v[176:179]
    v_lshlrev_b32 v121, 16, v74
    v_mfma_f32_16x16x32_bf16 v[180:183], a[164:167], v[164:167], v[180:183]
    s_add_u32 m0, s7, 73728
    s_add_u32 s69, s58, 262144
    buffer_load_dwordx4 v24, s[32:35], s69 offen lds
    v_mul_f32 v121, v121, v249
    v_mfma_f32_16x16x32_bf16 v[184:187], a[164:167], v[168:171], v[184:187]
    v_and_b32 v122, s62, v74
    v_mfma_f32_16x16x32_bf16 v[188:191], a[164:167], v[172:175], v[188:191]
    v_mul_f32 v122, v122, v250
    v_and_b32 v123, s62, v75
    v_mfma_f32_16x16x32_bf16 v[192:195], a[168:171], v[160:163], v[192:195]
    v_mul_f32 v123, v123, v251
    v_mfma_f32_16x16x32_bf16 v[196:199], a[168:171], v[164:167], v[196:199]
    s_add_u32 m0, s7, 77824
    s_add_u32 s69, s58, 294912
    buffer_load_dwordx4 v24, s[32:35], s69 offen lds
    v_lshlrev_b32 v124, 16, v76
    v_mfma_f32_16x16x32_bf16 v[200:203], a[168:171], v[168:171], v[200:203]
    v_mul_f32 v124, v124, v252
    v_mfma_f32_16x16x32_bf16 v[204:207], a[168:171], v[172:175], v[204:207]
    v_and_b32 v125, s62, v76
    v_mul_f32 v125, v125, v253
    s_waitcnt lgkmcnt(0)
    s_barrier
    v_mfma_f32_16x16x32_bf16 v[176:179], a[172:175], v[128:131], v[176:179]
    s_add_u32 m0, s7, 81920
    s_add_u32 s69, s58, 327680
    buffer_load_dwordx4 v24, s[32:35], s69 offen lds
    v_mfma_f32_16x16x32_bf16 v[180:183], a[172:175], v[132:135], v[180:183]
    v_lshlrev_b32 v126, 16, v77
    v_mfma_f32_16x16x32_bf16 v[184:187], a[172:175], v[136:139], v[184:187]
    v_mul_f32 v126, v126, v254
    v_mfma_f32_16x16x32_bf16 v[188:191], a[172:175], v[140:143], v[188:191]
    v_and_b32 v127, s62, v77
    v_mfma_f32_16x16x32_bf16 v[192:195], a[176:179], v[128:131], v[192:195]
    v_mul_f32 v127, v127, v255
    v_mfma_f32_16x16x32_bf16 v[196:199], a[176:179], v[132:135], v[196:199]
    s_add_u32 m0, s7, 86016
    s_add_u32 s69, s58, 360448
    buffer_load_dwordx4 v24, s[32:35], s69 offen lds
    v_mfma_f32_16x16x32_bf16 v[200:203], a[176:179], v[136:139], v[200:203]
    v_mfma_f32_16x16x32_bf16 v[204:207], a[176:179], v[140:143], v[204:207]
    v_pk_fma_f32 v[176:177], v[176:177], v[224:225], v[96:97]
    v_pk_fma_f32 v[178:179], v[178:179], v[226:227], v[98:99]
    v_pk_fma_f32 v[192:193], v[192:193], v[240:241], v[112:113]
    v_pk_fma_f32 v[194:195], v[194:195], v[242:243], v[114:115]
    v_pk_fma_f32 v[180:181], v[180:181], v[228:229], v[100:101]
    v_pk_fma_f32 v[182:183], v[182:183], v[230:231], v[102:103]
    v_pk_fma_f32 v[196:197], v[196:197], v[244:245], v[116:117]
    v_pk_fma_f32 v[198:199], v[198:199], v[246:247], v[118:119]
    v_pk_fma_f32 v[184:185], v[184:185], v[232:233], v[104:105]
    v_pk_fma_f32 v[186:187], v[186:187], v[234:235], v[106:107]
    v_pk_fma_f32 v[200:201], v[200:201], v[248:249], v[120:121]
    v_pk_fma_f32 v[202:203], v[202:203], v[250:251], v[122:123]
    v_pk_fma_f32 v[188:189], v[188:189], v[236:237], v[108:109]
    v_pk_fma_f32 v[190:191], v[190:191], v[238:239], v[110:111]
    v_pk_fma_f32 v[204:205], v[204:205], v[252:253], v[124:125]
    v_pk_fma_f32 v[206:207], v[206:207], v[254:255], v[126:127]
    v_cvt_pk_bf16_f32 v128, v176, v177
    v_cvt_pk_bf16_f32 v129, v178, v179
    v_cvt_pk_bf16_f32 v130, v192, v193
    v_cvt_pk_bf16_f32 v131, v194, v195
    v_cvt_pk_bf16_f32 v132, v180, v181
    v_cvt_pk_bf16_f32 v133, v182, v183
    v_cvt_pk_bf16_f32 v134, v196, v197
    v_cvt_pk_bf16_f32 v135, v198, v199
    v_cvt_pk_bf16_f32 v136, v184, v185
    v_cvt_pk_bf16_f32 v137, v186, v187
    v_cvt_pk_bf16_f32 v138, v200, v201
    v_cvt_pk_bf16_f32 v139, v202, v203
    v_cvt_pk_bf16_f32 v140, v188, v189
    v_cvt_pk_bf16_f32 v141, v190, v191
    v_cvt_pk_bf16_f32 v142, v204, v205
    v_cvt_pk_bf16_f32 v143, v206, v207
    v_min_u32 v128, -2, v128
    v_min_u32 v130, -2, v130
    v_min_u32 v132, -2, v132
    v_min_u32 v134, -2, v134
    v_min_u32 v136, -2, v136
    v_min_u32 v138, -2, v138
    v_min_u32 v140, -2, v140
    v_min_u32 v142, -2, v142
    buffer_store_dwordx4 v[128:131], v31, s[40:43], s63 offen sc1
    s_add_u32 s63, s63, 45056
    buffer_store_dwordx4 v[132:135], v31, s[40:43], s63 offen sc1
    s_add_u32 s63, s63, 45056
    buffer_store_dwordx4 v[136:139], v31, s[40:43], s63 offen sc1
    s_add_u32 s63, s63, 45056
    buffer_store_dwordx4 v[140:143], v31, s[40:43], s63 offen sc1
    v_xor_b32 v2, 0, v25
    v_lshl_add_u32 v12, v2, 5, v26
    v_xor_b32 v2, 1, v25
    v_lshl_add_u32 v13, v2, 5, v26
    v_xor_b32 v2, 2, v25
    v_lshl_add_u32 v14, v2, 5, v26
    v_xor_b32 v2, 3, v25
    v_lshl_add_u32 v15, v2, 5, v26
    v_and_b32 v2, 1, v20
    v_lshlrev_b32 v2, 5, v2
    v_lshrrev_b32 v3, 1, v20
    v_lshl_add_u32 v2, v3, 4, v2
    v_lshl_add_u32 v32, v1, 10, v2
    s_waitcnt vmcnt(18)
    s_barrier
    ds_read_b64_tr_b16 v[208:209], v12 offset:8192
    s_add_u32 m0, s7, 90112
    s_add_u32 s69, s58, 393216
    buffer_load_dwordx4 v24, s[32:35], s69 offen lds
    ds_read_b64_tr_b16 v[210:211], v12 offset:10240
    ds_read_b64_tr_b16 v[212:213], v13 offset:8192
    ds_read_b64_tr_b16 v[214:215], v13 offset:10240
    ds_read_b64_tr_b16 v[216:217], v14 offset:8192
    ds_read_b64_tr_b16 v[218:219], v14 offset:10240
    ds_read_b64_tr_b16 v[220:221], v15 offset:8192
    ds_read_b64_tr_b16 v[222:223], v15 offset:10240
    ds_read_b64_tr_b16 v[224:225], v12 offset:12288
    ds_read_b64_tr_b16 v[226:227], v12 offset:14336
    ds_read_b64_tr_b16 v[228:229], v13 offset:12288
    ds_read_b64_tr_b16 v[230:231], v13 offset:14336
    ds_read_b64_tr_b16 v[232:233], v14 offset:12288
    ds_read_b64_tr_b16 v[234:235], v14 offset:14336
    ds_read_b64_tr_b16 v[236:237], v15 offset:12288
    ds_read_b64_tr_b16 v[238:239], v15 offset:14336
    s_add_u32 m0, s7, 94208
    s_add_u32 s69, s58, 425984
    buffer_load_dwordx4 v24, s[32:35], s69 offen lds
    v_lshlrev_b32 v192, 16, v36
    v_and_b32 v193, s62, v36
    v_lshlrev_b32 v194, 16, v37
    v_and_b32 v195, s62, v37
    v_lshlrev_b32 v196, 16, v38
    v_and_b32 v197, s62, v38
    v_lshlrev_b32 v198, 16, v39
    v_and_b32 v199, s62, v39
    v_lshlrev_b32 v200, 16, v40
    v_and_b32 v201, s62, v40
    v_lshlrev_b32 v202, 16, v41
    v_and_b32 v203, s62, v41
    v_lshlrev_b32 v204, 16, v42
    v_and_b32 v205, s62, v42
    v_lshlrev_b32 v206, 16, v43
    v_and_b32 v207, s62, v43
    s_mul_i32 s78, s3, 45056
    s_add_u32 s78, s78, s61
    s_add_u32 s78, s78, 16384
    v_min_u32 v6, 27, v0
    s_add_u32 m0, s7, 98304
    s_add_u32 s69, s58, 458752
    buffer_load_dwordx4 v24, s[32:35], s69 offen lds
    v_lshlrev_b32 v6, 10, v6
    v_add_u32 v6, 1008, v6
    s_waitcnt lgkmcnt(8)
    v_mfma_f32_16x16x32_bf16 v[192:195], v[208:211], a[180:183], v[192:195]
    ds_read_b64_tr_b16 v[240:241], v12 offset:16384
    ds_read_b64_tr_b16 v[242:243], v12 offset:18432
    v_mfma_f32_16x16x32_bf16 v[196:199], v[212:215], a[180:183], v[196:199]
    ds_read_b64_tr_b16 v[244:245], v13 offset:16384
    ds_read_b64_tr_b16 v[246:247], v13 offset:18432
    v_mfma_f32_16x16x32_bf16 v[200:203], v[216:219], a[180:183], v[200:203]
    ds_read_b64_tr_b16 v[248:249], v14 offset:16384
    s_add_u32 m0, s7, 102400
    s_add_u32 s69, s58, 491520
    buffer_load_dwordx4 v24, s[32:35], s69 offen lds
    ds_read_b64_tr_b16 v[250:251], v14 offset:18432
    v_mfma_f32_16x16x32_bf16 v[204:207], v[220:223], a[180:183], v[204:207]
    ds_read_b64_tr_b16 v[252:253], v15 offset:16384
    ds_read_b64_tr_b16 v[254:255], v15 offset:18432
    s_waitcnt lgkmcnt(8)
    v_mfma_f32_16x16x32_bf16 v[192:195], v[224:227], a[184:187], v[192:195]
    ds_read_b64_tr_b16 v[208:209], v12 offset:20480
    ds_read_b64_tr_b16 v[210:211], v12 offset:22528
    v_mfma_f32_16x16x32_bf16 v[196:199], v[228:231], a[184:187], v[196:199]
    ds_read_b64_tr_b16 v[212:213], v13 offset:20480
    ds_read_b64_tr_b16 v[214:215], v13 offset:22528
    v_mfma_f32_16x16x32_bf16 v[200:203], v[232:235], a[184:187], v[200:203]
    ds_read_b64_tr_b16 v[216:217], v14 offset:20480
    s_add_u32 m0, s7, 106496
    s_add_u32 s69, s58, 524288
    buffer_load_dwordx4 v24, s[32:35], s69 offen lds
    ds_read_b64_tr_b16 v[218:219], v14 offset:22528
    v_mfma_f32_16x16x32_bf16 v[204:207], v[236:239], a[184:187], v[204:207]
    ds_read_b64_tr_b16 v[220:221], v15 offset:20480
    ds_read_b64_tr_b16 v[222:223], v15 offset:22528
    s_waitcnt lgkmcnt(8)
    v_mfma_f32_16x16x32_bf16 v[192:195], v[240:243], a[188:191], v[192:195]
    ds_read_b64_tr_b16 v[224:225], v12 offset:24576
    ds_read_b64_tr_b16 v[226:227], v12 offset:26624
    v_mfma_f32_16x16x32_bf16 v[196:199], v[244:247], a[188:191], v[196:199]
    ds_read_b64_tr_b16 v[228:229], v13 offset:24576
    ds_read_b64_tr_b16 v[230:231], v13 offset:26624
    v_mfma_f32_16x16x32_bf16 v[200:203], v[248:251], a[188:191], v[200:203]
    ds_read_b64_tr_b16 v[232:233], v14 offset:24576
    s_add_u32 m0, s7, 110592
    s_add_u32 s69, s58, 557056
    buffer_load_dwordx4 v24, s[32:35], s69 offen lds
    ds_read_b64_tr_b16 v[234:235], v14 offset:26624
    v_mfma_f32_16x16x32_bf16 v[204:207], v[252:255], a[188:191], v[204:207]
    ds_read_b64_tr_b16 v[236:237], v15 offset:24576
    ds_read_b64_tr_b16 v[238:239], v15 offset:26624
    s_waitcnt lgkmcnt(8)
    v_mfma_f32_16x16x32_bf16 v[192:195], v[208:211], a[192:195], v[192:195]
    ds_read_b64_tr_b16 v[240:241], v12 offset:28672
    ds_read_b64_tr_b16 v[242:243], v12 offset:30720
    v_mfma_f32_16x16x32_bf16 v[196:199], v[212:215], a[192:195], v[196:199]
    ds_read_b64_tr_b16 v[244:245], v13 offset:28672
    ds_read_b64_tr_b16 v[246:247], v13 offset:30720
    v_mfma_f32_16x16x32_bf16 v[200:203], v[216:219], a[192:195], v[200:203]
    ds_read_b64_tr_b16 v[248:249], v14 offset:28672
    s_add_u32 m0, s7, 114688
    s_add_u32 s69, s58, 589824
    buffer_load_dwordx4 v24, s[32:35], s69 offen lds
    ds_read_b64_tr_b16 v[250:251], v14 offset:30720
    v_mfma_f32_16x16x32_bf16 v[204:207], v[220:223], a[192:195], v[204:207]
    ds_read_b64_tr_b16 v[252:253], v15 offset:28672
    ds_read_b64_tr_b16 v[254:255], v15 offset:30720
    s_barrier
    s_waitcnt lgkmcnt(8)
    v_mfma_f32_16x16x32_bf16 v[192:195], v[224:227], a[196:199], v[192:195]
    ds_read_b64_tr_b16 v[208:209], v12 offset:32768
    ds_read_b64_tr_b16 v[210:211], v12 offset:34816
    v_mfma_f32_16x16x32_bf16 v[196:199], v[228:231], a[196:199], v[196:199]
    ds_read_b64_tr_b16 v[212:213], v13 offset:32768
    ds_read_b64_tr_b16 v[214:215], v13 offset:34816
    v_mfma_f32_16x16x32_bf16 v[200:203], v[232:235], a[196:199], v[200:203]
    ds_read_b64_tr_b16 v[216:217], v14 offset:32768
    ds_read_b64_tr_b16 v[218:219], v14 offset:34816
    v_mfma_f32_16x16x32_bf16 v[204:207], v[236:239], a[196:199], v[204:207]
    ds_read_b64_tr_b16 v[220:221], v15 offset:32768
    ds_read_b64_tr_b16 v[222:223], v15 offset:34816
    s_waitcnt lgkmcnt(8)
    v_mfma_f32_16x16x32_bf16 v[192:195], v[240:243], a[200:203], v[192:195]
    ds_read_b64_tr_b16 v[224:225], v12 offset:36864
    ds_read_b64_tr_b16 v[226:227], v12 offset:38912
    v_mfma_f32_16x16x32_bf16 v[196:199], v[244:247], a[200:203], v[196:199]
    ds_read_b64_tr_b16 v[228:229], v13 offset:36864
    ds_read_b64_tr_b16 v[230:231], v13 offset:38912
    v_mfma_f32_16x16x32_bf16 v[200:203], v[248:251], a[200:203], v[200:203]
    ds_read_b64_tr_b16 v[232:233], v14 offset:36864
    ds_read_b64_tr_b16 v[234:235], v14 offset:38912
    v_mfma_f32_16x16x32_bf16 v[204:207], v[252:255], a[200:203], v[204:207]
    ds_read_b64_tr_b16 v[236:237], v15 offset:36864
    ds_read_b64_tr_b16 v[238:239], v15 offset:38912
    s_waitcnt lgkmcnt(8)
    v_mfma_f32_16x16x32_bf16 v[192:195], v[208:211], a[204:207], v[192:195]
    ds_read_b64_tr_b16 v[240:241], v12 offset:40960
    ds_read_b64_tr_b16 v[242:243], v12 offset:43008
    v_mfma_f32_16x16x32_bf16 v[196:199], v[212:215], a[204:207], v[196:199]
    ds_read_b64_tr_b16 v[244:245], v13 offset:40960
    ds_read_b64_tr_b16 v[246:247], v13 offset:43008
    v_mfma_f32_16x16x32_bf16 v[200:203], v[216:219], a[204:207], v[200:203]
    ds_read_b64_tr_b16 v[248:249], v14 offset:40960
    ds_read_b64_tr_b16 v[250:251], v14 offset:43008
    v_mfma_f32_16x16x32_bf16 v[204:207], v[220:223], a[204:207], v[204:207]
    s_add_u32 m0, s7, 118784
    s_add_u32 s69, s58, 622592
    buffer_load_dwordx4 v24, s[32:35], s69 offen lds
    ds_read_b64_tr_b16 v[252:253], v15 offset:40960
    ds_read_b64_tr_b16 v[254:255], v15 offset:43008
    s_waitcnt lgkmcnt(8)
    v_mfma_f32_16x16x32_bf16 v[192:195], v[224:227], a[208:211], v[192:195]
    ds_read_b64_tr_b16 v[208:209], v12 offset:45056
    ds_read_b64_tr_b16 v[210:211], v12 offset:47104
    v_mfma_f32_16x16x32_bf16 v[196:199], v[228:231], a[208:211], v[196:199]
    ds_read_b64_tr_b16 v[212:213], v13 offset:45056
    ds_read_b64_tr_b16 v[214:215], v13 offset:47104
    v_mfma_f32_16x16x32_bf16 v[200:203], v[232:235], a[208:211], v[200:203]
    ds_read_b64_tr_b16 v[216:217], v14 offset:45056
    ds_read_b64_tr_b16 v[218:219], v14 offset:47104
    s_add_u32 m0, s7, 122880
    s_add_u32 s69, s58, 655360
    buffer_load_dwordx4 v24, s[32:35], s69 offen lds
    v_mfma_f32_16x16x32_bf16 v[204:207], v[236:239], a[208:211], v[204:207]
    ds_read_b64_tr_b16 v[220:221], v15 offset:45056
    ds_read_b64_tr_b16 v[222:223], v15 offset:47104
    s_waitcnt lgkmcnt(8)
    v_mfma_f32_16x16x32_bf16 v[192:195], v[240:243], a[212:215], v[192:195]
    ds_read_b64_tr_b16 v[224:225], v12 offset:49152
    ds_read_b64_tr_b16 v[226:227], v12 offset:51200
    v_mfma_f32_16x16x32_bf16 v[196:199], v[244:247], a[212:215], v[196:199]
    ds_read_b64_tr_b16 v[228:229], v13 offset:49152
    ds_read_b64_tr_b16 v[230:231], v13 offset:51200
    v_mfma_f32_16x16x32_bf16 v[200:203], v[248:251], a[212:215], v[200:203]
    s_add_u32 m0, s7, 126976
    s_add_u32 s69, s58, 688128
    buffer_load_dwordx4 v24, s[32:35], s69 offen lds
    ds_read_b64_tr_b16 v[232:233], v14 offset:49152
    ds_read_b64_tr_b16 v[234:235], v14 offset:51200
    v_mfma_f32_16x16x32_bf16 v[204:207], v[252:255], a[212:215], v[204:207]
    ds_read_b64_tr_b16 v[236:237], v15 offset:49152
    ds_read_b64_tr_b16 v[238:239], v15 offset:51200
    s_waitcnt lgkmcnt(8)
    v_mfma_f32_16x16x32_bf16 v[192:195], v[208:211], a[216:219], v[192:195]
    ds_read_b64_tr_b16 v[240:241], v12 offset:53248
    ds_read_b64_tr_b16 v[242:243], v12 offset:55296
    v_mfma_f32_16x16x32_bf16 v[196:199], v[212:215], a[216:219], v[196:199]
    ds_read_b64_tr_b16 v[244:245], v13 offset:53248
    s_add_u32 m0, s7, 0
    s_add_u32 s69, s58, 720896
    buffer_load_dwordx4 v24, s[32:35], s69 offen lds
    ds_read_b64_tr_b16 v[246:247], v13 offset:55296
    v_mfma_f32_16x16x32_bf16 v[200:203], v[216:219], a[216:219], v[200:203]
    ds_read_b64_tr_b16 v[248:249], v14 offset:53248
    ds_read_b64_tr_b16 v[250:251], v14 offset:55296
    v_mfma_f32_16x16x32_bf16 v[204:207], v[220:223], a[216:219], v[204:207]
    ds_read_b64_tr_b16 v[252:253], v15 offset:53248
    ds_read_b64_tr_b16 v[254:255], v15 offset:55296
    s_waitcnt lgkmcnt(8)
    v_mfma_f32_16x16x32_bf16 v[192:195], v[224:227], a[220:223], v[192:195]
    v_add_u32 v12, 122880, v12
    v_add_u32 v13, 122880, v13
    v_add_u32 v14, 122880, v14
    v_mfma_f32_16x16x32_bf16 v[196:199], v[228:231], a[220:223], v[196:199]
    s_add_u32 m0, s7, 4096
    s_add_u32 s69, s58, 753664
    buffer_load_dwordx4 v24, s[32:35], s69 offen lds
    v_add_u32 v15, 122880, v15
    ds_read_b64_tr_b16 v[208:209], v12 offset:8192
    ds_read_b64_tr_b16 v[210:211], v12 offset:10240
    v_mfma_f32_16x16x32_bf16 v[200:203], v[232:235], a[220:223], v[200:203]
    ds_read_b64_tr_b16 v[212:213], v13 offset:8192
    ds_read_b64_tr_b16 v[214:215], v13 offset:10240
    ds_read_b64_tr_b16 v[216:217], v14 offset:8192
    v_mfma_f32_16x16x32_bf16 v[204:207], v[236:239], a[220:223], v[204:207]
    ds_read_b64_tr_b16 v[218:219], v14 offset:10240
    ds_read_b64_tr_b16 v[220:221], v15 offset:8192
    ds_read_b64_tr_b16 v[222:223], v15 offset:10240
    s_waitcnt lgkmcnt(8)
    v_mfma_f32_16x16x32_bf16 v[192:195], v[240:243], a[224:227], v[192:195]
    ds_read_b64_tr_b16 v[224:225], v12 offset:12288
    s_add_u32 m0, s7, 8192
    s_add_u32 s69, s58, 786432
    buffer_load_dwordx4 v24, s[32:35], s69 offen lds
    ds_read_b64_tr_b16 v[226:227], v12 offset:14336
    v_mfma_f32_16x16x32_bf16 v[196:199], v[244:247], a[224:227], v[196:199]
    ds_read_b64_tr_b16 v[228:229], v13 offset:12288
    ds_read_b64_tr_b16 v[230:231], v13 offset:14336
    v_mfma_f32_16x16x32_bf16 v[200:203], v[248:251], a[224:227], v[200:203]
    ds_read_b64_tr_b16 v[232:233], v14 offset:12288
    ds_read_b64_tr_b16 v[234:235], v14 offset:14336
    v_mfma_f32_16x16x32_bf16 v[204:207], v[252:255], a[224:227], v[204:207]
    ds_read_b64_tr_b16 v[236:237], v15 offset:12288
    ds_read_b64_tr_b16 v[238:239], v15 offset:14336
    s_waitcnt lgkmcnt(8)
    v_mfma_f32_16x16x32_bf16 v[192:195], v[208:211], a[228:231], v[192:195]
    ds_read_b64_tr_b16 v[240:241], v12 offset:16384
    s_add_u32 m0, s7, 12288
    s_add_u32 s69, s58, 819200
    buffer_load_dwordx4 v24, s[32:35], s69 offen lds
    ds_read_b64_tr_b16 v[242:243], v12 offset:18432
    v_mfma_f32_16x16x32_bf16 v[196:199], v[212:215], a[228:231], v[196:199]
    ds_read_b64_tr_b16 v[244:245], v13 offset:16384
    ds_read_b64_tr_b16 v[246:247], v13 offset:18432
    v_mfma_f32_16x16x32_bf16 v[200:203], v[216:219], a[228:231], v[200:203]
    ds_read_b64_tr_b16 v[248:249], v14 offset:16384
    ds_read_b64_tr_b16 v[250:251], v14 offset:18432
    v_mfma_f32_16x16x32_bf16 v[204:207], v[220:223], a[228:231], v[204:207]
    ds_read_b64_tr_b16 v[252:253], v15 offset:16384
    ds_read_b64_tr_b16 v[254:255], v15 offset:18432
    s_waitcnt lgkmcnt(8)
    v_mfma_f32_16x16x32_bf16 v[192:195], v[224:227], a[232:235], v[192:195]
    ds_read_b64_tr_b16 v[208:209], v12 offset:20480
    s_add_u32 m0, s7, 16384
    s_add_u32 s69, s58, 851968
    buffer_load_dwordx4 v24, s[32:35], s69 offen lds
    ds_read_b64_tr_b16 v[210:211], v12 offset:22528
    v_mfma_f32_16x16x32_bf16 v[196:199], v[228:231], a[232:235], v[196:199]
    ds_read_b64_tr_b16 v[212:213], v13 offset:20480
    ds_read_b64_tr_b16 v[214:215], v13 offset:22528
    v_mfma_f32_16x16x32_bf16 v[200:203], v[232:235], a[232:235], v[200:203]
    ds_read_b64_tr_b16 v[216:217], v14 offset:20480
    ds_read_b64_tr_b16 v[218:219], v14 offset:22528
    v_mfma_f32_16x16x32_bf16 v[204:207], v[236:239], a[232:235], v[204:207]
    ds_read_b64_tr_b16 v[220:221], v15 offset:20480
    ds_read_b64_tr_b16 v[222:223], v15 offset:22528
    s_add_u32 m0, s7, 20480
    s_add_u32 s69, s58, 884736
    buffer_load_dwordx4 v24, s[32:35], s69 offen lds
    s_waitcnt vmcnt(0)
    s_barrier
    s_waitcnt lgkmcnt(8)
    v_mfma_f32_16x16x32_bf16 v[192:195], v[240:243], a[236:239], v[192:195]
    s_add_u32 s64, s64, 4096
    buffer_load_dwordx4 v[176:179], v21, s[40:43], s64 offen offset:0 sc1
    v_add_u32 v12, 4294844416, v12
    buffer_load_dwordx4 v[180:183], v21, s[40:43], s64 offen offset:1024 sc1
    v_add_u32 v13, 4294844416, v13
    buffer_load_dwordx4 v[184:187], v21, s[40:43], s64 offen offset:2048 sc1
    v_add_u32 v14, 4294844416, v14
    buffer_load_dwordx4 v[188:191], v21, s[40:43], s64 offen offset:3072 sc1
    v_mfma_f32_16x16x32_bf16 v[196:199], v[244:247], a[236:239], v[196:199]
    s_add_u32 s64, s64, 4096
    buffer_load_dwordx4 v[160:163], v21, s[40:43], s64 offen offset:0 sc1
    v_add_u32 v15, 4294844416, v15
    buffer_load_dwordx4 v[164:167], v21, s[40:43], s64 offen offset:1024 sc1
    ds_read_b64_tr_b16 v[224:225], v12 offset:57344
    buffer_load_dwordx4 v[168:171], v21, s[40:43], s64 offen offset:2048 sc1
    ds_read_b64_tr_b16 v[226:227], v12 offset:59392
    buffer_load_dwordx4 v[172:175], v21, s[40:43], s64 offen offset:3072 sc1
    v_mfma_f32_16x16x32_bf16 v[200:203], v[248:251], a[236:239], v[200:203]
    s_add_u32 s64, s64, 4096
    buffer_load_dwordx4 v[144:147], v21, s[40:43], s64 offen offset:0 sc1
    ds_read_b64_tr_b16 v[228:229], v13 offset:57344
    buffer_load_dwordx4 v[148:151], v21, s[40:43], s64 offen offset:1024 sc1
    ds_read_b64_tr_b16 v[230:231], v13 offset:59392
    buffer_load_dwordx4 v[152:155], v21, s[40:43], s64 offen offset:2048 sc1
    ds_read_b64_tr_b16 v[232:233], v14 offset:57344
    v_mfma_f32_16x16x32_bf16 v[204:207], v[252:255], a[236:239], v[204:207]
    ds_read_b64_tr_b16 v[234:235], v14 offset:59392
    ds_read_b64_tr_b16 v[236:237], v15 offset:57344
    ds_read_b64_tr_b16 v[238:239], v15 offset:59392
    s_waitcnt lgkmcnt(8)
    v_mfma_f32_16x16x32_bf16 v[192:195], v[208:211], a[240:243], v[192:195]
    v_add_u32 v12, 61440, v12
    v_add_u32 v13, 61440, v13
    v_add_u32 v14, 61440, v14
    v_mfma_f32_16x16x32_bf16 v[196:199], v[212:215], a[240:243], v[196:199]
    v_add_u32 v15, 61440, v15
    ds_read_b64_tr_b16 v[240:241], v12 offset:0
    ds_read_b64_tr_b16 v[242:243], v12 offset:2048
    v_mfma_f32_16x16x32_bf16 v[200:203], v[216:219], a[240:243], v[200:203]
    ds_read_b64_tr_b16 v[244:245], v13 offset:0
    ds_read_b64_tr_b16 v[246:247], v13 offset:2048
    ds_read_b64_tr_b16 v[248:249], v14 offset:0
    v_mfma_f32_16x16x32_bf16 v[204:207], v[220:223], a[240:243], v[204:207]
    ds_read_b64_tr_b16 v[250:251], v14 offset:2048
    ds_read_b64_tr_b16 v[252:253], v15 offset:0
    ds_read_b64_tr_b16 v[254:255], v15 offset:2048
    s_waitcnt vmcnt(7)
    v_max_u32 v7, v176, v178
    buffer_load_dwordx4 v[156:159], v21, s[40:43], s64 offen offset:3072 sc1
    v_max3_u32 v7, v180, v182, v7
    s_add_u32 s64, s64, 4096
    buffer_load_dwordx4 v[128:131], v21, s[40:43], s64 offen offset:0 sc1
    v_max3_u32 v7, v184, v186, v7
    buffer_load_dwordx4 v[132:135], v21, s[40:43], s64 offen offset:1024 sc1
    v_max3_u32 v7, v188, v190, v7
    buffer_load_dwordx4 v[136:139], v21, s[40:43], s64 offen offset:2048 sc1
    v_cmp_eq_u32 vcc, -1, v7
    s_nop 0
    s_cbranch_vccnz L_rare_69
L_back_70:
    s_waitcnt lgkmcnt(8)
    v_mfma_f32_16x16x32_bf16 v[192:195], v[224:227], v[176:179], v[192:195]
    buffer_load_dwordx4 v[140:143], v21, s[40:43], s64 offen offset:3072 sc1
    v_add_u32 v12, 61440, v12
    v_add_u32 v13, 61440, v13
    v_add_u32 v14, 61440, v14
    v_mfma_f32_16x16x32_bf16 v[196:199], v[228:231], v[176:179], v[196:199]
    v_add_u32 v15, 61440, v15
    s_add_u32 s64, s64, 4096
    buffer_load_dwordx4 v[112:115], v21, s[40:43], s64 offen offset:0 sc1
    ds_read_b64_tr_b16 v[208:209], v12 offset:24576
    ds_read_b64_tr_b16 v[210:211], v12 offset:26624
    v_mfma_f32_16x16x32_bf16 v[200:203], v[232:235], v[176:179], v[200:203]
    ds_read_b64_tr_b16 v[212:213], v13 offset:24576
    ds_read_b64_tr_b16 v[214:215], v13 offset:26624
    buffer_load_dwordx4 v[116:119], v21, s[40:43], s64 offen offset:1024 sc1
    ds_read_b64_tr_b16 v[216:217], v14 offset:24576
    v_mfma_f32_16x16x32_bf16 v[204:207], v[236:239], v[176:179], v[204:207]
    ds_read_b64_tr_b16 v[218:219], v14 offset:26624
    ds_read_b64_tr_b16 v[220:221], v15 offset:24576
    ds_read_b64_tr_b16 v[222:223], v15 offset:26624
    buffer_load_dwordx4 v[120:123], v21, s[40:43], s64 offen offset:2048 sc1
    s_waitcnt lgkmcnt(8)
    v_mfma_f32_16x16x32_bf16 v[192:195], v[240:243], v[180:183], v[192:195]
    ds_read_b64_tr_b16 v[224:225], v12 offset:28672
    ds_read_b64_tr_b16 v[226:227], v12 offset:30720
    v_mfma_f32_16x16x32_bf16 v[196:199], v[244:247], v[180:183], v[196:199]
    buffer_load_dwordx4 v[124:127], v21, s[40:43], s64 offen offset:3072 sc1
    ds_read_b64_tr_b16 v[228:229], v13 offset:28672
    ds_read_b64_tr_b16 v[230:231], v13 offset:30720
    v_mfma_f32_16x16x32_bf16 v[200:203], v[248:251], v[180:183], v[200:203]
    ds_read_b64_tr_b16 v[232:233], v14 offset:28672
    ds_read_b64_tr_b16 v[234:235], v14 offset:30720
    s_add_u32 s64, s64, 4096
    buffer_load_dwordx4 v[96:99], v21, s[40:43], s64 offen offset:0 sc1
    v_mfma_f32_16x16x32_bf16 v[204:207], v[252:255], v[180:183], v[204:207]
    ds_read_b64_tr_b16 v[236:237], v15 offset:28672
    ds_read_b64_tr_b16 v[238:239], v15 offset:30720
    s_waitcnt lgkmcnt(8)
    v_mfma_f32_16x16x32_bf16 v[192:195], v[208:211], v[184:187], v[192:195]
    buffer_load_dwordx4 v[100:103], v21, s[40:43], s64 offen offset:1024 sc1
    ds_read_b64_tr_b16 v[240:241], v12 offset:32768
    ds_read_b64_tr_b16 v[242:243], v12 offset:34816
    v_mfma_f32_16x16x32_bf16 v[196:199], v[212:215], v[184:187], v[196:199]
    ds_read_b64_tr_b16 v[244:245], v13 offset:32768
    ds_read_b64_tr_b16 v[246:247], v13 offset:34816
    v_mfma_f32_16x16x32_bf16 v[200:203], v[216:219], v[184:187], v[200:203]
    ds_read_b64_tr_b16 v[248:249], v14 offset:32768
    ds_read_b64_tr_b16 v[250:251], v14 offset:34816
    v_mfma_f32_16x16x32_bf16 v[204:207], v[220:223], v[184:187], v[204:207]
    ds_read_b64_tr_b16 v[252:253], v15 offset:32768
    ds_read_b64_tr_b16 v[254:255], v15 offset:34816
    s_waitcnt lgkmcnt(8)
    v_mfma_f32_16x16x32_bf16 v[192:195], v[224:227], v[188:191], v[192:195]
    ds_read_b64_tr_b16 v[208:209], v12 offset:36864
    ds_read_b64_tr_b16 v[210:211], v12 offset:38912
    v_mfma_f32_16x16x32_bf16 v[196:199], v[228:231], v[188:191], v[196:199]
    ds_read_b64_tr_b16 v[212:213], v13 offset:36864
    ds_read_b64_tr_b16 v[214:215], v13 offset:38912
    v_mfma_f32_16x16x32_bf16 v[200:203], v[232:235], v[188:191], v[200:203]
    ds_read_b64_tr_b16 v[216:217], v14 offset:36864
    ds_read_b64_tr_b16 v[218:219], v14 offset:38912
    v_mfma_f32_16x16x32_bf16 v[204:207], v[236:239], v[188:191], v[204:207]
    ds_read_b64_tr_b16 v[220:221], v15 offset:36864
    ds_read_b64_tr_b16 v[222:223], v15 offset:38912
    s_waitcnt vmcnt(14)
    v_max_u32 v7, v160, v162
    v_max3_u32 v7, v164, v166, v7
    v_max3_u32 v7, v168, v170, v7
    v_max3_u32 v7, v172, v174, v7
    v_cmp_eq_u32 vcc, -1, v7
    s_nop 0
    s_cbranch_vccnz L_rare_74
L_back_75:
    s_waitcnt lgkmcnt(8)
    v_mfma_f32_16x16x32_bf16 v[192:195], v[240:243], v[160:163], v[192:195]
    v_add_u32 v12, 4294905856, v12
    v_add_u32 v13, 4294905856, v13
    buffer_load_dwordx4 v[104:107], v21, s[40:43], s64 offen offset:2048 sc1
    v_add_u32 v14, 4294905856, v14
    v_mfma_f32_16x16x32_bf16 v[196:199], v[244:247], v[160:163], v[196:199]
    v_add_u32 v15, 4294905856, v15
    ds_read_b64_tr_b16 v[224:225], v12 offset:4096
    ds_read_b64_tr_b16 v[226:227], v12 offset:6144
    v_mfma_f32_16x16x32_bf16 v[200:203], v[248:251], v[160:163], v[200:203]
    ds_read_b64_tr_b16 v[228:229], v13 offset:4096
    ds_read_b64_tr_b16 v[230:231], v13 offset:6144
    ds_read_b64_tr_b16 v[232:233], v14 offset:4096
    v_mfma_f32_16x16x32_bf16 v[204:207], v[252:255], v[160:163], v[204:207]
    ds_read_b64_tr_b16 v[234:235], v14 offset:6144
    ds_read_b64_tr_b16 v[236:237], v15 offset:4096
    ds_read_b64_tr_b16 v[238:239], v15 offset:6144
    s_waitcnt lgkmcnt(8)
    v_mfma_f32_16x16x32_bf16 v[192:195], v[208:211], v[164:167], v[192:195]
    buffer_load_dwordx4 v[108:111], v21, s[40:43], s64 offen offset:3072 sc1
    ds_read_b64_tr_b16 v[240:241], v12 offset:8192
    ds_read_b64_tr_b16 v[242:243], v12 offset:10240
    v_mfma_f32_16x16x32_bf16 v[196:199], v[212:215], v[164:167], v[196:199]
    ds_read_b64_tr_b16 v[244:245], v13 offset:8192
    ds_read_b64_tr_b16 v[246:247], v13 offset:10240
    v_mfma_f32_16x16x32_bf16 v[200:203], v[216:219], v[164:167], v[200:203]
    ds_read_b64_tr_b16 v[248:249], v14 offset:8192
    ds_read_b64_tr_b16 v[250:251], v14 offset:10240
    v_mfma_f32_16x16x32_bf16 v[204:207], v[220:223], v[164:167], v[204:207]
    ds_read_b64_tr_b16 v[252:253], v15 offset:8192
    ds_read_b64_tr_b16 v[254:255], v15 offset:10240
    s_waitcnt lgkmcnt(8)
    v_mfma_f32_16x16x32_bf16 v[192:195], v[224:227], v[168:171], v[192:195]
    ds_read_b64_tr_b16 v[208:209], v12 offset:12288
    ds_read_b64_tr_b16 v[210:211], v12 offset:14336
    s_add_u32 s64, s64, 4096
    buffer_load_dwordx4 v[80:83], v21, s[40:43], s64 offen offset:0 sc1
    v_mfma_f32_16x16x32_bf16 v[196:199], v[228:231], v[168:171], v[196:199]
    ds_read_b64_tr_b16 v[212:213], v13 offset:12288
    ds_read_b64_tr_b16 v[214:215], v13 offset:14336
    v_mfma_f32_16x16x32_bf16 v[200:203], v[232:235], v[168:171], v[200:203]
    ds_read_b64_tr_b16 v[216:217], v14 offset:12288
    ds_read_b64_tr_b16 v[218:219], v14 offset:14336
    v_mfma_f32_16x16x32_bf16 v[204:207], v[236:239], v[168:171], v[204:207]
    ds_read_b64_tr_b16 v[220:221], v15 offset:12288
    ds_read_b64_tr_b16 v[222:223], v15 offset:14336
    s_waitcnt lgkmcnt(8)
    v_mfma_f32_16x16x32_bf16 v[192:195], v[240:243], v[172:175], v[192:195]
    ds_read_b64_tr_b16 v[224:225], v12 offset:16384
    ds_read_b64_tr_b16 v[226:227], v12 offset:18432
    v_mfma_f32_16x16x32_bf16 v[196:199], v[244:247], v[172:175], v[196:199]
    buffer_load_dwordx4 v[84:87], v21, s[40:43], s64 offen offset:1024 sc1
    ds_read_b64_tr_b16 v[228:229], v13 offset:16384
    ds_read_b64_tr_b16 v[230:231], v13 offset:18432
    v_mfma_f32_16x16x32_bf16 v[200:203], v[248:251], v[172:175], v[200:203]
    ds_read_b64_tr_b16 v[232:233], v14 offset:16384
    ds_read_b64_tr_b16 v[234:235], v14 offset:18432
    v_mfma_f32_16x16x32_bf16 v[204:207], v[252:255], v[172:175], v[204:207]
    ds_read_b64_tr_b16 v[236:237], v15 offset:16384
    ds_read_b64_tr_b16 v[238:239], v15 offset:18432
    s_waitcnt vmcnt(14)
    v_max_u32 v7, v144, v146
    v_max3_u32 v7, v148, v150, v7
    v_max3_u32 v7, v152, v154, v7
    v_max3_u32 v7, v156, v158, v7
    v_cmp_eq_u32 vcc, -1, v7
    s_nop 0
    s_cbranch_vccnz L_rare_79
L_back_80:
    s_waitcnt lgkmcnt(8)
    v_mfma_f32_16x16x32_bf16 v[192:195], v[208:211], v[144:147], v[192:195]
    buffer_load_dwordx4 v[88:91], v21, s[40:43], s64 offen offset:2048 sc1
    ds_read_b64_tr_b16 v[240:241], v12 offset:20480
    ds_read_b64_tr_b16 v[242:243], v12 offset:22528
    v_mfma_f32_16x16x32_bf16 v[196:199], v[212:215], v[144:147], v[196:199]
    ds_read_b64_tr_b16 v[244:245], v13 offset:20480
    ds_read_b64_tr_b16 v[246:247], v13 offset:22528
    v_mfma_f32_16x16x32_bf16 v[200:203], v[216:219], v[144:147], v[200:203]
    ds_read_b64_tr_b16 v[248:249], v14 offset:20480
    ds_read_b64_tr_b16 v[250:251], v14 offset:22528
    v_mfma_f32_16x16x32_bf16 v[204:207], v[220:223], v[144:147], v[204:207]
    ds_read_b64_tr_b16 v[252:253], v15 offset:20480
    ds_read_b64_tr_b16 v[254:255], v15 offset:22528
    s_waitcnt lgkmcnt(8)
    v_mfma_f32_16x16x32_bf16 v[192:195], v[224:227], v[148:151], v[192:195]
    buffer_load_dwordx4 v[92:95], v21, s[40:43], s64 offen offset:3072 sc1
    ds_read_b64_tr_b16 v[208:209], v12 offset:24576
    ds_read_b64_tr_b16 v[210:211], v12 offset:26624
    v_mfma_f32_16x16x32_bf16 v[196:199], v[228:231], v[148:151], v[196:199]
    ds_read_b64_tr_b16 v[212:213], v13 offset:24576
    ds_read_b64_tr_b16 v[214:215], v13 offset:26624
    v_mfma_f32_16x16x32_bf16 v[200:203], v[232:235], v[148:151], v[200:203]
    ds_read_b64_tr_b16 v[216:217], v14 offset:24576
    ds_read_b64_tr_b16 v[218:219], v14 offset:26624
    v_mfma_f32_16x16x32_bf16 v[204:207], v[236:239], v[148:151], v[204:207]
    ds_read_b64_tr_b16 v[220:221], v15 offset:24576
    ds_read_b64_tr_b16 v[222:223], v15 offset:26624
    s_waitcnt lgkmcnt(8)
    v_mfma_f32_16x16x32_bf16 v[192:195], v[240:243], v[152:155], v[192:195]
    ds_read_b64_tr_b16 v[224:225], v12 offset:28672
    ds_read_b64_tr_b16 v[226:227], v12 offset:30720
    v_mfma_f32_16x16x32_bf16 v[196:199], v[244:247], v[152:155], v[196:199]
    ds_read_b64_tr_b16 v[228:229], v13 offset:28672
    ds_read_b64_tr_b16 v[230:231], v13 offset:30720
    v_mfma_f32_16x16x32_bf16 v[200:203], v[248:251], v[152:155], v[200:203]
    ds_read_b64_tr_b16 v[232:233], v14 offset:28672
    ds_read_b64_tr_b16 v[234:235], v14 offset:30720
    v_mfma_f32_16x16x32_bf16 v[204:207], v[252:255], v[152:155], v[204:207]
    ds_read_b64_tr_b16 v[236:237], v15 offset:28672
    ds_read_b64_tr_b16 v[238:239], v15 offset:30720
    s_waitcnt lgkmcnt(8)
    v_mfma_f32_16x16x32_bf16 v[192:195], v[208:211], v[156:159], v[192:195]
    ds_read_b64_tr_b16 v[240:241], v12 offset:32768
    ds_read_b64_tr_b16 v[242:243], v12 offset:34816
    v_mfma_f32_16x16x32_bf16 v[196:199], v[212:215], v[156:159], v[196:199]
    ds_read_b64_tr_b16 v[244:245], v13 offset:32768
    ds_read_b64_tr_b16 v[246:247], v13 offset:34816
    v_mfma_f32_16x16x32_bf16 v[200:203], v[216:219], v[156:159], v[200:203]
    ds_read_b64_tr_b16 v[248:249], v14 offset:32768
    ds_read_b64_tr_b16 v[250:251], v14 offset:34816
    v_mfma_f32_16x16x32_bf16 v[204:207], v[220:223], v[156:159], v[204:207]
    ds_read_b64_tr_b16 v[252:253], v15 offset:32768
    ds_read_b64_tr_b16 v[254:255], v15 offset:34816
    s_waitcnt vmcnt(12)
    v_max_u32 v7, v128, v130
    v_max3_u32 v7, v132, v134, v7
    v_max3_u32 v7, v136, v138, v7
    v_max3_u32 v7, v140, v142, v7
    v_cmp_eq_u32 vcc, -1, v7
    s_nop 0
    s_cbranch_vccnz L_rare_84
L_back_85:
    s_waitcnt lgkmcnt(8)
    v_mfma_f32_16x16x32_bf16 v[192:195], v[224:227], v[128:131], v[192:195]
    ds_read_b64_tr_b16 v[208:209], v12 offset:36864
    ds_read_b64_tr_b16 v[210:211], v12 offset:38912
    v_mfma_f32_16x16x32_bf16 v[196:199], v[228:231], v[128:131], v[196:199]
    ds_read_b64_tr_b16 v[212:213], v13 offset:36864
    ds_read_b64_tr_b16 v[214:215], v13 offset:38912
    v_mfma_f32_16x16x32_bf16 v[200:203], v[232:235], v[128:131], v[200:203]
    ds_read_b64_tr_b16 v[216:217], v14 offset:36864
    ds_read_b64_tr_b16 v[218:219], v14 offset:38912
    v_mfma_f32_16x16x32_bf16 v[204:207], v[236:239], v[128:131], v[204:207]
    ds_read_b64_tr_b16 v[220:221], v15 offset:36864
    ds_read_b64_tr_b16 v[222:223], v15 offset:38912
    s_waitcnt lgkmcnt(8)
    v_mfma_f32_16x16x32_bf16 v[192:195], v[240:243], v[132:135], v[192:195]
    ds_read_b64_tr_b16 v[224:225], v12 offset:40960
    ds_read_b64_tr_b16 v[226:227], v12 offset:43008
    v_mfma_f32_16x16x32_bf16 v[196:199], v[244:247], v[132:135], v[196:199]
    ds_read_b64_tr_b16 v[228:229], v13 offset:40960
    ds_read_b64_tr_b16 v[230:231], v13 offset:43008
    v_mfma_f32_16x16x32_bf16 v[200:203], v[248:251], v[132:135], v[200:203]
    ds_read_b64_tr_b16 v[232:233], v14 offset:40960
    ds_read_b64_tr_b16 v[234:235], v14 offset:43008
    v_mfma_f32_16x16x32_bf16 v[204:207], v[252:255], v[132:135], v[204:207]
    ds_read_b64_tr_b16 v[236:237], v15 offset:40960
    ds_read_b64_tr_b16 v[238:239], v15 offset:43008
    s_waitcnt lgkmcnt(8)
    v_mfma_f32_16x16x32_bf16 v[192:195], v[208:211], v[136:139], v[192:195]
    ds_read_b64_tr_b16 v[240:241], v12 offset:45056
    ds_read_b64_tr_b16 v[242:243], v12 offset:47104
    v_mfma_f32_16x16x32_bf16 v[196:199], v[212:215], v[136:139], v[196:199]
    ds_read_b64_tr_b16 v[244:245], v13 offset:45056
    ds_read_b64_tr_b16 v[246:247], v13 offset:47104
    v_mfma_f32_16x16x32_bf16 v[200:203], v[216:219], v[136:139], v[200:203]
    ds_read_b64_tr_b16 v[248:249], v14 offset:45056
    ds_read_b64_tr_b16 v[250:251], v14 offset:47104
    v_mfma_f32_16x16x32_bf16 v[204:207], v[220:223], v[136:139], v[204:207]
    ds_read_b64_tr_b16 v[252:253], v15 offset:45056
    ds_read_b64_tr_b16 v[254:255], v15 offset:47104
    s_waitcnt lgkmcnt(8)
    v_mfma_f32_16x16x32_bf16 v[192:195], v[224:227], v[140:143], v[192:195]
    ds_read_b64_tr_b16 v[208:209], v12 offset:49152
    ds_read_b64_tr_b16 v[210:211], v12 offset:51200
    v_mfma_f32_16x16x32_bf16 v[196:199], v[228:231], v[140:143], v[196:199]
    ds_read_b64_tr_b16 v[212:213], v13 offset:49152
    ds_read_b64_tr_b16 v[214:215], v13 offset:51200
    v_mfma_f32_16x16x32_bf16 v[200:203], v[232:235], v[140:143], v[200:203]
    ds_read_b64_tr_b16 v[216:217], v14 offset:49152
    ds_read_b64_tr_b16 v[218:219], v14 offset:51200
    v_mfma_f32_16x16x32_bf16 v[204:207], v[236:239], v[140:143], v[204:207]
    ds_read_b64_tr_b16 v[220:221], v15 offset:49152
    ds_read_b64_tr_b16 v[222:223], v15 offset:51200
    s_waitcnt vmcnt(8)
    v_max_u32 v7, v112, v114
    v_max3_u32 v7, v116, v118, v7
    v_max3_u32 v7, v120, v122, v7
    v_max3_u32 v7, v124, v126, v7
    v_cmp_eq_u32 vcc, -1, v7
    s_nop 0
    s_cbranch_vccnz L_rare_89
L_back_90:
    s_waitcnt lgkmcnt(8)
    v_mfma_f32_16x16x32_bf16 v[192:195], v[240:243], v[112:115], v[192:195]
    ds_read_b64_tr_b16 v[224:225], v12 offset:53248
    ds_read_b64_tr_b16 v[226:227], v12 offset:55296
    v_mfma_f32_16x16x32_bf16 v[196:199], v[244:247], v[112:115], v[196:199]
    ds_read_b64_tr_b16 v[228:229], v13 offset:53248
    ds_read_b64_tr_b16 v[230:231], v13 offset:55296
    v_mfma_f32_16x16x32_bf16 v[200:203], v[248:251], v[112:115], v[200:203]
    ds_read_b64_tr_b16 v[232:233], v14 offset:53248
    ds_read_b64_tr_b16 v[234:235], v14 offset:55296
    v_mfma_f32_16x16x32_bf16 v[204:207], v[252:255], v[112:115], v[204:207]
    ds_read_b64_tr_b16 v[236:237], v15 offset:53248
    ds_read_b64_tr_b16 v[238:239], v15 offset:55296
    s_waitcnt lgkmcnt(8)
    v_mfma_f32_16x16x32_bf16 v[192:195], v[208:211], v[116:119], v[192:195]
    ds_read_b64_tr_b16 v[240:241], v12 offset:57344
    ds_read_b64_tr_b16 v[242:243], v12 offset:59392
    v_mfma_f32_16x16x32_bf16 v[196:199], v[212:215], v[116:119], v[196:199]
    ds_read_b64_tr_b16 v[244:245], v13 offset:57344
    ds_read_b64_tr_b16 v[246:247], v13 offset:59392
    v_mfma_f32_16x16x32_bf16 v[200:203], v[216:219], v[116:119], v[200:203]
    ds_read_b64_tr_b16 v[248:249], v14 offset:57344
    ds_read_b64_tr_b16 v[250:251], v14 offset:59392
    v_mfma_f32_16x16x32_bf16 v[204:207], v[220:223], v[116:119], v[204:207]
    ds_read_b64_tr_b16 v[252:253], v15 offset:57344
    ds_read_b64_tr_b16 v[254:255], v15 offset:59392
    s_waitcnt lgkmcnt(8)
    v_mfma_f32_16x16x32_bf16 v[192:195], v[224:227], v[120:123], v[192:195]
    v_add_u32 v12, 61440, v12
    v_add_u32 v13, 61440, v13
    v_add_u32 v14, 61440, v14
    v_mfma_f32_16x16x32_bf16 v[196:199], v[228:231], v[120:123], v[196:199]
    v_add_u32 v15, 61440, v15
    ds_read_b64_tr_b16 v[208:209], v12 offset:0
    ds_read_b64_tr_b16 v[210:211], v12 offset:2048
    v_mfma_f32_16x16x32_bf16 v[200:203], v[232:235], v[120:123], v[200:203]
    ds_read_b64_tr_b16 v[212:213], v13 offset:0
    ds_read_b64_tr_b16 v[214:215], v13 offset:2048
    ds_read_b64_tr_b16 v[216:217], v14 offset:0
    v_mfma_f32_16x16x32_bf16 v[204:207], v[236:239], v[120:123], v[204:207]
    ds_read_b64_tr_b16 v[218:219], v14 offset:2048
    ds_read_b64_tr_b16 v[220:221], v15 offset:0
    ds_read_b64_tr_b16 v[222:223], v15 offset:2048
    s_waitcnt lgkmcnt(8)
    v_mfma_f32_16x16x32_bf16 v[192:195], v[240:243], v[124:127], v[192:195]
    ds_read_b64_tr_b16 v[224:225], v12 offset:4096
    ds_read_b64_tr_b16 v[226:227], v12 offset:6144
    v_mfma_f32_16x16x32_bf16 v[196:199], v[244:247], v[124:127], v[196:199]
    ds_read_b64_tr_b16 v[228:229], v13 offset:4096
    ds_read_b64_tr_b16 v[230:231], v13 offset:6144
    v_mfma_f32_16x16x32_bf16 v[200:203], v[248:251], v[124:127], v[200:203]
    ds_read_b64_tr_b16 v[232:233], v14 offset:4096
    ds_read_b64_tr_b16 v[234:235], v14 offset:6144
    v_mfma_f32_16x16x32_bf16 v[204:207], v[252:255], v[124:127], v[204:207]
    ds_read_b64_tr_b16 v[236:237], v15 offset:4096
    ds_read_b64_tr_b16 v[238:239], v15 offset:6144
    s_waitcnt vmcnt(4)
    v_max_u32 v7, v96, v98
    v_max3_u32 v7, v100, v102, v7
    v_max3_u32 v7, v104, v106, v7
    v_max3_u32 v7, v108, v110, v7
    v_cmp_eq_u32 vcc, -1, v7
    s_nop 0
    s_cbranch_vccnz L_rare_94
L_back_95:
    s_waitcnt lgkmcnt(8)
    v_mfma_f32_16x16x32_bf16 v[192:195], v[208:211], v[96:99], v[192:195]
    v_add_u32 v12, 4294844416, v12
    v_add_u32 v13, 4294844416, v13
    v_add_u32 v14, 4294844416, v14
    v_mfma_f32_16x16x32_bf16 v[196:199], v[212:215], v[96:99], v[196:199]
    v_add_u32 v15, 4294844416, v15
    ds_read_b64_tr_b16 v[240:241], v12 offset:0
    ds_read_b64_tr_b16 v[242:243], v12 offset:2048
    v_mfma_f32_16x16x32_bf16 v[200:203], v[216:219], v[96:99], v[200:203]
    ds_read_b64_tr_b16 v[244:245], v13 offset:0
    ds_read_b64_tr_b16 v[246:247], v13 offset:2048
    ds_read_b64_tr_b16 v[248:249], v14 offset:0
    v_mfma_f32_16x16x32_bf16 v[204:207], v[220:223], v[96:99], v[204:207]
    ds_read_b64_tr_b16 v[250:251], v14 offset:2048
    ds_read_b64_tr_b16 v[252:253], v15 offset:0
    ds_read_b64_tr_b16 v[254:255], v15 offset:2048
    s_waitcnt lgkmcnt(8)
    v_mfma_f32_16x16x32_bf16 v[192:195], v[224:227], v[100:103], v[192:195]
    ds_read_b64_tr_b16 v[208:209], v12 offset:4096
    ds_read_b64_tr_b16 v[210:211], v12 offset:6144
    v_mfma_f32_16x16x32_bf16 v[196:199], v[228:231], v[100:103], v[196:199]
    ds_read_b64_tr_b16 v[212:213], v13 offset:4096
    ds_read_b64_tr_b16 v[214:215], v13 offset:6144
    v_mfma_f32_16x16x32_bf16 v[200:203], v[232:235], v[100:103], v[200:203]
    ds_read_b64_tr_b16 v[216:217], v14 offset:4096
    ds_read_b64_tr_b16 v[218:219], v14 offset:6144
    v_mfma_f32_16x16x32_bf16 v[204:207], v[236:239], v[100:103], v[204:207]
    ds_read_b64_tr_b16 v[220:221], v15 offset:4096
    ds_read_b64_tr_b16 v[222:223], v15 offset:6144
    s_waitcnt lgkmcnt(8)
    v_mfma_f32_16x16x32_bf16 v[192:195], v[240:243], v[104:107], v[192:195]
    ds_read_b64_tr_b16 v[224:225], v12 offset:8192
    ds_read_b64_tr_b16 v[226:227], v12 offset:10240
    v_mfma_f32_16x16x32_bf16 v[196:199], v[244:247], v[104:107], v[196:199]
    ds_read_b64_tr_b16 v[228:229], v13 offset:8192
    ds_read_b64_tr_b16 v[230:231], v13 offset:10240
    v_mfma_f32_16x16x32_bf16 v[200:203], v[248:251], v[104:107], v[200:203]
    ds_read_b64_tr_b16 v[232:233], v14 offset:8192
    ds_read_b64_tr_b16 v[234:235], v14 offset:10240
    v_mfma_f32_16x16x32_bf16 v[204:207], v[252:255], v[104:107], v[204:207]
    ds_read_b64_tr_b16 v[236:237], v15 offset:8192
    ds_read_b64_tr_b16 v[238:239], v15 offset:10240
    s_waitcnt lgkmcnt(8)
    v_mfma_f32_16x16x32_bf16 v[192:195], v[208:211], v[108:111], v[192:195]
    ds_read_b64_tr_b16 v[240:241], v12 offset:12288
    ds_read_b64_tr_b16 v[242:243], v12 offset:14336
    v_mfma_f32_16x16x32_bf16 v[196:199], v[212:215], v[108:111], v[196:199]
    ds_read_b64_tr_b16 v[244:245], v13 offset:12288
    ds_read_b64_tr_b16 v[246:247], v13 offset:14336
    v_mfma_f32_16x16x32_bf16 v[200:203], v[216:219], v[108:111], v[200:203]
    ds_read_b64_tr_b16 v[248:249], v14 offset:12288
    ds_read_b64_tr_b16 v[250:251], v14 offset:14336
    v_mfma_f32_16x16x32_bf16 v[204:207], v[220:223], v[108:111], v[204:207]
    ds_read_b64_tr_b16 v[252:253], v15 offset:12288
    ds_read_b64_tr_b16 v[254:255], v15 offset:14336
    s_waitcnt vmcnt(0)
    v_max_u32 v7, v80, v82
    v_max3_u32 v7, v84, v86, v7
    v_max3_u32 v7, v88, v90, v7
    v_max3_u32 v7, v92, v94, v7
    v_cmp_eq_u32 vcc, -1, v7
    s_nop 0
    s_cbranch_vccnz L_rare_99
L_back_100:
    s_waitcnt lgkmcnt(8)
    v_mfma_f32_16x16x32_bf16 v[192:195], v[224:227], v[80:83], v[192:195]
    ds_read_b64_tr_b16 v[208:209], v12 offset:16384
    ds_read_b64_tr_b16 v[210:211], v12 offset:18432
    v_mfma_f32_16x16x32_bf16 v[196:199], v[228:231], v[80:83], v[196:199]
    ds_read_b64_tr_b16 v[212:213], v13 offset:16384
    ds_read_b64_tr_b16 v[214:215], v13 offset:18432
    v_mfma_f32_16x16x32_bf16 v[200:203], v[232:235], v[80:83], v[200:203]
    ds_read_b64_tr_b16 v[216:217], v14 offset:16384
    ds_read_b64_tr_b16 v[218:219], v14 offset:18432
    v_mfma_f32_16x16x32_bf16 v[204:207], v[236:239], v[80:83], v[204:207]
    ds_read_b64_tr_b16 v[220:221], v15 offset:16384
    ds_read_b64_tr_b16 v[222:223], v15 offset:18432
    s_waitcnt lgkmcnt(8)
    v_mfma_f32_16x16x32_bf16 v[192:195], v[240:243], v[84:87], v[192:195]
    ds_read_b64_tr_b16 v[224:225], v12 offset:20480
    ds_read_b64_tr_b16 v[226:227], v12 offset:22528
    v_mfma_f32_16x16x32_bf16 v[196:199], v[244:247], v[84:87], v[196:199]
    ds_read_b64_tr_b16 v[228:229], v13 offset:20480
    ds_read_b64_tr_b16 v[230:231], v13 offset:22528
    v_mfma_f32_16x16x32_bf16 v[200:203], v[248:251], v[84:87], v[200:203]
    ds_read_b64_tr_b16 v[232:233], v14 offset:20480
    ds_read_b64_tr_b16 v[234:235], v14 offset:22528
    v_mfma_f32_16x16x32_bf16 v[204:207], v[252:255], v[84:87], v[204:207]
    ds_read_b64_tr_b16 v[236:237], v15 offset:20480
    ds_read_b64_tr_b16 v[238:239], v15 offset:22528
    s_waitcnt lgkmcnt(8)
    v_mfma_f32_16x16x32_bf16 v[192:195], v[208:211], v[88:91], v[192:195]
    v_mfma_f32_16x16x32_bf16 v[196:199], v[212:215], v[88:91], v[196:199]
    v_mfma_f32_16x16x32_bf16 v[200:203], v[216:219], v[88:91], v[200:203]
    v_mfma_f32_16x16x32_bf16 v[204:207], v[220:223], v[88:91], v[204:207]
    s_waitcnt lgkmcnt(0)
    v_mfma_f32_16x16x32_bf16 v[192:195], v[224:227], v[92:95], v[192:195]
    v_mfma_f32_16x16x32_bf16 v[196:199], v[228:231], v[92:95], v[196:199]
    v_mfma_f32_16x16x32_bf16 v[200:203], v[232:235], v[92:95], v[200:203]
    v_mfma_f32_16x16x32_bf16 v[204:207], v[236:239], v[92:95], v[204:207]
    s_nop 4
    v_cvt_pk_bf16_f32 v36, v192, v193
    v_cvt_pk_bf16_f32 v37, v194, v195
    v_cvt_pk_bf16_f32 v38, v196, v197
    v_cvt_pk_bf16_f32 v39, v198, v199
    v_cvt_pk_bf16_f32 v40, v200, v201
    v_cvt_pk_bf16_f32 v41, v202, v203
    v_cvt_pk_bf16_f32 v42, v204, v205
    v_cvt_pk_bf16_f32 v43, v206, v207
    v_permlane16_swap_b32 v36, v38
    v_permlane16_swap_b32 v37, v39
    buffer_store_dwordx4 v[36:39], v32, s[36:39], s75 offen offset:0 sc1
    v_permlane16_swap_b32 v40, v42
    v_permlane16_swap_b32 v41, v43
    buffer_store_dwordx4 v[40:43], v32, s[36:39], s75 offen offset:64 sc1
    s_waitcnt vmcnt(0) lgkmcnt(0)
L_end:
    s_endpgm
L_rare_1:
    s_nop 7
    v_mov_b32 v156, 0
    v_mov_b32 v157, 0
    v_mov_b32 v158, 0
    v_mov_b32 v159, 0
    v_mov_b32 v160, 0
    v_mov_b32 v161, 0
    v_mov_b32 v162, 0
    v_mov_b32 v163, 0
    v_mov_b32 v164, 0
    v_mov_b32 v165, 0
    v_mov_b32 v166, 0
    v_mov_b32 v167, 0
    v_mov_b32 v168, 0
    v_mov_b32 v169, 0
    v_mov_b32 v170, 0
    v_mov_b32 v171, 0
    v_mov_b32 v172, 0
    v_mov_b32 v173, 0
    v_mov_b32 v174, 0
    v_mov_b32 v175, 0
    v_mov_b32 v176, 0
    v_mov_b32 v177, 0
    v_mov_b32 v178, 0
    v_mov_b32 v179, 0
    v_mov_b32 v180, 0
    v_mov_b32 v181, 0
    v_mov_b32 v182, 0
    v_mov_b32 v183, 0
    v_mov_b32 v184, 0
    v_mov_b32 v185, 0
    v_mov_b32 v186, 0
    v_mov_b32 v187, 0
    s_nop 1
    s_branch L_back_2
L_rare_4:
    s_mov_b32 s50, 262144
L_poll_7:
    buffer_load_dwordx4 v[56:59], v38, s[40:43], s57 offen sc1
    buffer_load_dwordx4 v[60:63], v38, s[40:43], s58 offen sc1
    s_waitcnt vmcnt(0)
    v_xor_b32 v2, v57, v59
    v_xor_b32 v3, v61, v63
    v_xor_b32 v4, s6, v57
    v_xor_b32 v5, s6, v61
    v_or3_b32 v2, v2, v3, v4
    v_or_b32 v2, v2, v5
    v_cmp_ne_u32 vcc, 0, v2
    s_nop 0
    s_cmp_eq_u64 vcc, 0
    s_cbranch_scc1 L_back_5
    s_sub_u32 s50, s50, 1
    s_cmp_lg_u32 s50, 0
    s_cbranch_scc1 L_poll_7
    s_nop 1
    s_branch L_back_5
L_rare_8:
    s_mov_b32 s50, 262144
L_poll_11:
    buffer_load_dword v27, v28, s[40:43], s86 offen sc1
    s_waitcnt vmcnt(0)
    v_cmp_eq_u32 vcc, s6, v27
    s_nop 0
    s_and_b64 s[48:49], vcc, s[44:45]
    s_cmp_eq_u64 s[48:49], s[44:45]
    s_cbranch_scc1 L_back_9
    s_sub_u32 s50, s50, 1
    s_cmp_lg_u32 s50, 0
    s_cbranch_scc1 L_poll_11
    s_nop 1
    s_branch L_back_9
L_rare_12:
    s_nop 11
    v_mov_b32 v176, s58
    v_mov_b32 v177, s58
    v_mov_b32 v178, s58
    v_mov_b32 v179, s58
    v_mov_b32 v180, s58
    v_mov_b32 v181, s58
    v_mov_b32 v182, s58
    v_mov_b32 v183, s58
    v_mov_b32 v184, s58
    v_mov_b32 v185, s58
    v_mov_b32 v186, s58
    v_mov_b32 v187, s58
    v_mov_b32 v188, s58
    v_mov_b32 v189, s58
    v_mov_b32 v190, s58
    v_mov_b32 v191, s58
    s_branch L_back_13
L_rare_15:
    s_nop 11
    v_mov_b32 v160, s58
    v_mov_b32 v161, s58
    v_mov_b32 v162, s58
    v_mov_b32 v163, s58
    v_mov_b32 v164, s58
    v_mov_b32 v165, s58
    v_mov_b32 v166, s58
    v_mov_b32 v167, s58
    v_mov_b32 v168, s58
    v_mov_b32 v169, s58
    v_mov_b32 v170, s58
    v_mov_b32 v171, s58
    v_mov_b32 v172, s58
    v_mov_b32 v173, s58
    v_mov_b32 v174, s58
    v_mov_b32 v175, s58
    s_branch L_back_16
L_rare_18:
    s_nop 11
    v_mov_b32 v144, s58
    v_mov_b32 v145, s58
    v_mov_b32 v146, s58
    v_mov_b32 v147, s58
    v_mov_b32 v148, s58
    v_mov_b32 v149, s58
    v_mov_b32 v150, s58
    v_mov_b32 v151, s58
    v_mov_b32 v152, s58
    v_mov_b32 v153, s58
    v_mov_b32 v154, s58
    v_mov_b32 v155, s58
    v_mov_b32 v156, s58
    v_mov_b32 v157, s58
    v_mov_b32 v158, s58
    v_mov_b32 v159, s58
    s_branch L_back_19
L_rare_21:
    s_nop 11
    v_mov_b32 v128, s58
    v_mov_b32 v129, s58
    v_mov_b32 v130, s58
    v_mov_b32 v131, s58
    v_mov_b32 v132, s58
    v_mov_b32 v133, s58
    v_mov_b32 v134, s58
    v_mov_b32 v135, s58
    v_mov_b32 v136, s58
    v_mov_b32 v137, s58
    v_mov_b32 v138, s58
    v_mov_b32 v139, s58
    v_mov_b32 v140, s58
    v_mov_b32 v141, s58
    v_mov_b32 v142, s58
    v_mov_b32 v143, s58
    s_branch L_back_22
L_rare_24:
    s_nop 11
    v_mov_b32 v112, s58
    v_mov_b32 v113, s58
    v_mov_b32 v114, s58
    v_mov_b32 v115, s58
    v_mov_b32 v116, s58
    v_mov_b32 v117, s58
    v_mov_b32 v118, s58
    v_mov_b32 v119, s58
    v_mov_b32 v120, s58
    v_mov_b32 v121, s58
    v_mov_b32 v122, s58
    v_mov_b32 v123, s58
    v_mov_b32 v124, s58
    v_mov_b32 v125, s58
    v_mov_b32 v126, s58
    v_mov_b32 v127, s58
    s_branch L_back_25
L_rare_27:
    s_nop 11
    v_mov_b32 v96, s58
    v_mov_b32 v97, s58
    v_mov_b32 v98, s58
    v_mov_b32 v99, s58
    v_mov_b32 v100, s58
    v_mov_b32 v101, s58
    v_mov_b32 v102, s58
    v_mov_b32 v103, s58
    v_mov_b32 v104, s58
    v_mov_b32 v105, s58
    v_mov_b32 v106, s58
    v_mov_b32 v107, s58
    v_mov_b32 v108, s58
    v_mov_b32 v109, s58
    v_mov_b32 v110, s58
    v_mov_b32 v111, s58
    s_branch L_back_28
L_rare_30:
    s_nop 11
    v_mov_b32 v80, s58
    v_mov_b32 v81, s58
    v_mov_b32 v82, s58
    v_mov_b32 v83, s58
    v_mov_b32 v84, s58
    v_mov_b32 v85, s58
    v_mov_b32 v86, s58
    v_mov_b32 v87, s58
    v_mov_b32 v88, s58
    v_mov_b32 v89, s58
    v_mov_b32 v90, s58
    v_mov_b32 v91, s58
    v_mov_b32 v92, s58
    v_mov_b32 v93, s58
    v_mov_b32 v94, s58
    v_mov_b32 v95, s58
    s_branch L_back_31
L_rare_33:
    s_nop 11
    v_mov_b32 v64, s58
    v_mov_b32 v65, s58
    v_mov_b32 v66, s58
    v_mov_b32 v67, s58
    v_mov_b32 v68, s58
    v_mov_b32 v69, s58
    v_mov_b32 v70, s58
    v_mov_b32 v71, s58
    v_mov_b32 v72, s58
    v_mov_b32 v73, s58
    v_mov_b32 v74, s58
    v_mov_b32 v75, s58
    v_mov_b32 v76, s58
    v_mov_b32 v77, s58
    v_mov_b32 v78, s58
    v_mov_b32 v79, s58
    s_branch L_back_34
L_rare_36:
    s_nop 11
    v_mov_b32 v176, s58
    v_mov_b32 v177, s58
    v_mov_b32 v178, s58
    v_mov_b32 v179, s58
    v_mov_b32 v180, s58
    v_mov_b32 v181, s58
    v_mov_b32 v182, s58
    v_mov_b32 v183, s58
    v_mov_b32 v184, s58
    v_mov_b32 v185, s58
    v_mov_b32 v186, s58
    v_mov_b32 v187, s58
    v_mov_b32 v188, s58
    v_mov_b32 v189, s58
    v_mov_b32 v190, s58
    v_mov_b32 v191, s58
    s_branch L_back_37
L_rare_39:
    s_nop 11
    v_mov_b32 v160, s58
    v_mov_b32 v161, s58
    v_mov_b32 v162, s58
    v_mov_b32 v163, s58
    v_mov_b32 v164, s58
    v_mov_b32 v165, s58
    v_mov_b32 v166, s58
    v_mov_b32 v167, s58
    v_mov_b32 v168, s58
    v_mov_b32 v169, s58
    v_mov_b32 v170, s58
    v_mov_b32 v171, s58
    v_mov_b32 v172, s58
    v_mov_b32 v173, s58
    v_mov_b32 v174, s58
    v_mov_b32 v175, s58
    s_branch L_back_40
L_rare_42:
    s_nop 11
    v_mov_b32 v144, s58
    v_mov_b32 v145, s58
    v_mov_b32 v146, s58
    v_mov_b32 v147, s58
    v_mov_b32 v148, s58
    v_mov_b32 v149, s58
    v_mov_b32 v150, s58
    v_mov_b32 v151, s58
    v_mov_b32 v152, s58
    v_mov_b32 v153, s58
    v_mov_b32 v154, s58
    v_mov_b32 v155, s58
    v_mov_b32 v156, s58
    v_mov_b32 v157, s58
    v_mov_b32 v158, s58
    v_mov_b32 v159, s58
    s_branch L_back_43
L_rare_45:
    s_nop 11
    v_mov_b32 v128, s58
    v_mov_b32 v129, s58
    v_mov_b32 v130, s58
    v_mov_b32 v131, s58
    v_mov_b32 v132, s58
    v_mov_b32 v133, s58
    v_mov_b32 v134, s58
    v_mov_b32 v135, s58
    v_mov_b32 v136, s58
    v_mov_b32 v137, s58
    v_mov_b32 v138, s58
    v_mov_b32 v139, s58
    v_mov_b32 v140, s58
    v_mov_b32 v141, s58
    v_mov_b32 v142, s58
    v_mov_b32 v143, s58
    s_branch L_back_46
L_rare_48:
    s_nop 11
    v_mov_b32 v112, s58
    v_mov_b32 v113, s58
    v_mov_b32 v114, s58
    v_mov_b32 v115, s58
    v_mov_b32 v116, s58
    v_mov_b32 v117, s58
    v_mov_b32 v118, s58
    v_mov_b32 v119, s58
    v_mov_b32 v120, s58
    v_mov_b32 v121, s58
    v_mov_b32 v122, s58
    v_mov_b32 v123, s58
    v_mov_b32 v124, s58
    v_mov_b32 v125, s58
    v_mov_b32 v126, s58
    v_mov_b32 v127, s58
    s_branch L_back_49
L_rare_51:
    s_nop 11
    v_mov_b32 v96, s58
    v_mov_b32 v97, s58
    v_mov_b32 v98, s58
    v_mov_b32 v99, s58
    v_mov_b32 v100, s58
    v_mov_b32 v101, s58
    v_mov_b32 v102, s58
    v_mov_b32 v103, s58
    v_mov_b32 v104, s58
    v_mov_b32 v105, s58
    v_mov_b32 v106, s58
    v_mov_b32 v107, s58
    v_mov_b32 v108, s58
    v_mov_b32 v109, s58
    v_mov_b32 v110, s58
    v_mov_b32 v111, s58
    s_branch L_back_52
L_rare_54:
    s_mov_b32 s50, 262144
L_poll_57:
    buffer_load_dword v27, v28, s[40:43], s51 offen sc1
    s_waitcnt vmcnt(0)
    v_cmp_eq_u32 vcc, s6, v27
    s_nop 0
    s_and_b64 s[48:49], vcc, s[44:45]
    s_cmp_eq_u64 s[48:49], s[44:45]
    s_cbranch_scc1 L_back_55
    s_sub_u32 s50, s50, 1
    s_cmp_lg_u32 s50, 0
    s_cbranch_scc1 L_poll_57
    s_nop 1
    s_branch L_back_55
L_rare_58:
    s_nop 11
    v_mov_b32 v80, s58
    v_mov_b32 v81, s58
    v_mov_b32 v82, s58
    v_mov_b32 v83, s58
    v_mov_b32 v84, s58
    v_mov_b32 v85, s58
    v_mov_b32 v86, s58
    v_mov_b32 v87, s58
    v_mov_b32 v88, s58
    v_mov_b32 v89, s58
    v_mov_b32 v90, s58
    v_mov_b32 v91, s58
    v_mov_b32 v92, s58
    v_mov_b32 v93, s58
    v_mov_b32 v94, s58
    v_mov_b32 v95, s58
    s_branch L_back_59
L_rare_61:
    s_mov_b32 s50, 262144
L_poll_64:
    buffer_load_dword v27, v28, s[40:43], s53 offen sc1
    s_waitcnt vmcnt(0)
    v_cmp_eq_u32 vcc, s6, v27
    s_nop 0
    s_and_b64 s[48:49], vcc, s[44:45]
    s_cmp_eq_u64 s[48:49], s[44:45]
    s_cbranch_scc1 L_back_62
    s_sub_u32 s50, s50, 1
    s_cmp_lg_u32 s50, 0
    s_cbranch_scc1 L_poll_64
    s_nop 1
    s_branch L_back_62
L_rare_65:
    s_mov_b32 s50, 262144
L_poll_68:
    buffer_load_dwordx4 v[60:63], v21, s[40:43], s72 offen offset:0 sc1
    buffer_load_dwordx4 v[64:67], v21, s[40:43], s72 offen offset:1024 sc1
    buffer_load_dwordx4 v[68:71], v21, s[40:43], s72 offen offset:2048 sc1
    buffer_load_dwordx4 v[72:75], v21, s[40:43], s72 offen offset:3072 sc1
    buffer_load_dwordx4 v[76:79], v19, s[40:43], s72 offen offset:0 sc1
    s_waitcnt vmcnt(0)
    v_xor_b32 v18, v63, v29
    v_bitop3_b32 v18, v67, v29, v18 bitop3:0xbe
    v_bitop3_b32 v18, v71, v29, v18 bitop3:0xbe
    v_bitop3_b32 v18, v75, v29, v18 bitop3:0xbe
    v_bitop3_b32 v18, v79, v29, v18 bitop3:0xbe
    v_and_b32 v18, s74, v18
    v_cmp_ne_u32 vcc, 0, v18
    s_nop 0
    s_cmp_eq_u64 vcc, 0
    s_cbranch_scc1 L_back_66
    s_sub_u32 s50, s50, 1
    s_cmp_lg_u32 s50, 0
    s_cbranch_scc1 L_poll_68
    s_nop 1
    s_branch L_back_66
L_rare_69:
    s_mov_b32 s50, 262144
L_poll_72:
    buffer_load_dwordx4 v[2:5], v6, s[40:43], s78 offen sc1
    s_waitcnt vmcnt(0)
    v_max_u32 v7, v2, v4
    v_cmp_eq_u32 vcc, -1, v7
    s_sub_u32 s50, s50, 1
    s_cbranch_scc1 L_back_70
    s_cbranch_vccnz L_poll_72
    s_add_u32 s67, s78, 0
    buffer_load_dwordx4 v[176:179], v21, s[40:43], s67 offen offset:0 sc1
    buffer_load_dwordx4 v[180:183], v21, s[40:43], s67 offen offset:1024 sc1
    buffer_load_dwordx4 v[184:187], v21, s[40:43], s67 offen offset:2048 sc1
    buffer_load_dwordx4 v[188:191], v21, s[40:43], s67 offen offset:3072 sc1
    s_add_u32 s67, s78, 4096
    buffer_load_dwordx4 v[160:163], v21, s[40:43], s67 offen offset:0 sc1
    buffer_load_dwordx4 v[164:167], v21, s[40:43], s67 offen offset:1024 sc1
    buffer_load_dwordx4 v[168:171], v21, s[40:43], s67 offen offset:2048 sc1
    buffer_load_dwordx4 v[172:175], v21, s[40:43], s67 offen offset:3072 sc1
    s_add_u32 s67, s78, 8192
    buffer_load_dwordx4 v[144:147], v21, s[40:43], s67 offen offset:0 sc1
    buffer_load_dwordx4 v[148:151], v21, s[40:43], s67 offen offset:1024 sc1
    buffer_load_dwordx4 v[152:155], v21, s[40:43], s67 offen offset:2048 sc1
    buffer_load_dwordx4 v[156:159], v21, s[40:43], s67 offen offset:3072 sc1
    s_add_u32 s67, s78, 12288
    buffer_load_dwordx4 v[128:131], v21, s[40:43], s67 offen offset:0 sc1
    buffer_load_dwordx4 v[132:135], v21, s[40:43], s67 offen offset:1024 sc1
    buffer_load_dwordx4 v[136:139], v21, s[40:43], s67 offen offset:2048 sc1
    buffer_load_dwordx4 v[140:143], v21, s[40:43], s67 offen offset:3072 sc1
    s_add_u32 s67, s78, 16384
    buffer_load_dwordx4 v[112:115], v21, s[40:43], s67 offen offset:0 sc1
    buffer_load_dwordx4 v[116:119], v21, s[40:43], s67 offen offset:1024 sc1
    buffer_load_dwordx4 v[120:123], v21, s[40:43], s67 offen offset:2048 sc1
    buffer_load_dwordx4 v[124:127], v21, s[40:43], s67 offen offset:3072 sc1
    s_add_u32 s67, s78, 20480
    buffer_load_dwordx4 v[96:99], v21, s[40:43], s67 offen offset:0 sc1
    buffer_load_dwordx4 v[100:103], v21, s[40:43], s67 offen offset:1024 sc1
    buffer_load_dwordx4 v[104:107], v21, s[40:43], s67 offen offset:2048 sc1
    buffer_load_dwordx4 v[108:111], v21, s[40:43], s67 offen offset:3072 sc1
    s_add_u32 s67, s78, 24576
    buffer_load_dwordx4 v[80:83], v21, s[40:43], s67 offen offset:0 sc1
    buffer_load_dwordx4 v[84:87], v21, s[40:43], s67 offen offset:1024 sc1
    buffer_load_dwordx4 v[88:91], v21, s[40:43], s67 offen offset:2048 sc1
    buffer_load_dwordx4 v[92:95], v21, s[40:43], s67 offen offset:3072 sc1
    s_waitcnt vmcnt(0)
    v_max_u32 v7, v176, v178
    v_max3_u32 v7, v180, v182, v7
    v_max3_u32 v7, v184, v186, v7
    v_max3_u32 v7, v188, v190, v7
    v_cmp_eq_u32 vcc, -1, v7
    s_nop 0
    s_cbranch_vccnz L_poll_72
    s_nop 1
    s_branch L_back_70
L_rare_74:
    s_mov_b32 s50, 262144
L_poll_77:
    buffer_load_dwordx4 v[2:5], v6, s[40:43], s78 offen sc1
    s_waitcnt vmcnt(0)
    v_max_u32 v7, v2, v4
    v_cmp_eq_u32 vcc, -1, v7
    s_sub_u32 s50, s50, 1
    s_cbranch_scc1 L_back_75
    s_cbranch_vccnz L_poll_77
    s_add_u32 s67, s78, 4096
    buffer_load_dwordx4 v[160:163], v21, s[40:43], s67 offen offset:0 sc1
    buffer_load_dwordx4 v[164:167], v21, s[40:43], s67 offen offset:1024 sc1
    buffer_load_dwordx4 v[168:171], v21, s[40:43], s67 offen offset:2048 sc1
    buffer_load_dwordx4 v[172:175], v21, s[40:43], s67 offen offset:3072 sc1
    s_add_u32 s67, s78, 8192
    buffer_load_dwordx4 v[144:147], v21, s[40:43], s67 offen offset:0 sc1
    buffer_load_dwordx4 v[148:151], v21, s[40:43], s67 offen offset:1024 sc1
    buffer_load_dwordx4 v[152:155], v21, s[40:43], s67 offen offset:2048 sc1
    buffer_load_dwordx4 v[156:159], v21, s[40:43], s67 offen offset:3072 sc1
    s_add_u32 s67, s78, 12288
    buffer_load_dwordx4 v[128:131], v21, s[40:43], s67 offen offset:0 sc1
    buffer_load_dwordx4 v[132:135], v21, s[40:43], s67 offen offset:1024 sc1
    buffer_load_dwordx4 v[136:139], v21, s[40:43], s67 offen offset:2048 sc1
    buffer_load_dwordx4 v[140:143], v21, s[40:43], s67 offen offset:3072 sc1
    s_add_u32 s67, s78, 16384
    buffer_load_dwordx4 v[112:115], v21, s[40:43], s67 offen offset:0 sc1
    buffer_load_dwordx4 v[116:119], v21, s[40:43], s67 offen offset:1024 sc1
    buffer_load_dwordx4 v[120:123], v21, s[40:43], s67 offen offset:2048 sc1
    buffer_load_dwordx4 v[124:127], v21, s[40:43], s67 offen offset:3072 sc1
    s_add_u32 s67, s78, 20480
    buffer_load_dwordx4 v[96:99], v21, s[40:43], s67 offen offset:0 sc1
    buffer_load_dwordx4 v[100:103], v21, s[40:43], s67 offen offset:1024 sc1
    buffer_load_dwordx4 v[104:107], v21, s[40:43], s67 offen offset:2048 sc1
    buffer_load_dwordx4 v[108:111], v21, s[40:43], s67 offen offset:3072 sc1
    s_add_u32 s67, s78, 24576
    buffer_load_dwordx4 v[80:83], v21, s[40:43], s67 offen offset:0 sc1
    buffer_load_dwordx4 v[84:87], v21, s[40:43], s67 offen offset:1024 sc1
    buffer_load_dwordx4 v[88:91], v21, s[40:43], s67 offen offset:2048 sc1
    buffer_load_dwordx4 v[92:95], v21, s[40:43], s67 offen offset:3072 sc1
    s_waitcnt vmcnt(0)
    v_max_u32 v7, v160, v162
    v_max3_u32 v7, v164, v166, v7
    v_max3_u32 v7, v168, v170, v7
    v_max3_u32 v7, v172, v174, v7
    v_cmp_eq_u32 vcc, -1, v7
    s_nop 0
    s_cbranch_vccnz L_poll_77
    s_nop 1
    s_branch L_back_75
L_rare_79:
    s_mov_b32 s50, 262144
L_poll_82:
    buffer_load_dwordx4 v[2:5], v6, s[40:43], s78 offen sc1
    s_waitcnt vmcnt(0)
    v_max_u32 v7, v2, v4
    v_cmp_eq_u32 vcc, -1, v7
    s_sub_u32 s50, s50, 1
    s_cbranch_scc1 L_back_80
    s_cbranch_vccnz L_poll_82
    s_add_u32 s67, s78, 8192
    buffer_load_dwordx4 v[144:147], v21, s[40:43], s67 offen offset:0 sc1
    buffer_load_dwordx4 v[148:151], v21, s[40:43], s67 offen offset:1024 sc1
    buffer_load_dwordx4 v[152:155], v21, s[40:43], s67 offen offset:2048 sc1
    buffer_load_dwordx4 v[156:159], v21, s[40:43], s67 offen offset:3072 sc1
    s_add_u32 s67, s78, 12288
    buffer_load_dwordx4 v[128:131], v21, s[40:43], s67 offen offset:0 sc1
    buffer_load_dwordx4 v[132:135], v21, s[40:43], s67 offen offset:1024 sc1
    buffer_load_dwordx4 v[136:139], v21, s[40:43], s67 offen offset:2048 sc1
    buffer_load_dwordx4 v[140:143], v21, s[40:43], s67 offen offset:3072 sc1
    s_add_u32 s67, s78, 16384
    buffer_load_dwordx4 v[112:115], v21, s[40:43], s67 offen offset:0 sc1
    buffer_load_dwordx4 v[116:119], v21, s[40:43], s67 offen offset:1024 sc1
    buffer_load_dwordx4 v[120:123], v21, s[40:43], s67 offen offset:2048 sc1
    buffer_load_dwordx4 v[124:127], v21, s[40:43], s67 offen offset:3072 sc1
    s_add_u32 s67, s78, 20480
    buffer_load_dwordx4 v[96:99], v21, s[40:43], s67 offen offset:0 sc1
    buffer_load_dwordx4 v[100:103], v21, s[40:43], s67 offen offset:1024 sc1
    buffer_load_dwordx4 v[104:107], v21, s[40:43], s67 offen offset:2048 sc1
    buffer_load_dwordx4 v[108:111], v21, s[40:43], s67 offen offset:3072 sc1
    s_add_u32 s67, s78, 24576
    buffer_load_dwordx4 v[80:83], v21, s[40:43], s67 offen offset:0 sc1
    buffer_load_dwordx4 v[84:87], v21, s[40:43], s67 offen offset:1024 sc1
    buffer_load_dwordx4 v[88:91], v21, s[40:43], s67 offen offset:2048 sc1
    buffer_load_dwordx4 v[92:95], v21, s[40:43], s67 offen offset:3072 sc1
    s_waitcnt vmcnt(0)
    v_max_u32 v7, v144, v146
    v_max3_u32 v7, v148, v150, v7
    v_max3_u32 v7, v152, v154, v7
    v_max3_u32 v7, v156, v158, v7
    v_cmp_eq_u32 vcc, -1, v7
    s_nop 0
    s_cbranch_vccnz L_poll_82
    s_nop 1
    s_branch L_back_80
L_rare_84:
    s_mov_b32 s50, 262144
L_poll_87:
    buffer_load_dwordx4 v[2:5], v6, s[40:43], s78 offen sc1
    s_waitcnt vmcnt(0)
    v_max_u32 v7, v2, v4
    v_cmp_eq_u32 vcc, -1, v7
    s_sub_u32 s50, s50, 1
    s_cbranch_scc1 L_back_85
    s_cbranch_vccnz L_poll_87
    s_add_u32 s67, s78, 12288
    buffer_load_dwordx4 v[128:131], v21, s[40:43], s67 offen offset:0 sc1
    buffer_load_dwordx4 v[132:135], v21, s[40:43], s67 offen offset:1024 sc1
    buffer_load_dwordx4 v[136:139], v21, s[40:43], s67 offen offset:2048 sc1
    buffer_load_dwordx4 v[140:143], v21, s[40:43], s67 offen offset:3072 sc1
    s_add_u32 s67, s78, 16384
    buffer_load_dwordx4 v[112:115], v21, s[40:43], s67 offen offset:0 sc1
    buffer_load_dwordx4 v[116:119], v21, s[40:43], s67 offen offset:1024 sc1
    buffer_load_dwordx4 v[120:123], v21, s[40:43], s67 offen offset:2048 sc1
    buffer_load_dwordx4 v[124:127], v21, s[40:43], s67 offen offset:3072 sc1
    s_add_u32 s67, s78, 20480
    buffer_load_dwordx4 v[96:99], v21, s[40:43], s67 offen offset:0 sc1
    buffer_load_dwordx4 v[100:103], v21, s[40:43], s67 offen offset:1024 sc1
    buffer_load_dwordx4 v[104:107], v21, s[40:43], s67 offen offset:2048 sc1
    buffer_load_dwordx4 v[108:111], v21, s[40:43], s67 offen offset:3072 sc1
    s_add_u32 s67, s78, 24576
    buffer_load_dwordx4 v[80:83], v21, s[40:43], s67 offen offset:0 sc1
    buffer_load_dwordx4 v[84:87], v21, s[40:43], s67 offen offset:1024 sc1
    buffer_load_dwordx4 v[88:91], v21, s[40:43], s67 offen offset:2048 sc1
    buffer_load_dwordx4 v[92:95], v21, s[40:43], s67 offen offset:3072 sc1
    s_waitcnt vmcnt(0)
    v_max_u32 v7, v128, v130
    v_max3_u32 v7, v132, v134, v7
    v_max3_u32 v7, v136, v138, v7
    v_max3_u32 v7, v140, v142, v7
    v_cmp_eq_u32 vcc, -1, v7
    s_nop 0
    s_cbranch_vccnz L_poll_87
    s_nop 1
    s_branch L_back_85
L_rare_89:
    s_mov_b32 s50, 262144
L_poll_92:
    buffer_load_dwordx4 v[2:5], v6, s[40:43], s78 offen sc1
    s_waitcnt vmcnt(0)
    v_max_u32 v7, v2, v4
    v_cmp_eq_u32 vcc, -1, v7
    s_sub_u32 s50, s50, 1
    s_cbranch_scc1 L_back_90
    s_cbranch_vccnz L_poll_92
    s_add_u32 s67, s78, 16384
    buffer_load_dwordx4 v[112:115], v21, s[40:43], s67 offen offset:0 sc1
    buffer_load_dwordx4 v[116:119], v21, s[40:43], s67 offen offset:1024 sc1
    buffer_load_dwordx4 v[120:123], v21, s[40:43], s67 offen offset:2048 sc1
    buffer_load_dwordx4 v[124:127], v21, s[40:43], s67 offen offset:3072 sc1
    s_add_u32 s67, s78, 20480
    buffer_load_dwordx4 v[96:99], v21, s[40:43], s67 offen offset:0 sc1
    buffer_load_dwordx4 v[100:103], v21, s[40:43], s67 offen offset:1024 sc1
    buffer_load_dwordx4 v[104:107], v21, s[40:43], s67 offen offset:2048 sc1
    buffer_load_dwordx4 v[108:111], v21, s[40:43], s67 offen offset:3072 sc1
    s_add_u32 s67, s78, 24576
    buffer_load_dwordx4 v[80:83], v21, s[40:43], s67 offen offset:0 sc1
    buffer_load_dwordx4 v[84:87], v21, s[40:43], s67 offen offset:1024 sc1
    buffer_load_dwordx4 v[88:91], v21, s[40:43], s67 offen offset:2048 sc1
    buffer_load_dwordx4 v[92:95], v21, s[40:43], s67 offen offset:3072 sc1
    s_waitcnt vmcnt(0)
    v_max_u32 v7, v112, v114
    v_max3_u32 v7, v116, v118, v7
    v_max3_u32 v7, v120, v122, v7
    v_max3_u32 v7, v124, v126, v7
    v_cmp_eq_u32 vcc, -1, v7
    s_nop 0
    s_cbranch_vccnz L_poll_92
    s_nop 1
    s_branch L_back_90
L_rare_94:
    s_mov_b32 s50, 262144
L_poll_97:
    buffer_load_dwordx4 v[2:5], v6, s[40:43], s78 offen sc1
    s_waitcnt vmcnt(0)
    v_max_u32 v7, v2, v4
    v_cmp_eq_u32 vcc, -1, v7
    s_sub_u32 s50, s50, 1
    s_cbranch_scc1 L_back_95
    s_cbranch_vccnz L_poll_97
    s_add_u32 s67, s78, 20480
    buffer_load_dwordx4 v[96:99], v21, s[40:43], s67 offen offset:0 sc1
    buffer_load_dwordx4 v[100:103], v21, s[40:43], s67 offen offset:1024 sc1
    buffer_load_dwordx4 v[104:107], v21, s[40:43], s67 offen offset:2048 sc1
    buffer_load_dwordx4 v[108:111], v21, s[40:43], s67 offen offset:3072 sc1
    s_add_u32 s67, s78, 24576
    buffer_load_dwordx4 v[80:83], v21, s[40:43], s67 offen offset:0 sc1
    buffer_load_dwordx4 v[84:87], v21, s[40:43], s67 offen offset:1024 sc1
    buffer_load_dwordx4 v[88:91], v21, s[40:43], s67 offen offset:2048 sc1
    buffer_load_dwordx4 v[92:95], v21, s[40:43], s67 offen offset:3072 sc1
    s_waitcnt vmcnt(0)
    v_max_u32 v7, v96, v98
    v_max3_u32 v7, v100, v102, v7
    v_max3_u32 v7, v104, v106, v7
    v_max3_u32 v7, v108, v110, v7
    v_cmp_eq_u32 vcc, -1, v7
    s_nop 0
    s_cbranch_vccnz L_poll_97
    s_nop 1
    s_branch L_back_95
L_rare_99:
    s_mov_b32 s50, 262144
L_poll_102:
    buffer_load_dwordx4 v[2:5], v6, s[40:43], s78 offen sc1
    s_waitcnt vmcnt(0)
    v_max_u32 v7, v2, v4
    v_cmp_eq_u32 vcc, -1, v7
    s_sub_u32 s50, s50, 1
    s_cbranch_scc1 L_back_100
    s_cbranch_vccnz L_poll_102
    s_add_u32 s67, s78, 24576
    buffer_load_dwordx4 v[80:83], v21, s[40:43], s67 offen offset:0 sc1
    buffer_load_dwordx4 v[84:87], v21, s[40:43], s67 offen offset:1024 sc1
    buffer_load_dwordx4 v[88:91], v21, s[40:43], s67 offen offset:2048 sc1
    buffer_load_dwordx4 v[92:95], v21, s[40:43], s67 offen offset:3072 sc1
    s_waitcnt vmcnt(0)
    v_max_u32 v7, v80, v82
    v_max3_u32 v7, v84, v86, v7
    v_max3_u32 v7, v88, v90, v7
    v_max3_u32 v7, v92, v94, v7
    v_cmp_eq_u32 vcc, -1, v7
    s_nop 0
    s_cbranch_vccnz L_poll_102
    s_nop 1
    s_branch L_back_100
L_last:
    s_endpgm
.section .rodata,"a"
.p2align 6
.amdhsa_kernel parallel_sum__sliding_block__mixer_gmlp__prompt_kernel
  .amdhsa_next_free_vgpr 512
  .amdhsa_next_free_sgpr 102
  .amdhsa_accum_offset 256
  .amdhsa_group_segment_fixed_size 0
  .amdhsa_kernarg_size 88
  .amdhsa_user_sgpr_count 2
  .amdhsa_user_sgpr_kernarg_segment_ptr 1
  .amdhsa_system_sgpr_workgroup_id_x 1
  .amdhsa_float_denorm_mode_32 3
.end_amdhsa_kernel
```
